```python
import torch

def _softmax(x, axis=-1):
    return torch.softmax(x, dim=axis)
def _gelu(x):
    return torch.nn.functional.gelu(x, approximate="tanh")
def _silu(x):
    return torch.nn.functional.silu(x)
def _sigmoid(x):
    return torch.sigmoid(x)
def _layernorm(x, axis=-1, eps=1e-5):
    m = x.mean(dim=axis, keepdim=True)
    v = x.var(dim=axis, keepdim=True, unbiased=False)
    return (x - m) / torch.sqrt(v + eps)
def _scatter_add(tgt, idx, src, axis=0):
    return tgt.clone().index_add_(axis, idx, src)
def _segment_sum(src, seg, n):
    out = torch.zeros((n,) + src.shape[1:], dtype=src.dtype)
    return out.index_add_(0, seg, src)
def _pad(x, pw):
    flat = tuple(v for pair in reversed(pw) for v in pair)
    return torch.nn.functional.pad(x, flat)

kernel_name = 'concat_heads__gqa_block_cached__mha_block_cached__near_ridge'

def setup_inputs():

    _w = (lambda a: (lambda t: t.to(torch.bfloat16) if t.is_floating_point() else t)(torch.as_tensor(a)))
    def _A_setup():
        B, Sq, D = 8, 160, 448
        Hq, Hkv, Sk, Dh = 16, 8, 1024, 256
        assert Hq % Hkv == 0, (Hq, Hkv)
        return {
            "x": _w((lambda *s: torch.randn(*s, dtype=torch.bfloat16) * 0.8)(B, Sq, D)),
            "k_cache": _w((lambda *s: torch.randn(*s, dtype=torch.bfloat16) * 0.8)(B, Hkv, Sk, Dh)),
            "v_cache": _w((lambda *s: torch.randn(*s, dtype=torch.bfloat16) * 0.05)(B, Hkv, Sk, Dh)),
            "wq": _w((lambda *s: torch.randn(*s, dtype=torch.bfloat16) * 0.8)(D, Hq * Dh) * (D ** -0.5)),
            "wo": _w((lambda *s: torch.randn(*s, dtype=torch.bfloat16) * 0.05)(Hq * Dh, D) * ((Hq * Dh) ** -0.5)),
        }
    _A_in = _A_setup()

    def _B_setup():
        B, Sq, D = 8, 160, 448
        H, Sk, Dh = 16, 1024, 256
        return {
            "x": _w((lambda *s: torch.randn(*s, dtype=torch.bfloat16) * 0.8)(B, Sq, D)),
            "k_cache": _w((lambda *s: torch.randn(*s, dtype=torch.bfloat16) * 0.8)(B, H, Sk, Dh)),
            "v_cache": _w((lambda *s: torch.randn(*s, dtype=torch.bfloat16) * 0.05)(B, H, Sk, Dh)),
            "wq": _w((lambda *s: torch.randn(*s, dtype=torch.bfloat16) * 0.8)(D, H * Dh) * (D ** -0.5)),
            "wo": _w((lambda *s: torch.randn(*s, dtype=torch.bfloat16) * 0.05)(H * Dh, D) * ((H * Dh) ** -0.5)),
        }
    _B_in = _B_setup()

    return {
        "A_x": _A_in["x"],
        "A_k_cache": _A_in["k_cache"],
        "A_v_cache": _A_in["v_cache"],
        "A_wq": _A_in["wq"],
        "A_wo": _A_in["wo"],
        "B_x": _B_in["x"],
        "B_k_cache": _B_in["k_cache"],
        "B_v_cache": _B_in["v_cache"],
        "B_wq": _B_in["wq"],
        "B_wo": _B_in["wo"],
    }

def reference(A_x, A_k_cache, A_v_cache, A_wq, A_wo, B_x, B_k_cache, B_v_cache, B_wq, B_wo):
    def _A_ref(x, k_cache, v_cache, wq, wo):
        B, Sq, D = x.shape
        Hq, Dh = 16, 256
        Hkv = k_cache.shape[1]
        rep = Hq // Hkv
        q = (lambda x, *d: x.permute(*d))((x @ wq).reshape(B, Sq, Hq, Dh), 0, 2, 1, 3)
        k = (lambda x, n, axis: torch.repeat_interleave(x, n, dim=axis))(k_cache, rep, axis=1)
        v = (lambda x, n, axis: torch.repeat_interleave(x, n, dim=axis))(v_cache, rep, axis=1)
        scores = torch.einsum("bhqd,bhkd->bhqk", q, k) * (Dh ** -0.5)
        p = _softmax(scores, axis=-1)
        o = torch.einsum("bhqk,bhkd->bhqd", p, v)
        return (lambda x, *d: x.permute(*d))(o, 0, 2, 1, 3).reshape(B, Sq, Hq * Dh) @ wo

    def _B_ref(x, k_cache, v_cache, wq, wo):
        B, Sq, D = x.shape
        H, Dh = 16, 256
        q = (lambda x, *d: x.permute(*d))((x @ wq).reshape(B, Sq, H, Dh), 0, 2, 1, 3)
        scores = torch.einsum("bhqd,bhkd->bhqk", q, k_cache) * (Dh ** -0.5)
        p = _softmax(scores, axis=-1)
        o = torch.einsum("bhqk,bhkd->bhqd", p, v_cache)
        return (lambda x, *d: x.permute(*d))(o, 0, 2, 1, 3).reshape(B, Sq, H * Dh) @ wo

    a = _A_ref(A_x, A_k_cache, A_v_cache, A_wq, A_wo)
    b = _B_ref(B_x, B_k_cache, B_v_cache, B_wq, B_wo)
    return torch.concatenate([a, b], axis=-1)
```

```asm
; @launch grid=(256,1,1) block=(256,1,1) lds=163840
.amdgcn_target "amdgcn-amd-amdhsa--gfx950"
.text
.globl concat_heads__gqa_block_cached__mha_block_cached__near_ridge_kernel
.p2align 8
.type concat_heads__gqa_block_cached__mha_block_cached__near_ridge_kernel,@function
concat_heads__gqa_block_cached__mha_block_cached__near_ridge_kernel:
    s_cmp_lt_u32 s2, 256
    s_cbranch_scc1 L_code_start
    s_endpgm
L_code_start:
    s_load_dwordx16 s[4:19], s[0:1], 0
    s_load_dwordx8 s[20:27], s[0:1], 64
    s_load_dwordx2 s[28:29], s[0:1], 96
    v_lshrrev_b32 v252, 6, v0
    v_and_b32 v182, 63, v0
    v_readfirstlane_b32 s30, v252
    s_getpc_b64 s[100:101]
L_pc:
    s_add_u32 s100, s100, 0x12db
    s_addc_u32 s101, s101, 0
    s_and_b32 s100, s100, 0xfffff000
    s_lshr_b32 s85, s2, 3
    v_lshl_add_u32 v240, s85, 2, v252
    v_min_u32 v253, 2, v182
    v_lshl_add_u32 v253, v253, 7, v240
    v_lshlrev_b32 v253, 7, v253
    v_min_u32 v253, 0x92c0, v253
    global_load_dword a255, v253, s[100:101]
    s_and_b32 s84, s2, 7
    s_and_b32 s86, s85, 1
    s_lshl_b32 s87, s84, 1
    s_or_b32 s87, s87, s86
    s_bfe_u32 s88, s85, 0x10001
    s_lshr_b32 s89, s85, 2
    s_lshl_b32 s92, s30, 12
    s_lshl_b32 s31, s30, 10
    v_and_b32 v183, 31, v182
    v_lshrrev_b32 v184, 5, v182
    v_lshrrev_b32 v186, 4, v182
    v_lshrrev_b32 v252, 3, v182
    v_and_b32 v253, 7, v182
    v_xor_b32 v253, v253, v186
    v_mul_u32_u24 v252, 896, v252
    s_mul_i32 s90, s30, 28672
    v_lshl_add_u32 v172, v253, 4, v252
    v_xor_b32 v173, 64, v172
    s_and_b32 s91, s30, 1
    s_lshl_b32 s85, s91, 6
    v_xor_b32 v176, s85, v172
    v_add_u32 v172, s90, v172
    s_add_u32 s90, s90, 6144
    v_add_u32 v173, s90, v173
    v_add_u32 v174, 12288, v172
    v_add_u32 v175, 12288, v173
    s_mul_i32 s90, s30, 7168
    s_add_u32 s90, s90, 114688
    v_add_u32 v176, s90, v176
    s_lshl_b32 s85, s91, 3
    v_lshlrev_b32 v252, 1, v184
    v_xor_b32 v252, v252, v183
    v_xor_b32 v252, s85, v252
    v_lshlrev_b32 v252, 4, v252
    v_lshl_add_u32 v252, v184, 13, v252
    s_lshl_b32 s90, s30, 16
    v_add_u32 v168, s90, v252
    v_xor_b32 v169, 64, v168
    v_add_u32 v169, 15360, v169
    v_add_u32 v170, 30720, v168
    v_add_u32 v171, 30720, v169
    s_mul_i32 s90, s89, 143360
    s_lshl_b32 s91, s87, 9
    s_mov_b32 s34, 143360
    s_mov_b32 s35, 0x20000
    s_sub_u32 s38, 3670016, s91
    s_mov_b32 s39, 0x20000
    s_waitcnt lgkmcnt(0)
    s_cmp_eq_u32 s88, 0
    s_cselect_b64 s[32:33], s[4:5], s[14:15]
    s_cselect_b64 s[36:37], s[10:11], s[20:21]
    s_cselect_b64 s[40:41], s[6:7], s[16:17]
    s_cselect_b64 s[44:45], s[8:9], s[18:19]
    s_cselect_b64 s[48:49], s[12:13], s[22:23]
    s_cselect_b32 s84, s84, s87
    s_cselect_b32 s85, 3, 4
    s_add_u32 s32, s32, s90
    s_addc_u32 s33, s33, 0
    s_and_b32 s33, s33, 0xffff
    s_add_u32 s36, s36, s91
    s_addc_u32 s37, s37, 0
    s_and_b32 s37, s37, 0xffff
    s_add_u32 m0, s92, 98304
    s_mov_b32 s97, 0
    buffer_load_dwordx4 v172, s[32:35], s97 offen offset:0 lds
    buffer_load_dwordx4 v173, s[32:35], s97 offen offset:1024 lds
    buffer_load_dwordx4 v174, s[32:35], s97 offen offset:2048 lds
    buffer_load_dwordx4 v175, s[32:35], s97 offen offset:3072 lds
    s_add_u32 m0, s31, 114688
    s_nop 0
    buffer_load_dwordx4 v176, s[32:35], s97 offen lds
    s_add_u32 m0, s92, 0
    s_mov_b32 s97, 0
    buffer_load_dwordx4 v168, s[36:39], s97 offen offset:0 lds
    buffer_load_dwordx4 v169, s[36:39], s97 offen offset:1024 lds
    buffer_load_dwordx4 v170, s[36:39], s97 offen offset:2048 lds
    buffer_load_dwordx4 v171, s[36:39], s97 offen offset:3072 lds
    s_and_b32 s10, s30, 1
    s_lshr_b32 s11, s30, 1
    v_and_b32 v185, 15, v182
    v_and_b32 v187, 3, v182
    s_add_u32 m0, s92, 16384
    s_mov_b32 s97, 262144
    buffer_load_dwordx4 v168, s[36:39], s97 offen offset:0 lds
    v_lshlrev_b32 v187, 3, v187
    v_bfe_u32 v251, v182, 2, 3
    v_lshl_add_u32 v251, v251, 5, v187
    s_lshl_b32 s90, s10, 8
    buffer_load_dwordx4 v169, s[36:39], s97 offen offset:1024 lds
    v_add_u32 v251, s90, v251
    v_lshrrev_b32 v252, 2, v185
    v_lshl_add_u32 v252, v186, 3, v252
    v_lshl_add_u32 v160, v252, 9, v251
    buffer_load_dwordx4 v170, s[36:39], s97 offen offset:2048 lds
    v_xor_b32 v161, 32, v160
    v_xor_b32 v162, 64, v160
    v_xor_b32 v163, 96, v160
    v_xor_b32 v164, 128, v160
    buffer_load_dwordx4 v171, s[36:39], s97 offen offset:3072 lds
    v_xor_b32 v165, 160, v160
    v_xor_b32 v166, 192, v160
    v_xor_b32 v167, 224, v160
    v_lshrrev_b32 v252, 1, v185
    v_xor_b32 v252, v252, v186
    v_lshlrev_b32 v252, 4, v252
    v_lshl_add_u32 v252, v185, 7, v252
    s_mul_i32 s90, s11, 10240
    s_add_u32 s90, s90, 98304
    v_add_u32 v177, s90, v252
    v_xor_b32 v178, 64, v177
    s_mov_b64 exec, 0
    s_cmp_eq_u32 s30, 0
    s_cbranch_scc1 L_pg1
    s_cmp_eq_u32 s30, 1
    s_cbranch_scc1 L_pg2
    s_cmp_eq_u32 s30, 2
    s_cbranch_scc1 L_pg3
    s_branch L_pg4
L_pro_end:
.p2align 12
L_align:
L_pgret:
    s_mov_b64 exec, -1
    s_waitcnt vmcnt(4)
    s_barrier
    ds_read_b128 a[0:3], v177 offset:0
    ds_read_b128 a[32:35], v177 offset:2048
    ds_read_b64_tr_b16 a[192:193], v160 offset:0
    ds_read_b64_tr_b16 a[194:195], v160 offset:2048
    ds_read_b128 a[64:67], v177 offset:4096
    ds_read_b128 a[96:99], v177 offset:6144
    ds_read_b128 a[128:131], v177 offset:8192
    ds_read_b64_tr_b16 a[196:197], v161 offset:0
    s_waitcnt lgkmcnt(4)
    v_mfma_f32_16x16x32_bf16 v[0:3], a[192:195], a[0:3], 0
    s_add_u32 m0, s92, 118784
    ds_read_b64_tr_b16 a[198:199], v161 offset:2048
    v_mfma_f32_16x16x32_bf16 v[32:35], a[192:195], a[32:35], 0
    s_waitcnt lgkmcnt(4)
    ds_read_b64_tr_b16 a[200:201], v162 offset:0
    ds_read_b64_tr_b16 a[202:203], v162 offset:2048
    v_mfma_f32_16x16x32_bf16 v[64:67], a[192:195], a[64:67], 0
    s_waitcnt lgkmcnt(5)
    ds_read_b128 a[4:7], v178 offset:0
    v_mfma_f32_16x16x32_bf16 v[96:99], a[192:195], a[96:99], 0
    s_waitcnt lgkmcnt(5)
    s_mov_b32 s97, 128
    v_mfma_f32_16x16x32_bf16 v[128:131], a[192:195], a[128:131], 0
    s_waitcnt lgkmcnt(3)
    buffer_load_dwordx4 v172, s[32:35], s97 offen offset:0 lds
    v_mfma_f32_16x16x32_bf16 v[132:135], a[196:199], a[128:131], 0
    ds_read_b128 a[36:39], v178 offset:2048
    ds_read_b64_tr_b16 a[204:205], v163 offset:0
    v_mfma_f32_16x16x32_bf16 v[100:103], a[196:199], a[96:99], 0
    buffer_load_dwordx4 v173, s[32:35], s97 offen offset:1024 lds
    v_mfma_f32_16x16x32_bf16 v[68:71], a[196:199], a[64:67], 0
    ds_read_b64_tr_b16 a[206:207], v163 offset:2048
    ds_read_b128 a[68:71], v178 offset:4096
    v_mfma_f32_16x16x32_bf16 v[36:39], a[196:199], a[32:35], 0
    buffer_load_dwordx4 v174, s[32:35], s97 offen offset:2048 lds
    v_mfma_f32_16x16x32_bf16 v[4:7], a[196:199], a[0:3], 0
    s_waitcnt lgkmcnt(5)
    buffer_load_dwordx4 v175, s[32:35], s97 offen offset:3072 lds
    v_mfma_f32_16x16x32_bf16 v[8:11], a[200:203], a[0:3], 0
    ds_read_b128 a[100:103], v178 offset:6144
    ds_read_b64_tr_b16 a[208:209], v164 offset:0
    v_mfma_f32_16x16x32_bf16 v[40:43], a[200:203], a[32:35], 0
    s_add_u32 m0, s31, 135168
    ds_read_b64_tr_b16 a[210:211], v164 offset:2048
    v_mfma_f32_16x16x32_bf16 v[72:75], a[200:203], a[64:67], 0
    buffer_load_dwordx4 v176, s[32:35], s97 offen lds
    v_mfma_f32_16x16x32_bf16 v[104:107], a[200:203], a[96:99], 0
    ds_read_b128 a[132:135], v178 offset:8192
    ds_read_b64_tr_b16 a[212:213], v165 offset:0
    v_mfma_f32_16x16x32_bf16 v[136:139], a[200:203], a[128:131], 0
    s_waitcnt lgkmcnt(6)
    ds_read_b64_tr_b16 a[214:215], v165 offset:2048
    v_mfma_f32_16x16x32_bf16 v[140:143], a[204:207], a[128:131], 0
    s_add_u32 m0, s92, 32768
    ds_read_b64_tr_b16 a[216:217], v166 offset:0
    ds_read_b64_tr_b16 a[218:219], v166 offset:2048
    v_mfma_f32_16x16x32_bf16 v[108:111], a[204:207], a[96:99], 0
    s_mov_b32 s97, 524288
    buffer_load_dwordx4 v168, s[36:39], s97 offen offset:0 lds
    v_mfma_f32_16x16x32_bf16 v[76:79], a[204:207], a[64:67], 0
    v_mfma_f32_16x16x32_bf16 v[44:47], a[204:207], a[32:35], 0
    buffer_load_dwordx4 v169, s[36:39], s97 offen offset:1024 lds
    v_mfma_f32_16x16x32_bf16 v[12:15], a[204:207], a[0:3], 0
    s_waitcnt lgkmcnt(5)
    ds_read_b64_tr_b16 a[220:221], v167 offset:0
    ds_read_b64_tr_b16 a[222:223], v167 offset:2048
    v_mfma_f32_16x16x32_bf16 v[16:19], a[208:211], a[0:3], 0
    v_mfma_f32_16x16x32_bf16 v[48:51], a[208:211], a[32:35], 0
    buffer_load_dwordx4 v170, s[36:39], s97 offen offset:2048 lds
    v_mfma_f32_16x16x32_bf16 v[80:83], a[208:211], a[64:67], 0
    v_mfma_f32_16x16x32_bf16 v[112:115], a[208:211], a[96:99], 0
    v_mfma_f32_16x16x32_bf16 v[144:147], a[208:211], a[128:131], 0
    s_waitcnt lgkmcnt(2)
    buffer_load_dwordx4 v171, s[36:39], s97 offen offset:3072 lds
    v_mfma_f32_16x16x32_bf16 v[148:151], a[212:215], a[128:131], 0
    v_mfma_f32_16x16x32_bf16 v[116:119], a[212:215], a[96:99], 0
    v_mfma_f32_16x16x32_bf16 v[84:87], a[212:215], a[64:67], 0
    s_add_u32 m0, s92, 49152
    v_mfma_f32_16x16x32_bf16 v[52:55], a[212:215], a[32:35], 0
    s_mov_b32 s97, 786432
    buffer_load_dwordx4 v168, s[36:39], s97 offen offset:0 lds
    v_mfma_f32_16x16x32_bf16 v[20:23], a[212:215], a[0:3], 0
    v_mfma_f32_16x16x32_bf16 v[24:27], a[216:219], a[0:3], 0
    buffer_load_dwordx4 v169, s[36:39], s97 offen offset:1024 lds
    v_mfma_f32_16x16x32_bf16 v[56:59], a[216:219], a[32:35], 0
    v_mfma_f32_16x16x32_bf16 v[88:91], a[216:219], a[64:67], 0
    v_mfma_f32_16x16x32_bf16 v[120:123], a[216:219], a[96:99], 0
    buffer_load_dwordx4 v170, s[36:39], s97 offen offset:2048 lds
    v_mfma_f32_16x16x32_bf16 v[152:155], a[216:219], a[128:131], 0
    s_waitcnt lgkmcnt(0)
    v_mfma_f32_16x16x32_bf16 v[156:159], a[220:223], a[128:131], 0
    v_mfma_f32_16x16x32_bf16 v[124:127], a[220:223], a[96:99], 0
    buffer_load_dwordx4 v171, s[36:39], s97 offen offset:3072 lds
    v_mfma_f32_16x16x32_bf16 v[92:95], a[220:223], a[64:67], 0
    v_mfma_f32_16x16x32_bf16 v[60:63], a[220:223], a[32:35], 0
    v_mfma_f32_16x16x32_bf16 v[28:31], a[220:223], a[0:3], 0
    s_waitcnt vmcnt(8)
    s_barrier
    ds_read_b64_tr_b16 a[192:193], v160 offset:16384
    ds_read_b64_tr_b16 a[194:195], v160 offset:18432
    ds_read_b64_tr_b16 a[196:197], v161 offset:16384
    ds_read_b64_tr_b16 a[198:199], v161 offset:18432
    s_waitcnt lgkmcnt(2)
    v_mfma_f32_16x16x32_bf16 v[0:3], a[192:195], a[4:7], v[0:3]
    s_add_u32 m0, s92, 139264
    ds_read_b128 a[8:11], v177 offset:20480
    v_mfma_f32_16x16x32_bf16 v[32:35], a[192:195], a[36:39], v[32:35]
    s_mov_b32 s97, 256
    ds_read_b64_tr_b16 a[200:201], v162 offset:16384
    ds_read_b64_tr_b16 a[202:203], v162 offset:18432
    v_mfma_f32_16x16x32_bf16 v[64:67], a[192:195], a[68:71], v[64:67]
    ds_read_b128 a[40:43], v177 offset:22528
    v_mfma_f32_16x16x32_bf16 v[96:99], a[192:195], a[100:103], v[96:99]
    buffer_load_dwordx4 v172, s[32:35], s97 offen offset:0 lds
    v_mfma_f32_16x16x32_bf16 v[128:131], a[192:195], a[132:135], v[128:131]
    s_waitcnt lgkmcnt(4)
    v_mfma_f32_16x16x32_bf16 v[132:135], a[196:199], a[132:135], v[132:135]
    ds_read_b128 a[72:75], v177 offset:24576
    v_mfma_f32_16x16x32_bf16 v[100:103], a[196:199], a[100:103], v[100:103]
    ds_read_b64_tr_b16 a[204:205], v163 offset:16384
    ds_read_b64_tr_b16 a[206:207], v163 offset:18432
    v_mfma_f32_16x16x32_bf16 v[68:71], a[196:199], a[68:71], v[68:71]
    buffer_load_dwordx4 v173, s[32:35], s97 offen offset:1024 lds
    v_mfma_f32_16x16x32_bf16 v[36:39], a[196:199], a[36:39], v[36:39]
    ds_read_b128 a[104:107], v177 offset:26624
    v_mfma_f32_16x16x32_bf16 v[4:7], a[196:199], a[4:7], v[4:7]
    s_waitcnt lgkmcnt(5)
    buffer_load_dwordx4 v174, s[32:35], s97 offen offset:2048 lds
    v_mfma_f32_16x16x32_bf16 v[8:11], a[200:203], a[4:7], v[8:11]
    ds_read_b128 a[136:139], v177 offset:28672
    ds_read_b64_tr_b16 a[208:209], v164 offset:16384
    v_mfma_f32_16x16x32_bf16 v[40:43], a[200:203], a[36:39], v[40:43]
    ds_read_b64_tr_b16 a[210:211], v164 offset:18432
    v_mfma_f32_16x16x32_bf16 v[72:75], a[200:203], a[68:71], v[72:75]
    ds_read_b128 a[12:15], v178 offset:20480
    v_mfma_f32_16x16x32_bf16 v[104:107], a[200:203], a[100:103], v[104:107]
    buffer_load_dwordx4 v175, s[32:35], s97 offen offset:3072 lds
    v_mfma_f32_16x16x32_bf16 v[136:139], a[200:203], a[132:135], v[136:139]
    s_waitcnt lgkmcnt(5)
    ds_read_b64_tr_b16 a[212:213], v165 offset:16384
    ds_read_b64_tr_b16 a[214:215], v165 offset:18432
    v_mfma_f32_16x16x32_bf16 v[140:143], a[204:207], a[132:135], v[140:143]
    ds_read_b128 a[44:47], v178 offset:22528
    v_mfma_f32_16x16x32_bf16 v[108:111], a[204:207], a[100:103], v[108:111]
    ds_read_b128 a[76:79], v178 offset:24576
    v_mfma_f32_16x16x32_bf16 v[76:79], a[204:207], a[68:71], v[76:79]
    s_add_u32 m0, s31, 155648
    s_nop 0
    buffer_load_dwordx4 v176, s[32:35], s97 offen lds
    v_mfma_f32_16x16x32_bf16 v[44:47], a[204:207], a[36:39], v[44:47]
    ds_read_b64_tr_b16 a[216:217], v166 offset:16384
    ds_read_b64_tr_b16 a[218:219], v166 offset:18432
    v_mfma_f32_16x16x32_bf16 v[12:15], a[204:207], a[4:7], v[12:15]
    s_waitcnt lgkmcnt(7)
    ds_read_b128 a[108:111], v178 offset:26624
    v_mfma_f32_16x16x32_bf16 v[16:19], a[208:211], a[4:7], v[16:19]
    ds_read_b128 a[140:143], v178 offset:28672
    v_mfma_f32_16x16x32_bf16 v[48:51], a[208:211], a[36:39], v[48:51]
    s_add_u32 m0, s92, 0
    ds_read_b64_tr_b16 a[220:221], v167 offset:16384
    v_mfma_f32_16x16x32_bf16 v[80:83], a[208:211], a[68:71], v[80:83]
    s_mov_b32 s97, 1048576
    buffer_load_dwordx4 v168, s[36:39], s97 offen offset:0 lds
    v_mfma_f32_16x16x32_bf16 v[112:115], a[208:211], a[100:103], v[112:115]
    ds_read_b64_tr_b16 a[222:223], v167 offset:18432
    v_mfma_f32_16x16x32_bf16 v[144:147], a[208:211], a[132:135], v[144:147]
    s_waitcnt lgkmcnt(6)
    v_mfma_f32_16x16x32_bf16 v[148:151], a[212:215], a[132:135], v[148:151]
    v_mfma_f32_16x16x32_bf16 v[116:119], a[212:215], a[100:103], v[116:119]
    buffer_load_dwordx4 v169, s[36:39], s97 offen offset:1024 lds
    v_mfma_f32_16x16x32_bf16 v[84:87], a[212:215], a[68:71], v[84:87]
    v_mfma_f32_16x16x32_bf16 v[52:55], a[212:215], a[36:39], v[52:55]
    v_mfma_f32_16x16x32_bf16 v[20:23], a[212:215], a[4:7], v[20:23]
    s_waitcnt lgkmcnt(1)
    v_mfma_f32_16x16x32_bf16 v[24:27], a[216:219], a[4:7], v[24:27]
    buffer_load_dwordx4 v170, s[36:39], s97 offen offset:2048 lds
    v_mfma_f32_16x16x32_bf16 v[56:59], a[216:219], a[36:39], v[56:59]
    v_mfma_f32_16x16x32_bf16 v[88:91], a[216:219], a[68:71], v[88:91]
    v_mfma_f32_16x16x32_bf16 v[120:123], a[216:219], a[100:103], v[120:123]
    v_mfma_f32_16x16x32_bf16 v[152:155], a[216:219], a[132:135], v[152:155]
    s_waitcnt lgkmcnt(0)
    buffer_load_dwordx4 v171, s[36:39], s97 offen offset:3072 lds
    v_mfma_f32_16x16x32_bf16 v[156:159], a[220:223], a[132:135], v[156:159]
    v_mfma_f32_16x16x32_bf16 v[124:127], a[220:223], a[100:103], v[124:127]
    v_mfma_f32_16x16x32_bf16 v[92:95], a[220:223], a[68:71], v[92:95]
    v_mfma_f32_16x16x32_bf16 v[60:63], a[220:223], a[36:39], v[60:63]
    v_mfma_f32_16x16x32_bf16 v[28:31], a[220:223], a[4:7], v[28:31]
    s_waitcnt vmcnt(13)
    s_barrier
    ds_read_b64_tr_b16 a[192:193], v160 offset:32768
    ds_read_b64_tr_b16 a[194:195], v160 offset:34816
    ds_read_b64_tr_b16 a[196:197], v161 offset:32768
    ds_read_b64_tr_b16 a[198:199], v161 offset:34816
    s_waitcnt lgkmcnt(2)
    v_mfma_f32_16x16x32_bf16 v[0:3], a[192:195], a[8:11], v[0:3]
    s_add_u32 m0, s92, 16384
    v_mfma_f32_16x16x32_bf16 v[32:35], a[192:195], a[40:43], v[32:35]
    s_mov_b32 s97, 1310720
    ds_read_b64_tr_b16 a[200:201], v162 offset:32768
    ds_read_b64_tr_b16 a[202:203], v162 offset:34816
    v_mfma_f32_16x16x32_bf16 v[64:67], a[192:195], a[72:75], v[64:67]
    buffer_load_dwordx4 v168, s[36:39], s97 offen offset:0 lds
    v_mfma_f32_16x16x32_bf16 v[96:99], a[192:195], a[104:107], v[96:99]
    ds_read_b64_tr_b16 a[204:205], v163 offset:32768
    ds_read_b64_tr_b16 a[206:207], v163 offset:34816
    v_mfma_f32_16x16x32_bf16 v[128:131], a[192:195], a[136:139], v[128:131]
    s_waitcnt lgkmcnt(4)
    ds_read_b64_tr_b16 a[208:209], v164 offset:32768
    ds_read_b64_tr_b16 a[210:211], v164 offset:34816
    v_mfma_f32_16x16x32_bf16 v[132:135], a[196:199], a[136:139], v[132:135]
    v_mfma_f32_16x16x32_bf16 v[100:103], a[196:199], a[104:107], v[100:103]
    buffer_load_dwordx4 v169, s[36:39], s97 offen offset:1024 lds
    v_mfma_f32_16x16x32_bf16 v[68:71], a[196:199], a[72:75], v[68:71]
    v_mfma_f32_16x16x32_bf16 v[36:39], a[196:199], a[40:43], v[36:39]
    v_mfma_f32_16x16x32_bf16 v[4:7], a[196:199], a[8:11], v[4:7]
    s_waitcnt lgkmcnt(4)
    ds_read_b64_tr_b16 a[212:213], v165 offset:32768
    ds_read_b64_tr_b16 a[214:215], v165 offset:34816
    v_mfma_f32_16x16x32_bf16 v[8:11], a[200:203], a[8:11], v[8:11]
    v_mfma_f32_16x16x32_bf16 v[40:43], a[200:203], a[40:43], v[40:43]
    buffer_load_dwordx4 v170, s[36:39], s97 offen offset:2048 lds
    v_mfma_f32_16x16x32_bf16 v[72:75], a[200:203], a[72:75], v[72:75]
    v_mfma_f32_16x16x32_bf16 v[104:107], a[200:203], a[104:107], v[104:107]
    v_mfma_f32_16x16x32_bf16 v[136:139], a[200:203], a[136:139], v[136:139]
    s_waitcnt lgkmcnt(2)
    ds_read_b64_tr_b16 a[216:217], v166 offset:32768
    ds_read_b64_tr_b16 a[218:219], v166 offset:34816
    v_mfma_f32_16x16x32_bf16 v[140:143], a[204:207], a[136:139], v[140:143]
    v_mfma_f32_16x16x32_bf16 v[108:111], a[204:207], a[104:107], v[108:111]
    buffer_load_dwordx4 v171, s[36:39], s97 offen offset:3072 lds
    v_mfma_f32_16x16x32_bf16 v[76:79], a[204:207], a[72:75], v[76:79]
    v_mfma_f32_16x16x32_bf16 v[44:47], a[204:207], a[40:43], v[44:47]
    v_mfma_f32_16x16x32_bf16 v[12:15], a[204:207], a[8:11], v[12:15]
    ds_read_b64_tr_b16 a[220:221], v167 offset:32768
    ds_read_b64_tr_b16 a[222:223], v167 offset:34816
    v_mfma_f32_16x16x32_bf16 v[16:19], a[208:211], a[8:11], v[16:19]
    v_mfma_f32_16x16x32_bf16 v[48:51], a[208:211], a[40:43], v[48:51]
    v_mfma_f32_16x16x32_bf16 v[80:83], a[208:211], a[72:75], v[80:83]
    s_add_u32 m0, s92, 98304
    v_mfma_f32_16x16x32_bf16 v[112:115], a[208:211], a[104:107], v[112:115]
    s_mov_b32 s97, 384
    buffer_load_dwordx4 v172, s[32:35], s97 offen offset:0 lds
    v_mfma_f32_16x16x32_bf16 v[144:147], a[208:211], a[136:139], v[144:147]
    s_waitcnt lgkmcnt(2)
    v_mfma_f32_16x16x32_bf16 v[148:151], a[212:215], a[136:139], v[148:151]
    v_mfma_f32_16x16x32_bf16 v[116:119], a[212:215], a[104:107], v[116:119]
    v_mfma_f32_16x16x32_bf16 v[84:87], a[212:215], a[72:75], v[84:87]
    v_mfma_f32_16x16x32_bf16 v[52:55], a[212:215], a[40:43], v[52:55]
    buffer_load_dwordx4 v173, s[32:35], s97 offen offset:1024 lds
    v_mfma_f32_16x16x32_bf16 v[20:23], a[212:215], a[8:11], v[20:23]
    v_mfma_f32_16x16x32_bf16 v[24:27], a[216:219], a[8:11], v[24:27]
    v_mfma_f32_16x16x32_bf16 v[56:59], a[216:219], a[40:43], v[56:59]
    v_mfma_f32_16x16x32_bf16 v[88:91], a[216:219], a[72:75], v[88:91]
    v_mfma_f32_16x16x32_bf16 v[120:123], a[216:219], a[104:107], v[120:123]
    buffer_load_dwordx4 v174, s[32:35], s97 offen offset:2048 lds
    v_mfma_f32_16x16x32_bf16 v[152:155], a[216:219], a[136:139], v[152:155]
    s_waitcnt lgkmcnt(0)
    v_mfma_f32_16x16x32_bf16 v[156:159], a[220:223], a[136:139], v[156:159]
    v_mfma_f32_16x16x32_bf16 v[124:127], a[220:223], a[104:107], v[124:127]
    v_mfma_f32_16x16x32_bf16 v[92:95], a[220:223], a[72:75], v[92:95]
    v_mfma_f32_16x16x32_bf16 v[60:63], a[220:223], a[40:43], v[60:63]
    v_mfma_f32_16x16x32_bf16 v[28:31], a[220:223], a[8:11], v[28:31]
    s_lshl_b32 s85, s89, s85
    s_add_u32 s84, s84, s85
    s_lshl_b32 s84, s84, 19
    s_add_u32 s40, s40, s84
    s_addc_u32 s41, s41, 0
    s_and_b32 s41, s41, 0xffff
    s_mov_b32 s42, 524288
    s_mov_b32 s43, 0x20000
    s_add_u32 s44, s44, s84
    s_addc_u32 s45, s45, 0
    s_and_b32 s45, s45, 0xffff
    s_mov_b32 s46, 524288
    s_mov_b32 s47, 0x20000
    s_mul_i32 s91, s87, 229376
    s_add_u32 s48, s48, s91
    s_addc_u32 s49, s49, 0
    s_and_b32 s49, s49, 0xffff
    s_mov_b32 s50, 229376
    s_mov_b32 s51, 0x20000
    s_lshl_b32 s91, s88, 3
    s_add_u32 s14, s91, s89
    s_mov_b32 s15, s87
    s_lshl_b32 s91, s14, 4
    s_add_u32 s91, s91, s87
    s_mul_i32 s91, s91, 143360
    s_add_u32 s52, s28, s91
    s_addc_u32 s53, s29, 0
    s_and_b32 s53, s53, 0xffff
    s_mov_b32 s54, 143360
    s_mov_b32 s55, 0x20000
    s_lshl_b32 s91, s14, 12
    s_add_u32 s91, s91, 67108864
    s_add_u32 s16, s28, s91
    s_addc_u32 s17, s29, 0
    s_and_b32 s17, s17, 0xffff
    s_mov_b32 s18, 256
    s_mov_b32 s19, 0x20000
    s_lshl_b32 s91, s14, 4
    s_add_u32 s20, s26, s91
    s_addc_u32 s21, s27, 0
    s_and_b32 s21, s21, 0xffff
    s_mov_b32 s22, 4
    s_mov_b32 s23, 0x20000
    s_lshl_b32 s91, s87, 2
    v_lshlrev_b32 v252, 7, v182
    v_add_u32 v252, s92, v252
    v_mov_b32 v253, 0
    buffer_store_dword v253, v252, s[16:19], s91 offen sc1
    s_mov_b32 s93, 0
    s_mov_b32 s94, 0
    s_mov_b32 s96, 0
    s_mov_b32 s98, 1035512379
    s_mov_b32 s99, 3182996027
    s_lshl_b32 s90, s10, 3
    v_xor_b32 v252, v184, v183
    v_xor_b32 v252, s90, v252
    s_waitcnt vmcnt(12)
    s_barrier
    ds_read_b64_tr_b16 a[192:193], v160 offset:49152
    ds_read_b64_tr_b16 a[194:195], v160 offset:51200
    ds_read_b64_tr_b16 a[196:197], v161 offset:49152
    ds_read_b64_tr_b16 a[198:199], v161 offset:51200
    s_waitcnt lgkmcnt(2)
    v_mfma_f32_16x16x32_bf16 v[0:3], a[192:195], a[12:15], v[0:3]
    s_add_u32 m0, s92, 98304
    ds_read_b128 a[16:19], v177 offset:40960
    v_mfma_f32_16x16x32_bf16 v[32:35], a[192:195], a[44:47], v[32:35]
    s_mov_b32 s97, 384
    ds_read_b64_tr_b16 a[200:201], v162 offset:49152
    ds_read_b64_tr_b16 a[202:203], v162 offset:51200
    v_mfma_f32_16x16x32_bf16 v[64:67], a[192:195], a[76:79], v[64:67]
    ds_read_b128 a[48:51], v177 offset:43008
    v_mfma_f32_16x16x32_bf16 v[96:99], a[192:195], a[108:111], v[96:99]
    buffer_load_dwordx4 v175, s[32:35], s97 offen offset:3072 lds
    v_mfma_f32_16x16x32_bf16 v[128:131], a[192:195], a[140:143], v[128:131]
    s_waitcnt lgkmcnt(4)
    v_mfma_f32_16x16x32_bf16 v[132:135], a[196:199], a[140:143], v[132:135]
    ds_read_b128 a[80:83], v177 offset:45056
    v_mfma_f32_16x16x32_bf16 v[100:103], a[196:199], a[108:111], v[100:103]
    ds_read_b64_tr_b16 a[204:205], v163 offset:49152
    ds_read_b64_tr_b16 a[206:207], v163 offset:51200
    v_mfma_f32_16x16x32_bf16 v[68:71], a[196:199], a[76:79], v[68:71]
    s_add_u32 m0, s31, 114688
    v_mfma_f32_16x16x32_bf16 v[36:39], a[196:199], a[44:47], v[36:39]
    ds_read_b128 a[112:115], v177 offset:47104
    v_mfma_f32_16x16x32_bf16 v[4:7], a[196:199], a[12:15], v[4:7]
    s_waitcnt lgkmcnt(5)
    buffer_load_dwordx4 v176, s[32:35], s97 offen lds
    v_mfma_f32_16x16x32_bf16 v[8:11], a[200:203], a[12:15], v[8:11]
    ds_read_b128 a[144:147], v177 offset:49152
    ds_read_b64_tr_b16 a[208:209], v164 offset:49152
    v_mfma_f32_16x16x32_bf16 v[40:43], a[200:203], a[44:47], v[40:43]
    ds_read_b64_tr_b16 a[210:211], v164 offset:51200
    v_mfma_f32_16x16x32_bf16 v[72:75], a[200:203], a[76:79], v[72:75]
    ds_read_b128 a[20:23], v178 offset:40960
    v_mfma_f32_16x16x32_bf16 v[104:107], a[200:203], a[108:111], v[104:107]
    s_add_u32 m0, s92, 32768
    ds_read_b64_tr_b16 a[212:213], v165 offset:49152
    v_mfma_f32_16x16x32_bf16 v[136:139], a[200:203], a[140:143], v[136:139]
    s_waitcnt lgkmcnt(6)
    ds_read_b64_tr_b16 a[214:215], v165 offset:51200
    v_mfma_f32_16x16x32_bf16 v[140:143], a[204:207], a[140:143], v[140:143]
    s_mov_b32 s97, 1572864
    buffer_load_dwordx4 v168, s[36:39], s97 offen offset:0 lds
    v_mfma_f32_16x16x32_bf16 v[108:111], a[204:207], a[108:111], v[108:111]
    ds_read_b128 a[52:55], v178 offset:43008
    v_mfma_f32_16x16x32_bf16 v[76:79], a[204:207], a[76:79], v[76:79]
    ds_read_b128 a[84:87], v178 offset:45056
    v_mfma_f32_16x16x32_bf16 v[44:47], a[204:207], a[44:47], v[44:47]
    ds_read_b64_tr_b16 a[216:217], v166 offset:49152
    ds_read_b64_tr_b16 a[218:219], v166 offset:51200
    v_mfma_f32_16x16x32_bf16 v[12:15], a[204:207], a[12:15], v[12:15]
    s_waitcnt lgkmcnt(7)
    v_mfma_f32_16x16x32_bf16 v[16:19], a[208:211], a[12:15], v[16:19]
    ds_read_b128 a[116:119], v178 offset:47104
    v_mfma_f32_16x16x32_bf16 v[48:51], a[208:211], a[44:47], v[48:51]
    buffer_load_dwordx4 v169, s[36:39], s97 offen offset:1024 lds
    v_mfma_f32_16x16x32_bf16 v[80:83], a[208:211], a[76:79], v[80:83]
    ds_read_b128 a[148:151], v178 offset:49152
    ds_read_b64_tr_b16 a[220:221], v167 offset:49152
    v_mfma_f32_16x16x32_bf16 v[112:115], a[208:211], a[108:111], v[112:115]
    ds_read_b64_tr_b16 a[222:223], v167 offset:51200
    v_mfma_f32_16x16x32_bf16 v[144:147], a[208:211], a[140:143], v[144:147]
    s_waitcnt lgkmcnt(7)
    v_mfma_f32_16x16x32_bf16 v[148:151], a[212:215], a[140:143], v[148:151]
    v_mfma_f32_16x16x32_bf16 v[116:119], a[212:215], a[108:111], v[116:119]
    v_mfma_f32_16x16x32_bf16 v[84:87], a[212:215], a[76:79], v[84:87]
    buffer_load_dwordx4 v170, s[36:39], s97 offen offset:2048 lds
    v_mfma_f32_16x16x32_bf16 v[52:55], a[212:215], a[44:47], v[52:55]
    v_mfma_f32_16x16x32_bf16 v[20:23], a[212:215], a[12:15], v[20:23]
    s_waitcnt lgkmcnt(3)
    v_mfma_f32_16x16x32_bf16 v[24:27], a[216:219], a[12:15], v[24:27]
    v_mfma_f32_16x16x32_bf16 v[56:59], a[216:219], a[44:47], v[56:59]
    v_mfma_f32_16x16x32_bf16 v[88:91], a[216:219], a[76:79], v[88:91]
    v_mfma_f32_16x16x32_bf16 v[120:123], a[216:219], a[108:111], v[120:123]
    buffer_load_dwordx4 v171, s[36:39], s97 offen offset:3072 lds
    v_mfma_f32_16x16x32_bf16 v[152:155], a[216:219], a[140:143], v[152:155]
    s_waitcnt lgkmcnt(0)
    v_mfma_f32_16x16x32_bf16 v[156:159], a[220:223], a[140:143], v[156:159]
    v_mfma_f32_16x16x32_bf16 v[124:127], a[220:223], a[108:111], v[124:127]
    v_mfma_f32_16x16x32_bf16 v[92:95], a[220:223], a[76:79], v[92:95]
    v_mfma_f32_16x16x32_bf16 v[60:63], a[220:223], a[44:47], v[60:63]
    v_mfma_f32_16x16x32_bf16 v[28:31], a[220:223], a[12:15], v[28:31]
    v_lshlrev_b32 v252, 4, v252
    v_lshl_add_u32 v252, v184, 9, v252
    v_add_u32 v212, s92, v252
    v_xor_b32 v213, 32, v212
    v_xor_b32 v214, 64, v212
    v_xor_b32 v215, 96, v212
    v_lshlrev_b32 v252, 1, v184
    v_xor_b32 v252, v252, v183
    v_lshlrev_b32 v252, 4, v252
    v_lshl_add_u32 v252, v184, 9, v252
    v_add_u32 v216, s92, v252
    v_xor_b32 v217, 64, v216
    v_xor_b32 v218, 128, v216
    v_xor_b32 v219, 192, v216
    s_lshl_b32 s90, s89, 2
    s_add_u32 s90, s90, s30
    s_mul_i32 s9, s90, 7168
    s_mul_i32 s90, s11, 10
    s_add_u32 s90, s90, s10
    s_lshl_b32 s4, s90, 10
    v_lshrrev_b32 v252, 2, v182
    v_lshl_add_u32 v204, v252, 9, v251
    v_xor_b32 v205, 32, v204
    v_xor_b32 v206, 64, v204
    v_xor_b32 v207, 96, v204
    v_xor_b32 v208, 128, v204
    v_xor_b32 v209, 160, v204
    v_xor_b32 v210, 192, v204
    v_xor_b32 v211, 224, v204
    v_xor_b32 v252, v186, v185
    v_lshlrev_b32 v252, 4, v252
    v_lshl_add_u32 v252, v185, 9, v252
    s_mul_i32 s90, s10, 8448
    s_add_u32 s90, s90, 65536
    v_add_u32 v200, s90, v252
    v_xor_b32 v201, 64, v200
    v_xor_b32 v202, 128, v200
    v_xor_b32 v203, 192, v200
    v_xor_b32 v245, 256, v200
    v_xor_b32 v246, 320, v200
    s_waitcnt vmcnt(14)
    s_barrier
    ds_read_b64_tr_b16 a[192:193], v160 offset:0
    ds_read_b64_tr_b16 a[194:195], v160 offset:2048
    ds_read_b64_tr_b16 a[196:197], v161 offset:0
    ds_read_b64_tr_b16 a[198:199], v161 offset:2048
    s_waitcnt lgkmcnt(2)
    v_mfma_f32_16x16x32_bf16 v[0:3], a[192:195], a[16:19], v[0:3]
    s_add_u32 m0, s92, 49152
    v_mfma_f32_16x16x32_bf16 v[32:35], a[192:195], a[48:51], v[32:35]
    s_mov_b32 s97, 1835008
    ds_read_b64_tr_b16 a[200:201], v162 offset:0
    ds_read_b64_tr_b16 a[202:203], v162 offset:2048
    v_mfma_f32_16x16x32_bf16 v[64:67], a[192:195], a[80:83], v[64:67]
    buffer_load_dwordx4 v168, s[36:39], s97 offen offset:0 lds
    v_mfma_f32_16x16x32_bf16 v[96:99], a[192:195], a[112:115], v[96:99]
    ds_read_b64_tr_b16 a[204:205], v163 offset:0
    ds_read_b64_tr_b16 a[206:207], v163 offset:2048
    v_mfma_f32_16x16x32_bf16 v[128:131], a[192:195], a[144:147], v[128:131]
    s_waitcnt lgkmcnt(4)
    ds_read_b64_tr_b16 a[208:209], v164 offset:0
    ds_read_b64_tr_b16 a[210:211], v164 offset:2048
    v_mfma_f32_16x16x32_bf16 v[132:135], a[196:199], a[144:147], v[132:135]
    v_mfma_f32_16x16x32_bf16 v[100:103], a[196:199], a[112:115], v[100:103]
    buffer_load_dwordx4 v169, s[36:39], s97 offen offset:1024 lds
    v_mfma_f32_16x16x32_bf16 v[68:71], a[196:199], a[80:83], v[68:71]
    v_mfma_f32_16x16x32_bf16 v[36:39], a[196:199], a[48:51], v[36:39]
    v_mfma_f32_16x16x32_bf16 v[4:7], a[196:199], a[16:19], v[4:7]
    s_waitcnt lgkmcnt(4)
    ds_read_b64_tr_b16 a[212:213], v165 offset:0
    ds_read_b64_tr_b16 a[214:215], v165 offset:2048
    v_mfma_f32_16x16x32_bf16 v[8:11], a[200:203], a[16:19], v[8:11]
    v_mfma_f32_16x16x32_bf16 v[40:43], a[200:203], a[48:51], v[40:43]
    buffer_load_dwordx4 v170, s[36:39], s97 offen offset:2048 lds
    v_mfma_f32_16x16x32_bf16 v[72:75], a[200:203], a[80:83], v[72:75]
    v_mfma_f32_16x16x32_bf16 v[104:107], a[200:203], a[112:115], v[104:107]
    v_mfma_f32_16x16x32_bf16 v[136:139], a[200:203], a[144:147], v[136:139]
    s_waitcnt lgkmcnt(2)
    ds_read_b64_tr_b16 a[216:217], v166 offset:0
    ds_read_b64_tr_b16 a[218:219], v166 offset:2048
    v_mfma_f32_16x16x32_bf16 v[140:143], a[204:207], a[144:147], v[140:143]
    v_mfma_f32_16x16x32_bf16 v[108:111], a[204:207], a[112:115], v[108:111]
    buffer_load_dwordx4 v171, s[36:39], s97 offen offset:3072 lds
    v_mfma_f32_16x16x32_bf16 v[76:79], a[204:207], a[80:83], v[76:79]
    v_mfma_f32_16x16x32_bf16 v[44:47], a[204:207], a[48:51], v[44:47]
    v_mfma_f32_16x16x32_bf16 v[12:15], a[204:207], a[16:19], v[12:15]
    ds_read_b64_tr_b16 a[220:221], v167 offset:0
    ds_read_b64_tr_b16 a[222:223], v167 offset:2048
    v_mfma_f32_16x16x32_bf16 v[16:19], a[208:211], a[16:19], v[16:19]
    v_mfma_f32_16x16x32_bf16 v[48:51], a[208:211], a[48:51], v[48:51]
    v_mfma_f32_16x16x32_bf16 v[80:83], a[208:211], a[80:83], v[80:83]
    s_add_u32 m0, s92, 118784
    v_mfma_f32_16x16x32_bf16 v[112:115], a[208:211], a[112:115], v[112:115]
    s_mov_b32 s97, 512
    buffer_load_dwordx4 v172, s[32:35], s97 offen offset:0 lds
    v_mfma_f32_16x16x32_bf16 v[144:147], a[208:211], a[144:147], v[144:147]
    s_waitcnt lgkmcnt(2)
    v_mfma_f32_16x16x32_bf16 v[148:151], a[212:215], a[144:147], v[148:151]
    v_mfma_f32_16x16x32_bf16 v[116:119], a[212:215], a[112:115], v[116:119]
    v_mfma_f32_16x16x32_bf16 v[84:87], a[212:215], a[80:83], v[84:87]
    v_mfma_f32_16x16x32_bf16 v[52:55], a[212:215], a[48:51], v[52:55]
    buffer_load_dwordx4 v173, s[32:35], s97 offen offset:1024 lds
    v_mfma_f32_16x16x32_bf16 v[20:23], a[212:215], a[16:19], v[20:23]
    v_mfma_f32_16x16x32_bf16 v[24:27], a[216:219], a[16:19], v[24:27]
    v_mfma_f32_16x16x32_bf16 v[56:59], a[216:219], a[48:51], v[56:59]
    v_mfma_f32_16x16x32_bf16 v[88:91], a[216:219], a[80:83], v[88:91]
    v_mfma_f32_16x16x32_bf16 v[120:123], a[216:219], a[112:115], v[120:123]
    buffer_load_dwordx4 v174, s[32:35], s97 offen offset:2048 lds
    v_mfma_f32_16x16x32_bf16 v[152:155], a[216:219], a[144:147], v[152:155]
    s_waitcnt lgkmcnt(0)
    v_mfma_f32_16x16x32_bf16 v[156:159], a[220:223], a[144:147], v[156:159]
    v_mfma_f32_16x16x32_bf16 v[124:127], a[220:223], a[112:115], v[124:127]
    v_mfma_f32_16x16x32_bf16 v[92:95], a[220:223], a[80:83], v[92:95]
    v_mfma_f32_16x16x32_bf16 v[60:63], a[220:223], a[48:51], v[60:63]
    v_mfma_f32_16x16x32_bf16 v[28:31], a[220:223], a[16:19], v[28:31]
    v_xor_b32 v247, 384, v200
    v_xor_b32 v248, 448, v200
    v_lshrrev_b32 v252, 3, v182
    v_mul_u32_u24 v252, 896, v252
    v_lshlrev_b32 v253, 1, v186
    v_xor_b32 v253, v253, v182
    v_and_b32 v253, 7, v253
    v_lshl_add_u32 v252, v253, 4, v252
    s_mul_i32 s90, s30, 28672
    v_add_u32 v223, s90, v252
    v_bfe_u32 v252, v182, 3, 2
    s_lshl_b32 s90, s10, 1
    v_xor_b32 v252, s90, v252
    v_lshl_add_u32 v252, v252, 5, v187
    v_lshrrev_b32 v253, 2, v182
    v_lshl_add_u32 v238, v253, 7, v252
    v_xor_b32 v239, 32, v238
    v_lshlrev_b32 v222, 4, v182
    s_mul_i32 s90, s11, 5120
    s_add_u32 s90, s90, 139264
    v_add_u32 v221, s90, v222
    s_lshl_b32 s90, s10, 3
    v_add_u32 v220, s90, v221
    s_mul_i32 s90, s11, 1280
    s_add_u32 s90, s90, 159744
    v_lshl_add_u32 v225, v185, 4, s90
    v_and_b32 v252, 1, v186
    v_lshl_add_u32 v253, v252, 2, v225
    s_lshl_b32 s90, s10, 3
    v_add_u32 v224, s90, v253
    s_waitcnt vmcnt(11)
    s_barrier
    ds_read_b64_tr_b16 a[192:193], v160 offset:16384
    ds_read_b64_tr_b16 a[194:195], v160 offset:18432
    ds_read_b64_tr_b16 a[196:197], v161 offset:16384
    ds_read_b64_tr_b16 a[198:199], v161 offset:18432
    s_waitcnt lgkmcnt(2)
    v_mfma_f32_16x16x32_bf16 v[0:3], a[192:195], a[20:23], v[0:3]
    s_add_u32 m0, s92, 118784
    ds_read_b128 a[24:27], v177 offset:0
    v_mfma_f32_16x16x32_bf16 v[32:35], a[192:195], a[52:55], v[32:35]
    s_mov_b32 s97, 512
    ds_read_b64_tr_b16 a[200:201], v162 offset:16384
    ds_read_b64_tr_b16 a[202:203], v162 offset:18432
    v_mfma_f32_16x16x32_bf16 v[64:67], a[192:195], a[84:87], v[64:67]
    ds_read_b128 a[56:59], v177 offset:2048
    v_mfma_f32_16x16x32_bf16 v[96:99], a[192:195], a[116:119], v[96:99]
    buffer_load_dwordx4 v175, s[32:35], s97 offen offset:3072 lds
    v_mfma_f32_16x16x32_bf16 v[128:131], a[192:195], a[148:151], v[128:131]
    s_waitcnt lgkmcnt(4)
    v_mfma_f32_16x16x32_bf16 v[132:135], a[196:199], a[148:151], v[132:135]
    ds_read_b128 a[88:91], v177 offset:4096
    v_mfma_f32_16x16x32_bf16 v[100:103], a[196:199], a[116:119], v[100:103]
L_pg1:
    s_cbranch_execz L_pg5
    ds_read_b64_tr_b16 a[204:205], v163 offset:16384
    ds_read_b64_tr_b16 a[206:207], v163 offset:18432
    v_mfma_f32_16x16x32_bf16 v[68:71], a[196:199], a[84:87], v[68:71]
    s_add_u32 m0, s31, 135168
    v_mfma_f32_16x16x32_bf16 v[36:39], a[196:199], a[52:55], v[36:39]
    ds_read_b128 a[120:123], v177 offset:6144
    v_mfma_f32_16x16x32_bf16 v[4:7], a[196:199], a[20:23], v[4:7]
    s_waitcnt lgkmcnt(5)
    buffer_load_dwordx4 v176, s[32:35], s97 offen lds
    v_mfma_f32_16x16x32_bf16 v[8:11], a[200:203], a[20:23], v[8:11]
    ds_read_b128 a[152:155], v177 offset:8192
    ds_read_b64_tr_b16 a[208:209], v164 offset:16384
    v_mfma_f32_16x16x32_bf16 v[40:43], a[200:203], a[52:55], v[40:43]
    ds_read_b64_tr_b16 a[210:211], v164 offset:18432
    v_mfma_f32_16x16x32_bf16 v[72:75], a[200:203], a[84:87], v[72:75]
    ds_read_b128 a[28:31], v178 offset:0
    v_mfma_f32_16x16x32_bf16 v[104:107], a[200:203], a[116:119], v[104:107]
    s_add_u32 m0, s92, 0
    ds_read_b64_tr_b16 a[212:213], v165 offset:16384
    v_mfma_f32_16x16x32_bf16 v[136:139], a[200:203], a[148:151], v[136:139]
    s_waitcnt lgkmcnt(6)
    ds_read_b64_tr_b16 a[214:215], v165 offset:18432
    v_mfma_f32_16x16x32_bf16 v[140:143], a[204:207], a[148:151], v[140:143]
    s_mov_b32 s97, 2097152
    buffer_load_dwordx4 v168, s[36:39], s97 offen offset:0 lds
    v_mfma_f32_16x16x32_bf16 v[108:111], a[204:207], a[116:119], v[108:111]
    ds_read_b128 a[60:63], v178 offset:2048
    v_mfma_f32_16x16x32_bf16 v[76:79], a[204:207], a[84:87], v[76:79]
    ds_read_b128 a[92:95], v178 offset:4096
    v_mfma_f32_16x16x32_bf16 v[44:47], a[204:207], a[52:55], v[44:47]
    ds_read_b64_tr_b16 a[216:217], v166 offset:16384
    ds_read_b64_tr_b16 a[218:219], v166 offset:18432
    v_mfma_f32_16x16x32_bf16 v[12:15], a[204:207], a[20:23], v[12:15]
    s_waitcnt lgkmcnt(7)
    v_mfma_f32_16x16x32_bf16 v[16:19], a[208:211], a[20:23], v[16:19]
    ds_read_b128 a[124:127], v178 offset:6144
    v_mfma_f32_16x16x32_bf16 v[48:51], a[208:211], a[52:55], v[48:51]
    buffer_load_dwordx4 v169, s[36:39], s97 offen offset:1024 lds
    v_mfma_f32_16x16x32_bf16 v[80:83], a[208:211], a[84:87], v[80:83]
    ds_read_b128 a[156:159], v178 offset:8192
    ds_read_b64_tr_b16 a[220:221], v167 offset:16384
    v_mfma_f32_16x16x32_bf16 v[112:115], a[208:211], a[116:119], v[112:115]
    ds_read_b64_tr_b16 a[222:223], v167 offset:18432
    v_mfma_f32_16x16x32_bf16 v[144:147], a[208:211], a[148:151], v[144:147]
    s_waitcnt lgkmcnt(7)
    v_mfma_f32_16x16x32_bf16 v[148:151], a[212:215], a[148:151], v[148:151]
    v_mfma_f32_16x16x32_bf16 v[116:119], a[212:215], a[116:119], v[116:119]
    v_mfma_f32_16x16x32_bf16 v[84:87], a[212:215], a[84:87], v[84:87]
    buffer_load_dwordx4 v170, s[36:39], s97 offen offset:2048 lds
    v_mfma_f32_16x16x32_bf16 v[52:55], a[212:215], a[52:55], v[52:55]
    v_mfma_f32_16x16x32_bf16 v[20:23], a[212:215], a[20:23], v[20:23]
    s_waitcnt lgkmcnt(3)
    v_mfma_f32_16x16x32_bf16 v[24:27], a[216:219], a[20:23], v[24:27]
    v_mfma_f32_16x16x32_bf16 v[56:59], a[216:219], a[52:55], v[56:59]
    v_mfma_f32_16x16x32_bf16 v[88:91], a[216:219], a[84:87], v[88:91]
    v_mfma_f32_16x16x32_bf16 v[120:123], a[216:219], a[116:119], v[120:123]
    buffer_load_dwordx4 v171, s[36:39], s97 offen offset:3072 lds
    v_mfma_f32_16x16x32_bf16 v[152:155], a[216:219], a[148:151], v[152:155]
    s_waitcnt lgkmcnt(0)
    v_mfma_f32_16x16x32_bf16 v[156:159], a[220:223], a[148:151], v[156:159]
    v_mfma_f32_16x16x32_bf16 v[124:127], a[220:223], a[116:119], v[124:127]
    v_mfma_f32_16x16x32_bf16 v[92:95], a[220:223], a[84:87], v[92:95]
    v_mfma_f32_16x16x32_bf16 v[60:63], a[220:223], a[52:55], v[60:63]
    v_mfma_f32_16x16x32_bf16 v[28:31], a[220:223], a[20:23], v[28:31]
    v_add_u32 v227, 162304, v222
    s_lshl_b32 s90, s30, 2
    v_add_u32 v226, s90, v227
    s_mul_i32 s90, s11, 98304
    s_mul_i32 s91, s10, 20480
    s_add_u32 s85, s90, s91
    v_add_u32 v228, s85, v222
    s_sub_u32 s91, 20480, s91
    s_add_u32 s85, s90, s91
    v_add_u32 v229, s85, v222
    s_cmp_eq_u32 s11, 0
    s_cselect_b32 s90, 32768, s96
    s_cselect_b32 s91, 98304, s96
    s_cmp_eq_u32 s11, 1
    s_cselect_b32 s90, 118784, s90
    s_cselect_b32 s91, 139264, s91
    s_cmp_eq_u32 s10, 0
    s_cselect_b32 s85, s91, s90
    s_cselect_b32 s90, s90, s91
    v_add_u32 v180, s90, v222
    v_add_u32 v181, s85, v222
    v_lshlrev_b32 v253, 4, v185
    v_lshl_add_u32 v253, v184, 8, v253
    v_lshl_add_u32 v253, v252, 3, v253
    v_add_u32 v179, s90, v253
    s_waitcnt vmcnt(13)
    s_barrier
    ds_read_b64_tr_b16 a[192:193], v160 offset:32768
    ds_read_b64_tr_b16 a[194:195], v160 offset:34816
    ds_read_b64_tr_b16 a[196:197], v161 offset:32768
    ds_read_b64_tr_b16 a[198:199], v161 offset:34816
    s_waitcnt lgkmcnt(2)
    v_mfma_f32_16x16x32_bf16 v[0:3], a[192:195], a[24:27], v[0:3]
    s_add_u32 m0, s92, 16384
    v_mfma_f32_16x16x32_bf16 v[32:35], a[192:195], a[56:59], v[32:35]
    s_mov_b32 s97, 2359296
    ds_read_b64_tr_b16 a[200:201], v162 offset:32768
    ds_read_b64_tr_b16 a[202:203], v162 offset:34816
    v_mfma_f32_16x16x32_bf16 v[64:67], a[192:195], a[88:91], v[64:67]
    buffer_load_dwordx4 v168, s[36:39], s97 offen offset:0 lds
    v_mfma_f32_16x16x32_bf16 v[96:99], a[192:195], a[120:123], v[96:99]
    ds_read_b64_tr_b16 a[204:205], v163 offset:32768
    ds_read_b64_tr_b16 a[206:207], v163 offset:34816
    v_mfma_f32_16x16x32_bf16 v[128:131], a[192:195], a[152:155], v[128:131]
    s_waitcnt lgkmcnt(4)
    ds_read_b64_tr_b16 a[208:209], v164 offset:32768
    ds_read_b64_tr_b16 a[210:211], v164 offset:34816
    v_mfma_f32_16x16x32_bf16 v[132:135], a[196:199], a[152:155], v[132:135]
    v_mfma_f32_16x16x32_bf16 v[100:103], a[196:199], a[120:123], v[100:103]
    buffer_load_dwordx4 v169, s[36:39], s97 offen offset:1024 lds
    v_mfma_f32_16x16x32_bf16 v[68:71], a[196:199], a[88:91], v[68:71]
    v_mfma_f32_16x16x32_bf16 v[36:39], a[196:199], a[56:59], v[36:39]
    v_mfma_f32_16x16x32_bf16 v[4:7], a[196:199], a[24:27], v[4:7]
    s_waitcnt lgkmcnt(4)
    ds_read_b64_tr_b16 a[212:213], v165 offset:32768
    ds_read_b64_tr_b16 a[214:215], v165 offset:34816
    v_mfma_f32_16x16x32_bf16 v[8:11], a[200:203], a[24:27], v[8:11]
    v_mfma_f32_16x16x32_bf16 v[40:43], a[200:203], a[56:59], v[40:43]
    buffer_load_dwordx4 v170, s[36:39], s97 offen offset:2048 lds
    v_mfma_f32_16x16x32_bf16 v[72:75], a[200:203], a[88:91], v[72:75]
    v_mfma_f32_16x16x32_bf16 v[104:107], a[200:203], a[120:123], v[104:107]
    v_mfma_f32_16x16x32_bf16 v[136:139], a[200:203], a[152:155], v[136:139]
    s_waitcnt lgkmcnt(2)
    ds_read_b64_tr_b16 a[216:217], v166 offset:32768
    ds_read_b64_tr_b16 a[218:219], v166 offset:34816
    v_mfma_f32_16x16x32_bf16 v[140:143], a[204:207], a[152:155], v[140:143]
    v_mfma_f32_16x16x32_bf16 v[108:111], a[204:207], a[120:123], v[108:111]
    buffer_load_dwordx4 v171, s[36:39], s97 offen offset:3072 lds
    v_mfma_f32_16x16x32_bf16 v[76:79], a[204:207], a[88:91], v[76:79]
    v_mfma_f32_16x16x32_bf16 v[44:47], a[204:207], a[56:59], v[44:47]
    v_mfma_f32_16x16x32_bf16 v[12:15], a[204:207], a[24:27], v[12:15]
    ds_read_b64_tr_b16 a[220:221], v167 offset:32768
    ds_read_b64_tr_b16 a[222:223], v167 offset:34816
    v_mfma_f32_16x16x32_bf16 v[16:19], a[208:211], a[24:27], v[16:19]
    v_mfma_f32_16x16x32_bf16 v[48:51], a[208:211], a[56:59], v[48:51]
    v_mfma_f32_16x16x32_bf16 v[80:83], a[208:211], a[88:91], v[80:83]
    s_add_u32 m0, s92, 139264
    v_mfma_f32_16x16x32_bf16 v[112:115], a[208:211], a[120:123], v[112:115]
    s_mov_b32 s97, 640
    buffer_load_dwordx4 v172, s[32:35], s97 offen offset:0 lds
    v_mfma_f32_16x16x32_bf16 v[144:147], a[208:211], a[152:155], v[144:147]
    s_waitcnt lgkmcnt(2)
    v_mfma_f32_16x16x32_bf16 v[148:151], a[212:215], a[152:155], v[148:151]
    v_mfma_f32_16x16x32_bf16 v[116:119], a[212:215], a[120:123], v[116:119]
    v_mfma_f32_16x16x32_bf16 v[84:87], a[212:215], a[88:91], v[84:87]
    v_mfma_f32_16x16x32_bf16 v[52:55], a[212:215], a[56:59], v[52:55]
    buffer_load_dwordx4 v173, s[32:35], s97 offen offset:1024 lds
    v_mfma_f32_16x16x32_bf16 v[20:23], a[212:215], a[24:27], v[20:23]
    v_mfma_f32_16x16x32_bf16 v[24:27], a[216:219], a[24:27], v[24:27]
    v_mfma_f32_16x16x32_bf16 v[56:59], a[216:219], a[56:59], v[56:59]
    v_mfma_f32_16x16x32_bf16 v[88:91], a[216:219], a[88:91], v[88:91]
    v_mfma_f32_16x16x32_bf16 v[120:123], a[216:219], a[120:123], v[120:123]
    buffer_load_dwordx4 v174, s[32:35], s97 offen offset:2048 lds
    v_mfma_f32_16x16x32_bf16 v[152:155], a[216:219], a[152:155], v[152:155]
    s_waitcnt lgkmcnt(0)
    v_mfma_f32_16x16x32_bf16 v[156:159], a[220:223], a[152:155], v[156:159]
    v_mfma_f32_16x16x32_bf16 v[124:127], a[220:223], a[120:123], v[124:127]
    v_mfma_f32_16x16x32_bf16 v[92:95], a[220:223], a[88:91], v[92:95]
    v_mfma_f32_16x16x32_bf16 v[60:63], a[220:223], a[56:59], v[60:63]
    v_mfma_f32_16x16x32_bf16 v[28:31], a[220:223], a[24:27], v[28:31]
    s_waitcnt vmcnt(11)
    s_barrier
    ds_read_b64_tr_b16 a[192:193], v160 offset:49152
    ds_read_b64_tr_b16 a[194:195], v160 offset:51200
    ds_read_b64_tr_b16 a[196:197], v161 offset:49152
    ds_read_b64_tr_b16 a[198:199], v161 offset:51200
    s_waitcnt lgkmcnt(2)
    v_mfma_f32_16x16x32_bf16 v[0:3], a[192:195], a[28:31], v[0:3]
    s_add_u32 m0, s92, 139264
    ds_read_b128 a[0:3], v177 offset:20480
    v_mfma_f32_16x16x32_bf16 v[32:35], a[192:195], a[60:63], v[32:35]
    s_mov_b32 s97, 640
    ds_read_b64_tr_b16 a[200:201], v162 offset:49152
    ds_read_b64_tr_b16 a[202:203], v162 offset:51200
    v_mfma_f32_16x16x32_bf16 v[64:67], a[192:195], a[92:95], v[64:67]
    ds_read_b128 a[32:35], v177 offset:22528
    v_mfma_f32_16x16x32_bf16 v[96:99], a[192:195], a[124:127], v[96:99]
    buffer_load_dwordx4 v175, s[32:35], s97 offen offset:3072 lds
    v_mfma_f32_16x16x32_bf16 v[128:131], a[192:195], a[156:159], v[128:131]
    s_waitcnt lgkmcnt(4)
    v_mfma_f32_16x16x32_bf16 v[132:135], a[196:199], a[156:159], v[132:135]
    ds_read_b128 a[64:67], v177 offset:24576
    v_mfma_f32_16x16x32_bf16 v[100:103], a[196:199], a[124:127], v[100:103]
    ds_read_b64_tr_b16 a[204:205], v163 offset:49152
    ds_read_b64_tr_b16 a[206:207], v163 offset:51200
    v_mfma_f32_16x16x32_bf16 v[68:71], a[196:199], a[92:95], v[68:71]
    s_add_u32 m0, s31, 155648
    v_mfma_f32_16x16x32_bf16 v[36:39], a[196:199], a[60:63], v[36:39]
    ds_read_b128 a[96:99], v177 offset:26624
    v_mfma_f32_16x16x32_bf16 v[4:7], a[196:199], a[28:31], v[4:7]
    s_waitcnt lgkmcnt(5)
    buffer_load_dwordx4 v176, s[32:35], s97 offen lds
    v_mfma_f32_16x16x32_bf16 v[8:11], a[200:203], a[28:31], v[8:11]
    ds_read_b128 a[128:131], v177 offset:28672
    ds_read_b64_tr_b16 a[208:209], v164 offset:49152
    v_mfma_f32_16x16x32_bf16 v[40:43], a[200:203], a[60:63], v[40:43]
    ds_read_b64_tr_b16 a[210:211], v164 offset:51200
    v_mfma_f32_16x16x32_bf16 v[72:75], a[200:203], a[92:95], v[72:75]
    ds_read_b128 a[4:7], v178 offset:20480
    v_mfma_f32_16x16x32_bf16 v[104:107], a[200:203], a[124:127], v[104:107]
    s_add_u32 m0, s92, 32768
    ds_read_b64_tr_b16 a[212:213], v165 offset:49152
    v_mfma_f32_16x16x32_bf16 v[136:139], a[200:203], a[156:159], v[136:139]
    s_waitcnt lgkmcnt(6)
    ds_read_b64_tr_b16 a[214:215], v165 offset:51200
    v_mfma_f32_16x16x32_bf16 v[140:143], a[204:207], a[156:159], v[140:143]
    s_mov_b32 s97, 2621440
    buffer_load_dwordx4 v168, s[36:39], s97 offen offset:0 lds
    v_mfma_f32_16x16x32_bf16 v[108:111], a[204:207], a[124:127], v[108:111]
    ds_read_b128 a[36:39], v178 offset:22528
    v_mfma_f32_16x16x32_bf16 v[76:79], a[204:207], a[92:95], v[76:79]
    ds_read_b128 a[68:71], v178 offset:24576
    v_mfma_f32_16x16x32_bf16 v[44:47], a[204:207], a[60:63], v[44:47]
    ds_read_b64_tr_b16 a[216:217], v166 offset:49152
    ds_read_b64_tr_b16 a[218:219], v166 offset:51200
    v_mfma_f32_16x16x32_bf16 v[12:15], a[204:207], a[28:31], v[12:15]
    s_waitcnt lgkmcnt(7)
    v_mfma_f32_16x16x32_bf16 v[16:19], a[208:211], a[28:31], v[16:19]
    ds_read_b128 a[100:103], v178 offset:26624
    v_mfma_f32_16x16x32_bf16 v[48:51], a[208:211], a[60:63], v[48:51]
    buffer_load_dwordx4 v169, s[36:39], s97 offen offset:1024 lds
    v_mfma_f32_16x16x32_bf16 v[80:83], a[208:211], a[92:95], v[80:83]
    ds_read_b128 a[132:135], v178 offset:28672
    ds_read_b64_tr_b16 a[220:221], v167 offset:49152
    v_mfma_f32_16x16x32_bf16 v[112:115], a[208:211], a[124:127], v[112:115]
    ds_read_b64_tr_b16 a[222:223], v167 offset:51200
    v_mfma_f32_16x16x32_bf16 v[144:147], a[208:211], a[156:159], v[144:147]
    s_waitcnt lgkmcnt(7)
    v_mfma_f32_16x16x32_bf16 v[148:151], a[212:215], a[156:159], v[148:151]
    v_mfma_f32_16x16x32_bf16 v[116:119], a[212:215], a[124:127], v[116:119]
    v_mfma_f32_16x16x32_bf16 v[84:87], a[212:215], a[92:95], v[84:87]
    buffer_load_dwordx4 v170, s[36:39], s97 offen offset:2048 lds
    v_mfma_f32_16x16x32_bf16 v[52:55], a[212:215], a[60:63], v[52:55]
    v_mfma_f32_16x16x32_bf16 v[20:23], a[212:215], a[28:31], v[20:23]
    s_waitcnt lgkmcnt(3)
    v_mfma_f32_16x16x32_bf16 v[24:27], a[216:219], a[28:31], v[24:27]
    v_mfma_f32_16x16x32_bf16 v[56:59], a[216:219], a[60:63], v[56:59]
    v_mfma_f32_16x16x32_bf16 v[88:91], a[216:219], a[92:95], v[88:91]
    v_mfma_f32_16x16x32_bf16 v[120:123], a[216:219], a[124:127], v[120:123]
    buffer_load_dwordx4 v171, s[36:39], s97 offen offset:3072 lds
    v_mfma_f32_16x16x32_bf16 v[152:155], a[216:219], a[156:159], v[152:155]
    s_waitcnt lgkmcnt(0)
    v_mfma_f32_16x16x32_bf16 v[156:159], a[220:223], a[156:159], v[156:159]
    v_mfma_f32_16x16x32_bf16 v[124:127], a[220:223], a[124:127], v[124:127]
    v_mfma_f32_16x16x32_bf16 v[92:95], a[220:223], a[92:95], v[92:95]
    v_mfma_f32_16x16x32_bf16 v[60:63], a[220:223], a[60:63], v[60:63]
    v_mfma_f32_16x16x32_bf16 v[28:31], a[220:223], a[28:31], v[28:31]
    s_waitcnt vmcnt(13)
    s_barrier
    ds_read_b64_tr_b16 a[192:193], v160 offset:0
    ds_read_b64_tr_b16 a[194:195], v160 offset:2048
    ds_read_b64_tr_b16 a[196:197], v161 offset:0
    ds_read_b64_tr_b16 a[198:199], v161 offset:2048
    s_waitcnt lgkmcnt(2)
    v_mfma_f32_16x16x32_bf16 v[0:3], a[192:195], a[0:3], v[0:3]
    s_add_u32 m0, s92, 49152
    v_mfma_f32_16x16x32_bf16 v[32:35], a[192:195], a[32:35], v[32:35]
    s_mov_b32 s97, 2883584
    ds_read_b64_tr_b16 a[200:201], v162 offset:0
    ds_read_b64_tr_b16 a[202:203], v162 offset:2048
    v_mfma_f32_16x16x32_bf16 v[64:67], a[192:195], a[64:67], v[64:67]
    buffer_load_dwordx4 v168, s[36:39], s97 offen offset:0 lds
    v_mfma_f32_16x16x32_bf16 v[96:99], a[192:195], a[96:99], v[96:99]
    ds_read_b64_tr_b16 a[204:205], v163 offset:0
    ds_read_b64_tr_b16 a[206:207], v163 offset:2048
    v_mfma_f32_16x16x32_bf16 v[128:131], a[192:195], a[128:131], v[128:131]
    s_waitcnt lgkmcnt(4)
    ds_read_b64_tr_b16 a[208:209], v164 offset:0
    ds_read_b64_tr_b16 a[210:211], v164 offset:2048
    v_mfma_f32_16x16x32_bf16 v[132:135], a[196:199], a[128:131], v[132:135]
    v_mfma_f32_16x16x32_bf16 v[100:103], a[196:199], a[96:99], v[100:103]
    buffer_load_dwordx4 v169, s[36:39], s97 offen offset:1024 lds
    v_mfma_f32_16x16x32_bf16 v[68:71], a[196:199], a[64:67], v[68:71]
    v_mfma_f32_16x16x32_bf16 v[36:39], a[196:199], a[32:35], v[36:39]
    v_mfma_f32_16x16x32_bf16 v[4:7], a[196:199], a[0:3], v[4:7]
    s_waitcnt lgkmcnt(4)
    ds_read_b64_tr_b16 a[212:213], v165 offset:0
    ds_read_b64_tr_b16 a[214:215], v165 offset:2048
    v_mfma_f32_16x16x32_bf16 v[8:11], a[200:203], a[0:3], v[8:11]
    v_mfma_f32_16x16x32_bf16 v[40:43], a[200:203], a[32:35], v[40:43]
    buffer_load_dwordx4 v170, s[36:39], s97 offen offset:2048 lds
    v_mfma_f32_16x16x32_bf16 v[72:75], a[200:203], a[64:67], v[72:75]
    v_mfma_f32_16x16x32_bf16 v[104:107], a[200:203], a[96:99], v[104:107]
    v_mfma_f32_16x16x32_bf16 v[136:139], a[200:203], a[128:131], v[136:139]
    s_waitcnt lgkmcnt(2)
    ds_read_b64_tr_b16 a[216:217], v166 offset:0
    ds_read_b64_tr_b16 a[218:219], v166 offset:2048
    v_mfma_f32_16x16x32_bf16 v[140:143], a[204:207], a[128:131], v[140:143]
    v_mfma_f32_16x16x32_bf16 v[108:111], a[204:207], a[96:99], v[108:111]
    buffer_load_dwordx4 v171, s[36:39], s97 offen offset:3072 lds
    v_mfma_f32_16x16x32_bf16 v[76:79], a[204:207], a[64:67], v[76:79]
    v_mfma_f32_16x16x32_bf16 v[44:47], a[204:207], a[32:35], v[44:47]
    v_mfma_f32_16x16x32_bf16 v[12:15], a[204:207], a[0:3], v[12:15]
    ds_read_b64_tr_b16 a[220:221], v167 offset:0
    ds_read_b64_tr_b16 a[222:223], v167 offset:2048
    v_mfma_f32_16x16x32_bf16 v[16:19], a[208:211], a[0:3], v[16:19]
    v_mfma_f32_16x16x32_bf16 v[48:51], a[208:211], a[32:35], v[48:51]
    v_mfma_f32_16x16x32_bf16 v[80:83], a[208:211], a[64:67], v[80:83]
    s_add_u32 m0, s92, 98304
    v_mfma_f32_16x16x32_bf16 v[112:115], a[208:211], a[96:99], v[112:115]
    s_mov_b32 s97, 768
    buffer_load_dwordx4 v172, s[32:35], s97 offen offset:0 lds
    v_mfma_f32_16x16x32_bf16 v[144:147], a[208:211], a[128:131], v[144:147]
    s_waitcnt lgkmcnt(2)
    v_mfma_f32_16x16x32_bf16 v[148:151], a[212:215], a[128:131], v[148:151]
    v_mfma_f32_16x16x32_bf16 v[116:119], a[212:215], a[96:99], v[116:119]
    v_mfma_f32_16x16x32_bf16 v[84:87], a[212:215], a[64:67], v[84:87]
    v_mfma_f32_16x16x32_bf16 v[52:55], a[212:215], a[32:35], v[52:55]
    buffer_load_dwordx4 v173, s[32:35], s97 offen offset:1024 lds
    v_mfma_f32_16x16x32_bf16 v[20:23], a[212:215], a[0:3], v[20:23]
    v_mfma_f32_16x16x32_bf16 v[24:27], a[216:219], a[0:3], v[24:27]
    v_mfma_f32_16x16x32_bf16 v[56:59], a[216:219], a[32:35], v[56:59]
    v_mfma_f32_16x16x32_bf16 v[88:91], a[216:219], a[64:67], v[88:91]
    v_mfma_f32_16x16x32_bf16 v[120:123], a[216:219], a[96:99], v[120:123]
    buffer_load_dwordx4 v174, s[32:35], s97 offen offset:2048 lds
    v_mfma_f32_16x16x32_bf16 v[152:155], a[216:219], a[128:131], v[152:155]
    s_waitcnt lgkmcnt(0)
    v_mfma_f32_16x16x32_bf16 v[156:159], a[220:223], a[128:131], v[156:159]
    v_mfma_f32_16x16x32_bf16 v[124:127], a[220:223], a[96:99], v[124:127]
    v_mfma_f32_16x16x32_bf16 v[92:95], a[220:223], a[64:67], v[92:95]
    v_mfma_f32_16x16x32_bf16 v[60:63], a[220:223], a[32:35], v[60:63]
    v_mfma_f32_16x16x32_bf16 v[28:31], a[220:223], a[0:3], v[28:31]
    s_waitcnt vmcnt(11)
    s_barrier
    ds_read_b64_tr_b16 a[192:193], v160 offset:16384
    ds_read_b64_tr_b16 a[194:195], v160 offset:18432
    ds_read_b64_tr_b16 a[196:197], v161 offset:16384
    ds_read_b64_tr_b16 a[198:199], v161 offset:18432
    s_waitcnt lgkmcnt(2)
    v_mfma_f32_16x16x32_bf16 v[0:3], a[192:195], a[4:7], v[0:3]
    s_add_u32 m0, s92, 98304
    ds_read_b128 a[8:11], v177 offset:40960
    v_mfma_f32_16x16x32_bf16 v[32:35], a[192:195], a[36:39], v[32:35]
    s_mov_b32 s97, 768
    ds_read_b64_tr_b16 a[200:201], v162 offset:16384
    ds_read_b64_tr_b16 a[202:203], v162 offset:18432
    v_mfma_f32_16x16x32_bf16 v[64:67], a[192:195], a[68:71], v[64:67]
    ds_read_b128 a[40:43], v177 offset:43008
    v_mfma_f32_16x16x32_bf16 v[96:99], a[192:195], a[100:103], v[96:99]
    buffer_load_dwordx4 v175, s[32:35], s97 offen offset:3072 lds
    v_mfma_f32_16x16x32_bf16 v[128:131], a[192:195], a[132:135], v[128:131]
    s_waitcnt lgkmcnt(4)
    v_mfma_f32_16x16x32_bf16 v[132:135], a[196:199], a[132:135], v[132:135]
    ds_read_b128 a[72:75], v177 offset:45056
    v_mfma_f32_16x16x32_bf16 v[100:103], a[196:199], a[100:103], v[100:103]
    ds_read_b64_tr_b16 a[204:205], v163 offset:16384
    ds_read_b64_tr_b16 a[206:207], v163 offset:18432
    v_mfma_f32_16x16x32_bf16 v[68:71], a[196:199], a[68:71], v[68:71]
    s_add_u32 m0, s31, 114688
    v_mfma_f32_16x16x32_bf16 v[36:39], a[196:199], a[36:39], v[36:39]
    ds_read_b128 a[104:107], v177 offset:47104
    v_mfma_f32_16x16x32_bf16 v[4:7], a[196:199], a[4:7], v[4:7]
    s_waitcnt lgkmcnt(5)
    buffer_load_dwordx4 v176, s[32:35], s97 offen lds
    v_mfma_f32_16x16x32_bf16 v[8:11], a[200:203], a[4:7], v[8:11]
    ds_read_b128 a[136:139], v177 offset:49152
    ds_read_b64_tr_b16 a[208:209], v164 offset:16384
    v_mfma_f32_16x16x32_bf16 v[40:43], a[200:203], a[36:39], v[40:43]
    ds_read_b64_tr_b16 a[210:211], v164 offset:18432
    v_mfma_f32_16x16x32_bf16 v[72:75], a[200:203], a[68:71], v[72:75]
    ds_read_b128 a[12:15], v178 offset:40960
    v_mfma_f32_16x16x32_bf16 v[104:107], a[200:203], a[100:103], v[104:107]
    s_add_u32 m0, s92, 0
    ds_read_b64_tr_b16 a[212:213], v165 offset:16384
    v_mfma_f32_16x16x32_bf16 v[136:139], a[200:203], a[132:135], v[136:139]
    s_waitcnt lgkmcnt(6)
    ds_read_b64_tr_b16 a[214:215], v165 offset:18432
    v_mfma_f32_16x16x32_bf16 v[140:143], a[204:207], a[132:135], v[140:143]
    s_mov_b32 s97, 3145728
    buffer_load_dwordx4 v168, s[36:39], s97 offen offset:0 lds
    v_mfma_f32_16x16x32_bf16 v[108:111], a[204:207], a[100:103], v[108:111]
    ds_read_b128 a[44:47], v178 offset:43008
    v_mfma_f32_16x16x32_bf16 v[76:79], a[204:207], a[68:71], v[76:79]
    ds_read_b128 a[76:79], v178 offset:45056
    v_mfma_f32_16x16x32_bf16 v[44:47], a[204:207], a[36:39], v[44:47]
    ds_read_b64_tr_b16 a[216:217], v166 offset:16384
    ds_read_b64_tr_b16 a[218:219], v166 offset:18432
    v_mfma_f32_16x16x32_bf16 v[12:15], a[204:207], a[4:7], v[12:15]
    s_waitcnt lgkmcnt(7)
    v_mfma_f32_16x16x32_bf16 v[16:19], a[208:211], a[4:7], v[16:19]
    ds_read_b128 a[108:111], v178 offset:47104
    v_mfma_f32_16x16x32_bf16 v[48:51], a[208:211], a[36:39], v[48:51]
    buffer_load_dwordx4 v169, s[36:39], s97 offen offset:1024 lds
    v_mfma_f32_16x16x32_bf16 v[80:83], a[208:211], a[68:71], v[80:83]
    ds_read_b128 a[140:143], v178 offset:49152
    ds_read_b64_tr_b16 a[220:221], v167 offset:16384
    v_mfma_f32_16x16x32_bf16 v[112:115], a[208:211], a[100:103], v[112:115]
    ds_read_b64_tr_b16 a[222:223], v167 offset:18432
    v_mfma_f32_16x16x32_bf16 v[144:147], a[208:211], a[132:135], v[144:147]
    s_waitcnt lgkmcnt(7)
    v_mfma_f32_16x16x32_bf16 v[148:151], a[212:215], a[132:135], v[148:151]
    v_mfma_f32_16x16x32_bf16 v[116:119], a[212:215], a[100:103], v[116:119]
    v_mfma_f32_16x16x32_bf16 v[84:87], a[212:215], a[68:71], v[84:87]
    buffer_load_dwordx4 v170, s[36:39], s97 offen offset:2048 lds
    v_mfma_f32_16x16x32_bf16 v[52:55], a[212:215], a[36:39], v[52:55]
    v_mfma_f32_16x16x32_bf16 v[20:23], a[212:215], a[4:7], v[20:23]
    s_waitcnt lgkmcnt(3)
    v_mfma_f32_16x16x32_bf16 v[24:27], a[216:219], a[4:7], v[24:27]
    v_mfma_f32_16x16x32_bf16 v[56:59], a[216:219], a[36:39], v[56:59]
    v_mfma_f32_16x16x32_bf16 v[88:91], a[216:219], a[68:71], v[88:91]
    v_mfma_f32_16x16x32_bf16 v[120:123], a[216:219], a[100:103], v[120:123]
    buffer_load_dwordx4 v171, s[36:39], s97 offen offset:3072 lds
    v_mfma_f32_16x16x32_bf16 v[152:155], a[216:219], a[132:135], v[152:155]
    s_waitcnt lgkmcnt(0)
    v_mfma_f32_16x16x32_bf16 v[156:159], a[220:223], a[132:135], v[156:159]
    v_mfma_f32_16x16x32_bf16 v[124:127], a[220:223], a[100:103], v[124:127]
    v_mfma_f32_16x16x32_bf16 v[92:95], a[220:223], a[68:71], v[92:95]
    v_mfma_f32_16x16x32_bf16 v[60:63], a[220:223], a[36:39], v[60:63]
    v_mfma_f32_16x16x32_bf16 v[28:31], a[220:223], a[4:7], v[28:31]
    s_waitcnt vmcnt(13)
    s_barrier
    ds_read_b64_tr_b16 a[192:193], v160 offset:32768
    ds_read_b64_tr_b16 a[194:195], v160 offset:34816
    ds_read_b64_tr_b16 a[196:197], v161 offset:32768
    ds_read_b64_tr_b16 a[198:199], v161 offset:34816
    s_waitcnt lgkmcnt(2)
    v_mfma_f32_16x16x32_bf16 v[0:3], a[192:195], a[8:11], v[0:3]
    s_add_u32 m0, s92, 16384
    v_mfma_f32_16x16x32_bf16 v[32:35], a[192:195], a[40:43], v[32:35]
    s_mov_b32 s97, 3407872
    ds_read_b64_tr_b16 a[200:201], v162 offset:32768
    ds_read_b64_tr_b16 a[202:203], v162 offset:34816
    v_mfma_f32_16x16x32_bf16 v[64:67], a[192:195], a[72:75], v[64:67]
    buffer_load_dwordx4 v168, s[36:39], s97 offen offset:0 lds
    v_mfma_f32_16x16x32_bf16 v[96:99], a[192:195], a[104:107], v[96:99]
    ds_read_b64_tr_b16 a[204:205], v163 offset:32768
    ds_read_b64_tr_b16 a[206:207], v163 offset:34816
    v_mfma_f32_16x16x32_bf16 v[128:131], a[192:195], a[136:139], v[128:131]
    s_waitcnt lgkmcnt(4)
    ds_read_b64_tr_b16 a[208:209], v164 offset:32768
    ds_read_b64_tr_b16 a[210:211], v164 offset:34816
    v_mfma_f32_16x16x32_bf16 v[132:135], a[196:199], a[136:139], v[132:135]
    v_mfma_f32_16x16x32_bf16 v[100:103], a[196:199], a[104:107], v[100:103]
    v_mfma_f32_16x16x32_bf16 v[68:71], a[196:199], a[72:75], v[68:71]
    buffer_load_dwordx4 v169, s[36:39], s97 offen offset:1024 lds
    v_mfma_f32_16x16x32_bf16 v[36:39], a[196:199], a[40:43], v[36:39]
    v_mfma_f32_16x16x32_bf16 v[4:7], a[196:199], a[8:11], v[4:7]
    s_waitcnt lgkmcnt(4)
    ds_read_b64_tr_b16 a[212:213], v165 offset:32768
    ds_read_b64_tr_b16 a[214:215], v165 offset:34816
    v_mfma_f32_16x16x32_bf16 v[8:11], a[200:203], a[8:11], v[8:11]
    v_mfma_f32_16x16x32_bf16 v[40:43], a[200:203], a[40:43], v[40:43]
    v_mfma_f32_16x16x32_bf16 v[72:75], a[200:203], a[72:75], v[72:75]
    buffer_load_dwordx4 v170, s[36:39], s97 offen offset:2048 lds
    v_mfma_f32_16x16x32_bf16 v[104:107], a[200:203], a[104:107], v[104:107]
    v_mfma_f32_16x16x32_bf16 v[136:139], a[200:203], a[136:139], v[136:139]
    s_waitcnt lgkmcnt(2)
    ds_read_b64_tr_b16 a[216:217], v166 offset:32768
    ds_read_b64_tr_b16 a[218:219], v166 offset:34816
    v_mfma_f32_16x16x32_bf16 v[140:143], a[204:207], a[136:139], v[140:143]
    v_mfma_f32_16x16x32_bf16 v[108:111], a[204:207], a[104:107], v[108:111]
    v_mfma_f32_16x16x32_bf16 v[76:79], a[204:207], a[72:75], v[76:79]
    v_mfma_f32_16x16x32_bf16 v[44:47], a[204:207], a[40:43], v[44:47]
    buffer_load_dwordx4 v171, s[36:39], s97 offen offset:3072 lds
    v_mfma_f32_16x16x32_bf16 v[12:15], a[204:207], a[8:11], v[12:15]
    ds_read_b64_tr_b16 a[220:221], v167 offset:32768
    ds_read_b64_tr_b16 a[222:223], v167 offset:34816
    v_mfma_f32_16x16x32_bf16 v[16:19], a[208:211], a[8:11], v[16:19]
    v_mfma_f32_16x16x32_bf16 v[48:51], a[208:211], a[40:43], v[48:51]
    v_mfma_f32_16x16x32_bf16 v[80:83], a[208:211], a[72:75], v[80:83]
    v_mfma_f32_16x16x32_bf16 v[112:115], a[208:211], a[104:107], v[112:115]
    v_mfma_f32_16x16x32_bf16 v[144:147], a[208:211], a[136:139], v[144:147]
    s_waitcnt lgkmcnt(2)
    v_mfma_f32_16x16x32_bf16 v[148:151], a[212:215], a[136:139], v[148:151]
    v_mfma_f32_16x16x32_bf16 v[116:119], a[212:215], a[104:107], v[116:119]
    v_mfma_f32_16x16x32_bf16 v[84:87], a[212:215], a[72:75], v[84:87]
    v_mfma_f32_16x16x32_bf16 v[52:55], a[212:215], a[40:43], v[52:55]
    v_mfma_f32_16x16x32_bf16 v[20:23], a[212:215], a[8:11], v[20:23]
    v_mfma_f32_16x16x32_bf16 v[24:27], a[216:219], a[8:11], v[24:27]
    v_mfma_f32_16x16x32_bf16 v[56:59], a[216:219], a[40:43], v[56:59]
    v_mfma_f32_16x16x32_bf16 v[88:91], a[216:219], a[72:75], v[88:91]
    v_mfma_f32_16x16x32_bf16 v[120:123], a[216:219], a[104:107], v[120:123]
    v_mfma_f32_16x16x32_bf16 v[152:155], a[216:219], a[136:139], v[152:155]
    s_waitcnt lgkmcnt(0)
    v_mfma_f32_16x16x32_bf16 v[156:159], a[220:223], a[136:139], v[156:159]
    v_mfma_f32_16x16x32_bf16 v[124:127], a[220:223], a[104:107], v[124:127]
    v_mfma_f32_16x16x32_bf16 v[92:95], a[220:223], a[72:75], v[92:95]
    v_mfma_f32_16x16x32_bf16 v[60:63], a[220:223], a[40:43], v[60:63]
    v_mfma_f32_16x16x32_bf16 v[28:31], a[220:223], a[8:11], v[28:31]
    s_waitcnt vmcnt(8)
    s_barrier
    ds_read_b64_tr_b16 a[192:193], v160 offset:49152
    ds_read_b64_tr_b16 a[194:195], v160 offset:51200
    ds_read_b64_tr_b16 a[196:197], v161 offset:49152
    ds_read_b64_tr_b16 a[198:199], v161 offset:51200
    s_waitcnt lgkmcnt(2)
    v_mfma_f32_16x16x32_bf16 v[0:3], a[192:195], a[12:15], v[0:3]
    s_add_u32 m0, s92, 65536
    ds_read_b128 a[16:19], v177 offset:0
    v_mfma_f32_16x16x32_bf16 v[32:35], a[192:195], a[44:47], v[32:35]
    ds_read_b64_tr_b16 a[200:201], v162 offset:49152
    ds_read_b64_tr_b16 a[202:203], v162 offset:51200
    v_mfma_f32_16x16x32_bf16 v[64:67], a[192:195], a[76:79], v[64:67]
    ds_read_b128 a[48:51], v177 offset:2048
    v_mfma_f32_16x16x32_bf16 v[96:99], a[192:195], a[108:111], v[96:99]
    buffer_load_dwordx4 v212, s[40:43], s93 offen offset:0 nt lds
    v_mfma_f32_16x16x32_bf16 v[128:131], a[192:195], a[140:143], v[128:131]
    s_waitcnt lgkmcnt(4)
    v_mfma_f32_16x16x32_bf16 v[132:135], a[196:199], a[140:143], v[132:135]
    ds_read_b128 a[80:83], v177 offset:4096
    v_mfma_f32_16x16x32_bf16 v[100:103], a[196:199], a[108:111], v[100:103]
    ds_read_b64_tr_b16 a[204:205], v163 offset:49152
    ds_read_b64_tr_b16 a[206:207], v163 offset:51200
    v_mfma_f32_16x16x32_bf16 v[68:71], a[196:199], a[76:79], v[68:71]
    buffer_load_dwordx4 v213, s[40:43], s93 offen offset:1024 nt lds
    v_mfma_f32_16x16x32_bf16 v[36:39], a[196:199], a[44:47], v[36:39]
    ds_read_b128 a[112:115], v177 offset:6144
    v_mfma_f32_16x16x32_bf16 v[4:7], a[196:199], a[12:15], v[4:7]
    s_waitcnt lgkmcnt(5)
    ds_read_b128 a[144:147], v177 offset:8192
    v_mfma_f32_16x16x32_bf16 v[8:11], a[200:203], a[12:15], v[8:11]
    ds_read_b64_tr_b16 a[208:209], v164 offset:49152
    v_mfma_f32_16x16x32_bf16 v[40:43], a[200:203], a[44:47], v[40:43]
    ds_read_b64_tr_b16 a[210:211], v164 offset:51200
    v_mfma_f32_16x16x32_bf16 v[72:75], a[200:203], a[76:79], v[72:75]
    buffer_load_dwordx4 v214, s[40:43], s93 offen offset:2048 nt lds
    v_mfma_f32_16x16x32_bf16 v[104:107], a[200:203], a[108:111], v[104:107]
    ds_read_b128 a[20:23], v178 offset:0
    ds_read_b64_tr_b16 a[212:213], v165 offset:49152
    v_mfma_f32_16x16x32_bf16 v[136:139], a[200:203], a[140:143], v[136:139]
    s_waitcnt lgkmcnt(6)
    ds_read_b64_tr_b16 a[214:215], v165 offset:51200
    v_mfma_f32_16x16x32_bf16 v[140:143], a[204:207], a[140:143], v[140:143]
    ds_read_b128 a[52:55], v178 offset:2048
    v_mfma_f32_16x16x32_bf16 v[108:111], a[204:207], a[108:111], v[108:111]
    v_mfma_f32_16x16x32_bf16 v[76:79], a[204:207], a[76:79], v[76:79]
    buffer_load_dwordx4 v215, s[40:43], s93 offen offset:3072 nt lds
    v_mfma_f32_16x16x32_bf16 v[44:47], a[204:207], a[44:47], v[44:47]
    ds_read_b128 a[84:87], v178 offset:4096
    ds_read_b64_tr_b16 a[216:217], v166 offset:49152
    v_mfma_f32_16x16x32_bf16 v[12:15], a[204:207], a[12:15], v[12:15]
    s_waitcnt lgkmcnt(6)
    ds_read_b64_tr_b16 a[218:219], v166 offset:51200
    v_mfma_f32_16x16x32_bf16 v[16:19], a[208:211], a[12:15], v[16:19]
    ds_read_b128 a[116:119], v178 offset:6144
    v_mfma_f32_16x16x32_bf16 v[48:51], a[208:211], a[44:47], v[48:51]
    v_mfma_f32_16x16x32_bf16 v[80:83], a[208:211], a[76:79], v[80:83]
    ds_read_b128 a[148:151], v178 offset:8192
    ds_read_b64_tr_b16 a[220:221], v167 offset:49152
    v_mfma_f32_16x16x32_bf16 v[112:115], a[208:211], a[108:111], v[112:115]
    s_add_u32 s93, s93, 16384
    ds_read_b64_tr_b16 a[222:223], v167 offset:51200
    v_mfma_f32_16x16x32_bf16 v[144:147], a[208:211], a[140:143], v[144:147]
L_pg2:
    s_cbranch_execz L_pg6
    s_waitcnt lgkmcnt(7)
    v_mfma_f32_16x16x32_bf16 v[148:151], a[212:215], a[140:143], v[148:151]
    v_mfma_f32_16x16x32_bf16 v[116:119], a[212:215], a[108:111], v[116:119]
    v_mfma_f32_16x16x32_bf16 v[84:87], a[212:215], a[76:79], v[84:87]
    v_mfma_f32_16x16x32_bf16 v[52:55], a[212:215], a[44:47], v[52:55]
    v_mfma_f32_16x16x32_bf16 v[20:23], a[212:215], a[12:15], v[20:23]
    s_waitcnt lgkmcnt(3)
    v_mfma_f32_16x16x32_bf16 v[24:27], a[216:219], a[12:15], v[24:27]
    v_mfma_f32_16x16x32_bf16 v[56:59], a[216:219], a[44:47], v[56:59]
    v_mfma_f32_16x16x32_bf16 v[88:91], a[216:219], a[76:79], v[88:91]
    v_mfma_f32_16x16x32_bf16 v[120:123], a[216:219], a[108:111], v[120:123]
    v_mfma_f32_16x16x32_bf16 v[152:155], a[216:219], a[140:143], v[152:155]
    s_waitcnt lgkmcnt(0)
    v_mfma_f32_16x16x32_bf16 v[156:159], a[220:223], a[140:143], v[156:159]
    v_mfma_f32_16x16x32_bf16 v[124:127], a[220:223], a[108:111], v[124:127]
    v_mfma_f32_16x16x32_bf16 v[92:95], a[220:223], a[76:79], v[92:95]
    v_mfma_f32_16x16x32_bf16 v[60:63], a[220:223], a[44:47], v[60:63]
    v_mfma_f32_16x16x32_bf16 v[28:31], a[220:223], a[12:15], v[28:31]
    s_waitcnt vmcnt(4)
    s_barrier
    ds_read_b64_tr_b16 a[192:193], v160 offset:0
    ds_read_b64_tr_b16 a[194:195], v160 offset:2048
    ds_read_b64_tr_b16 a[196:197], v160 offset:16384
    ds_read_b64_tr_b16 a[198:199], v160 offset:18432
    s_waitcnt lgkmcnt(2)
    v_mfma_f32_16x16x32_bf16 v[0:3], a[192:195], a[16:19], v[0:3]
    s_waitcnt lgkmcnt(0)
    v_mfma_f32_16x16x32_bf16 v[0:3], a[196:199], a[20:23], v[0:3]
    s_add_u32 m0, s92, 81920
    ds_read_b64_tr_b16 a[200:201], v161 offset:0
    ds_read_b64_tr_b16 a[202:203], v161 offset:2048
    v_mfma_f32_16x16x32_bf16 v[32:35], a[192:195], a[48:51], v[32:35]
    ds_read_b64_tr_b16 a[204:205], v161 offset:16384
    ds_read_b64_tr_b16 a[206:207], v161 offset:18432
    v_mfma_f32_16x16x32_bf16 v[32:35], a[196:199], a[52:55], v[32:35]
    buffer_load_dwordx4 v212, s[40:43], s93 offen offset:0 nt lds
    v_mfma_f32_16x16x32_bf16 v[64:67], a[192:195], a[80:83], v[64:67]
    buffer_load_dwordx4 v213, s[40:43], s93 offen offset:1024 nt lds
    v_mfma_f32_16x16x32_bf16 v[64:67], a[196:199], a[84:87], v[64:67]
    ds_read_b64_tr_b16 a[208:209], v162 offset:0
    ds_read_b64_tr_b16 a[210:211], v162 offset:2048
    v_mfma_f32_16x16x32_bf16 v[96:99], a[192:195], a[112:115], v[96:99]
    buffer_load_dwordx4 v214, s[40:43], s93 offen offset:2048 nt lds
    v_mfma_f32_16x16x32_bf16 v[96:99], a[196:199], a[116:119], v[96:99]
    ds_read_b64_tr_b16 a[212:213], v162 offset:16384
    v_cvt_pk_bf16_f32 v0, v0, v1
    v_mfma_f32_16x16x32_bf16 v[128:131], a[192:195], a[144:147], v[128:131]
    ds_read_b64_tr_b16 a[214:215], v162 offset:18432
    v_cvt_pk_bf16_f32 v1, v2, v3
    v_mfma_f32_16x16x32_bf16 v[128:131], a[196:199], a[148:151], v[128:131]
    s_waitcnt lgkmcnt(6)
    ds_read_b64_tr_b16 a[216:217], v163 offset:0
    v_cvt_pk_bf16_f32 v32, v32, v33
    v_mfma_f32_16x16x32_bf16 v[132:135], a[200:203], a[144:147], v[132:135]
    s_waitcnt lgkmcnt(5)
    ds_read_b64_tr_b16 a[218:219], v163 offset:2048
    v_cvt_pk_bf16_f32 v33, v34, v35
    v_mfma_f32_16x16x32_bf16 v[132:135], a[204:207], a[148:151], v[132:135]
    buffer_load_dwordx4 v215, s[40:43], s93 offen offset:3072 nt lds
    v_mfma_f32_16x16x32_bf16 v[100:103], a[200:203], a[112:115], v[100:103]
    s_add_u32 s93, s93, 16384
    ds_read_b64_tr_b16 a[220:221], v163 offset:16384
    v_cvt_pk_bf16_f32 v64, v64, v65
    v_mfma_f32_16x16x32_bf16 v[100:103], a[204:207], a[116:119], v[100:103]
    v_cvt_pk_bf16_f32 v65, v66, v67
    v_min_u32 v241, 880, v222
    v_mfma_f32_16x16x32_bf16 v[68:71], a[200:203], a[80:83], v[68:71]
    ds_read_b64_tr_b16 a[222:223], v163 offset:18432
    v_cvt_pk_bf16_f32 v96, v96, v97
    v_mfma_f32_16x16x32_bf16 v[68:71], a[204:207], a[84:87], v[68:71]
    v_cvt_pk_bf16_f32 v97, v98, v99
    v_lshlrev_b32 v241, 3, v241
    v_mfma_f32_16x16x32_bf16 v[36:39], a[200:203], a[48:51], v[36:39]
    ds_write2st64_b64 v179, v[0:1], v[32:33] offset0:0 offset1:8
    v_mfma_f32_16x16x32_bf16 v[36:39], a[204:207], a[52:55], v[36:39]
    v_cvt_pk_bf16_f32 v128, v128, v129
    v_cvt_pk_bf16_f32 v129, v130, v131
    v_mfma_f32_16x16x32_bf16 v[4:7], a[200:203], a[16:19], v[4:7]
    ds_write2st64_b64 v179, v[64:65], v[96:97] offset0:16 offset1:24
    v_mfma_f32_16x16x32_bf16 v[4:7], a[204:207], a[20:23], v[4:7]
    s_waitcnt lgkmcnt(4)
    buffer_load_dword a253, v241, s[48:51], s9 offen
    v_mfma_f32_16x16x32_bf16 v[8:11], a[208:211], a[16:19], v[8:11]
    s_lshl_b32 s12, s96, 4
    v_cvt_pk_bf16_f32 v132, v132, v133
    v_cvt_pk_bf16_f32 v133, v134, v135
    v_mfma_f32_16x16x32_bf16 v[8:11], a[212:215], a[20:23], v[8:11]
    s_add_u32 s12, s12, s31
    v_cvt_pk_bf16_f32 v100, v100, v101
    v_cvt_pk_bf16_f32 v101, v102, v103
    v_mfma_f32_16x16x32_bf16 v[40:43], a[208:211], a[48:51], v[40:43]
    ds_write_b64 v179, v[128:129] offset:16384
    v_mfma_f32_16x16x32_bf16 v[40:43], a[212:215], a[52:55], v[40:43]
    v_mov_b32 v251, 1
    v_cvt_pk_bf16_f32 v68, v68, v69
    v_mfma_f32_16x16x32_bf16 v[72:75], a[208:211], a[80:83], v[72:75]
    buffer_atomic_add v251, v222, s[20:23], s12 offen sc1
    v_mfma_f32_16x16x32_bf16 v[72:75], a[212:215], a[84:87], v[72:75]
    v_cvt_pk_bf16_f32 v69, v70, v71
    v_cvt_pk_bf16_f32 v36, v36, v37
    v_mfma_f32_16x16x32_bf16 v[104:107], a[208:211], a[112:115], v[104:107]
    ds_read_b64_tr_b16 a[192:193], v164 offset:0
    v_cvt_pk_bf16_f32 v37, v38, v39
    v_mfma_f32_16x16x32_bf16 v[104:107], a[212:215], a[116:119], v[104:107]
    ds_write2st64_b64 v179, v[132:133], v[100:101] offset0:33 offset1:25
    v_mfma_f32_16x16x32_bf16 v[136:139], a[208:211], a[144:147], v[136:139]
    v_cvt_pk_bf16_f32 v4, v4, v5
    v_cvt_pk_bf16_f32 v5, v6, v7
    v_mfma_f32_16x16x32_bf16 v[136:139], a[212:215], a[148:151], v[136:139]
    ds_write2st64_b64 v179, v[68:69], v[36:37] offset0:17 offset1:9
    v_mfma_f32_16x16x32_bf16 v[140:143], a[216:219], a[144:147], v[140:143]
    s_waitcnt lgkmcnt(3)
    v_cvt_pk_bf16_f32 v8, v8, v9
    v_cvt_pk_bf16_f32 v9, v10, v11
    v_mfma_f32_16x16x32_bf16 v[140:143], a[220:223], a[148:151], v[140:143]
    ds_read_b64_tr_b16 a[194:195], v164 offset:2048
    v_cvt_pk_bf16_f32 v40, v40, v41
    v_mfma_f32_16x16x32_bf16 v[108:111], a[216:219], a[112:115], v[108:111]
    ds_read_b64_tr_b16 a[196:197], v164 offset:16384
    v_cvt_pk_bf16_f32 v41, v42, v43
    v_mfma_f32_16x16x32_bf16 v[108:111], a[220:223], a[116:119], v[108:111]
    ds_write_b64 v179, v[4:5] offset:512
    v_mfma_f32_16x16x32_bf16 v[76:79], a[216:219], a[80:83], v[76:79]
    ds_read_b128 a[0:3], v180 offset:0
    ds_read_b64_tr_b16 a[198:199], v164 offset:18432
    v_mfma_f32_16x16x32_bf16 v[76:79], a[220:223], a[84:87], v[76:79]
    ds_read_b64_tr_b16 a[200:201], v165 offset:0
    v_cvt_pk_bf16_f32 v72, v72, v73
    v_mfma_f32_16x16x32_bf16 v[44:47], a[216:219], a[48:51], v[44:47]
    ds_read_b128 a[32:35], v180 offset:4096
    v_cvt_pk_bf16_f32 v73, v74, v75
    v_mfma_f32_16x16x32_bf16 v[44:47], a[220:223], a[52:55], v[44:47]
    ds_read_b128 a[64:67], v180 offset:8192
    v_cvt_pk_bf16_f32 v104, v104, v105
    v_mfma_f32_16x16x32_bf16 v[12:15], a[216:219], a[16:19], v[12:15]
    ds_read_b128 a[96:99], v180 offset:12288
    v_cvt_pk_bf16_f32 v105, v106, v107
    v_mfma_f32_16x16x32_bf16 v[12:15], a[220:223], a[20:23], v[12:15]
    s_waitcnt lgkmcnt(8)
    ds_write2st64_b64 v179, v[8:9], v[40:41] offset0:2 offset1:10
    v_mfma_f32_16x16x32_bf16 v[16:19], a[192:195], a[16:19], v[16:19]
    s_waitcnt lgkmcnt(5)
    ds_read_b128 a[128:131], v180 offset:16384
    v_cvt_pk_bf16_f32 v136, v136, v137
    v_mfma_f32_16x16x32_bf16 v[16:19], a[196:199], a[20:23], v[16:19]
    ds_read_b64_tr_b16 a[202:203], v165 offset:2048
    v_cvt_pk_bf16_f32 v137, v138, v139
    v_mfma_f32_16x16x32_bf16 v[48:51], a[192:195], a[48:51], v[48:51]
    ds_write2st64_b64 v179, v[72:73], v[104:105] offset0:18 offset1:26
    v_mfma_f32_16x16x32_bf16 v[48:51], a[196:199], a[52:55], v[48:51]
    ds_read_b64_tr_b16 a[204:205], v165 offset:16384
    v_cvt_pk_bf16_f32 v140, v140, v141
    v_mfma_f32_16x16x32_bf16 v[80:83], a[192:195], a[80:83], v[80:83]
    ds_read_b64_tr_b16 a[206:207], v165 offset:18432
    v_cvt_pk_bf16_f32 v141, v142, v143
    v_mfma_f32_16x16x32_bf16 v[80:83], a[196:199], a[84:87], v[80:83]
    v_cvt_pk_bf16_f32 v108, v108, v109
    v_cvt_pk_bf16_f32 v109, v110, v111
    v_mfma_f32_16x16x32_bf16 v[112:115], a[192:195], a[112:115], v[112:115]
    ds_write_b64 v179, v[136:137] offset:17408
    v_mfma_f32_16x16x32_bf16 v[112:115], a[196:199], a[116:119], v[112:115]
    v_cvt_pk_bf16_f32 v76, v76, v77
    v_cvt_pk_bf16_f32 v77, v78, v79
    v_mfma_f32_16x16x32_bf16 v[144:147], a[192:195], a[144:147], v[144:147]
    v_cvt_pk_bf16_f32 v44, v44, v45
    v_cvt_pk_bf16_f32 v45, v46, v47
    v_mfma_f32_16x16x32_bf16 v[144:147], a[196:199], a[148:151], v[144:147]
    s_waitcnt lgkmcnt(4)
    ds_write2st64_b64 v179, v[140:141], v[108:109] offset0:35 offset1:27
    v_mfma_f32_16x16x32_bf16 v[148:151], a[200:203], a[144:147], v[148:151]
    s_waitcnt lgkmcnt(2)
    v_cvt_pk_bf16_f32 v12, v12, v13
    v_cvt_pk_bf16_f32 v13, v14, v15
    v_mfma_f32_16x16x32_bf16 v[148:151], a[204:207], a[148:151], v[148:151]
    ds_write2st64_b64 v179, v[76:77], v[44:45] offset0:19 offset1:11
    v_mfma_f32_16x16x32_bf16 v[116:119], a[200:203], a[112:115], v[116:119]
    ds_read_b64_tr_b16 a[208:209], v166 offset:0
    v_cvt_pk_bf16_f32 v16, v16, v17
    v_mfma_f32_16x16x32_bf16 v[116:119], a[204:207], a[116:119], v[116:119]
    ds_read_b64_tr_b16 a[210:211], v166 offset:2048
    v_cvt_pk_bf16_f32 v17, v18, v19
    v_mfma_f32_16x16x32_bf16 v[84:87], a[200:203], a[80:83], v[84:87]
    ds_read_b64_tr_b16 a[212:213], v166 offset:16384
    ds_read_b64_tr_b16 a[214:215], v166 offset:18432
    v_mfma_f32_16x16x32_bf16 v[84:87], a[204:207], a[84:87], v[84:87]
    v_cvt_pk_bf16_f32 v48, v48, v49
    v_cvt_pk_bf16_f32 v49, v50, v51
    v_mfma_f32_16x16x32_bf16 v[52:55], a[200:203], a[48:51], v[52:55]
    ds_write_b64 v179, v[12:13] offset:1536
    v_mfma_f32_16x16x32_bf16 v[52:55], a[204:207], a[52:55], v[52:55]
    ds_read_b128 a[4:7], v180 offset:1024
    v_cvt_pk_bf16_f32 v80, v80, v81
    v_mfma_f32_16x16x32_bf16 v[20:23], a[200:203], a[16:19], v[20:23]
    ds_read_b128 a[36:39], v180 offset:5120
    v_cvt_pk_bf16_f32 v81, v82, v83
    v_mfma_f32_16x16x32_bf16 v[20:23], a[204:207], a[20:23], v[20:23]
    s_waitcnt lgkmcnt(5)
    ds_read_b128 a[68:71], v180 offset:9216
    v_cvt_pk_bf16_f32 v112, v112, v113
    v_mfma_f32_16x16x32_bf16 v[24:27], a[208:211], a[16:19], v[24:27]
    s_waitcnt lgkmcnt(4)
    ds_read_b128 a[100:103], v180 offset:13312
    v_cvt_pk_bf16_f32 v113, v114, v115
    v_mfma_f32_16x16x32_bf16 v[24:27], a[212:215], a[20:23], v[24:27]
    ds_write2st64_b64 v179, v[16:17], v[48:49] offset0:4 offset1:12
    v_mfma_f32_16x16x32_bf16 v[56:59], a[208:211], a[48:51], v[56:59]
    ds_read_b128 a[132:135], v180 offset:17408
    v_cvt_pk_bf16_f32 v144, v144, v145
    v_mfma_f32_16x16x32_bf16 v[56:59], a[212:215], a[52:55], v[56:59]
    ds_read_b64_tr_b16 a[216:217], v167 offset:0
    ds_read_b64_tr_b16 a[218:219], v167 offset:2048
    v_cvt_pk_bf16_f32 v145, v146, v147
    v_mfma_f32_16x16x32_bf16 v[88:91], a[208:211], a[80:83], v[88:91]
    ds_write2st64_b64 v179, v[80:81], v[112:113] offset0:20 offset1:28
    v_mfma_f32_16x16x32_bf16 v[88:91], a[212:215], a[84:87], v[88:91]
    ds_read_b64_tr_b16 a[220:221], v167 offset:16384
    ds_read_b64_tr_b16 a[222:223], v167 offset:18432
    v_cvt_pk_bf16_f32 v148, v148, v149
    v_cvt_pk_bf16_f32 v149, v150, v151
    v_mfma_f32_16x16x32_bf16 v[120:123], a[208:211], a[112:115], v[120:123]
    v_cvt_pk_bf16_f32 v116, v116, v117
    v_cvt_pk_bf16_f32 v117, v118, v119
    v_mfma_f32_16x16x32_bf16 v[120:123], a[212:215], a[116:119], v[120:123]
    ds_write_b64 v179, v[144:145] offset:18432
    v_mfma_f32_16x16x32_bf16 v[152:155], a[208:211], a[144:147], v[152:155]
    s_waitcnt lgkmcnt(8)
    v_cvt_pk_bf16_f32 v84, v84, v85
    v_cvt_pk_bf16_f32 v85, v86, v87
    v_mfma_f32_16x16x32_bf16 v[152:155], a[212:215], a[148:151], v[152:155]
    s_waitcnt lgkmcnt(4)
    v_cvt_pk_bf16_f32 v52, v52, v53
    v_cvt_pk_bf16_f32 v53, v54, v55
    v_mfma_f32_16x16x32_bf16 v[156:159], a[216:219], a[144:147], v[156:159]
    s_waitcnt lgkmcnt(1)
    ds_write2st64_b64 v179, v[148:149], v[116:117] offset0:37 offset1:29
    v_mfma_f32_16x16x32_bf16 v[156:159], a[220:223], a[148:151], v[156:159]
    v_cvt_pk_bf16_f32 v20, v20, v21
    v_cvt_pk_bf16_f32 v21, v22, v23
    v_mfma_f32_16x16x32_bf16 v[124:127], a[216:219], a[112:115], v[124:127]
    ds_write2st64_b64 v179, v[84:85], v[52:53] offset0:21 offset1:13
    v_mfma_f32_16x16x32_bf16 v[124:127], a[220:223], a[116:119], v[124:127]
    v_cvt_pk_bf16_f32 v24, v24, v25
    v_cvt_pk_bf16_f32 v25, v26, v27
    v_mfma_f32_16x16x32_bf16 v[92:95], a[216:219], a[80:83], v[92:95]
    v_cvt_pk_bf16_f32 v56, v56, v57
    v_cvt_pk_bf16_f32 v57, v58, v59
    v_mfma_f32_16x16x32_bf16 v[92:95], a[220:223], a[84:87], v[92:95]
    ds_write_b64 v179, v[20:21] offset:2560
    v_mfma_f32_16x16x32_bf16 v[60:63], a[216:219], a[48:51], v[60:63]
    ds_read_b128 a[8:11], v180 offset:2048
    v_cvt_pk_bf16_f32 v88, v88, v89
    v_mfma_f32_16x16x32_bf16 v[60:63], a[220:223], a[52:55], v[60:63]
    ds_read_b128 a[40:43], v180 offset:6144
    v_cvt_pk_bf16_f32 v89, v90, v91
    v_mfma_f32_16x16x32_bf16 v[28:31], a[216:219], a[16:19], v[28:31]
    ds_read_b128 a[72:75], v180 offset:10240
    v_cvt_pk_bf16_f32 v120, v120, v121
    v_mfma_f32_16x16x32_bf16 v[28:31], a[220:223], a[20:23], v[28:31]
    ds_read_b128 a[104:107], v180 offset:14336
    v_cvt_pk_bf16_f32 v121, v122, v123
    ds_write2st64_b64 v179, v[24:25], v[56:57] offset0:6 offset1:14
    ds_read_b128 a[136:139], v180 offset:18432
    v_cvt_pk_bf16_f32 v152, v152, v153
    v_cvt_pk_bf16_f32 v153, v154, v155
    ds_write2st64_b64 v179, v[88:89], v[120:121] offset0:22 offset1:30
    v_cvt_pk_bf16_f32 v156, v156, v157
    v_cvt_pk_bf16_f32 v157, v158, v159
    v_cvt_pk_bf16_f32 v124, v124, v125
    v_cvt_pk_bf16_f32 v125, v126, v127
    ds_write_b64 v179, v[152:153] offset:19456
    v_cvt_pk_bf16_f32 v92, v92, v93
    v_cvt_pk_bf16_f32 v93, v94, v95
    v_cvt_pk_bf16_f32 v60, v60, v61
    v_cvt_pk_bf16_f32 v61, v62, v63
    ds_write2st64_b64 v179, v[156:157], v[124:125] offset0:39 offset1:31
    v_cvt_pk_bf16_f32 v28, v28, v29
    v_cvt_pk_bf16_f32 v29, v30, v31
    ds_write2st64_b64 v179, v[92:93], v[60:61] offset0:23 offset1:15
    ds_write_b64 v179, v[28:29] offset:3584
    s_waitcnt vmcnt(2) lgkmcnt(0)
    s_barrier
    ds_read_b128 a[160:163], v200 offset:0
    ds_read_b128 a[164:167], v201 offset:0
    ds_read_b128 a[168:171], v202 offset:0
    ds_read_b128 a[172:175], v203 offset:0
    ds_read_b128 a[12:15], v180 offset:3072
    ds_read_b128 a[176:179], v245 offset:0
    ds_read_b128 a[16:19], v181 offset:0
    ds_read_b128 a[180:183], v246 offset:0
    s_waitcnt lgkmcnt(7)
    v_mfma_f32_16x16x32_bf16 v[0:3], a[160:163], a[0:3], 0
    s_waitcnt lgkmcnt(6)
    ds_read_b128 a[20:23], v181 offset:1024
    ds_read_b128 a[184:187], v247 offset:0
    v_mfma_f32_16x16x32_bf16 v[0:3], a[164:167], a[4:7], v[0:3]
    s_waitcnt lgkmcnt(7)
    ds_read_b128 a[24:27], v181 offset:2048
    ds_read_b128 a[188:191], v248 offset:0
    v_mfma_f32_16x16x32_bf16 v[0:3], a[168:171], a[8:11], v[0:3]
    s_waitcnt lgkmcnt(7)
    ds_read_b128 a[28:31], v181 offset:3072
    ds_read_b128 a[44:47], v180 offset:7168
    v_mfma_f32_16x16x32_bf16 v[0:3], a[172:175], a[12:15], v[0:3]
    s_waitcnt lgkmcnt(7)
    ds_read_b128 a[48:51], v181 offset:4096
    s_add_u32 m0, s92, 0
    v_mfma_f32_16x16x32_bf16 v[0:3], a[176:179], a[16:19], v[0:3]
    s_waitcnt lgkmcnt(6)
    buffer_load_dwordx4 v216, s[44:47], s94 offen offset:0 nt lds
    v_mfma_f32_16x16x32_bf16 v[0:3], a[180:183], a[20:23], v[0:3]
    s_waitcnt lgkmcnt(4)
    ds_read_b128 a[52:55], v181 offset:5120
    ds_read_b128 a[56:59], v181 offset:6144
    v_mfma_f32_16x16x32_bf16 v[0:3], a[184:187], a[24:27], v[0:3]
    s_waitcnt lgkmcnt(4)
    ds_read_b128 a[60:63], v181 offset:7168
    v_mfma_f32_16x16x32_bf16 v[0:3], a[188:191], a[28:31], v[0:3]
    buffer_load_dwordx4 v217, s[44:47], s94 offen offset:1024 nt lds
    v_mfma_f32_16x16x32_bf16 v[4:7], a[160:163], a[32:35], 0
    v_mfma_f32_16x16x32_bf16 v[4:7], a[164:167], a[36:39], v[4:7]
    v_mfma_f32_16x16x32_bf16 v[4:7], a[168:171], a[40:43], v[4:7]
    s_waitcnt lgkmcnt(4)
    ds_read_b128 a[76:79], v180 offset:11264
    v_mfma_f32_16x16x32_bf16 v[4:7], a[172:175], a[44:47], v[4:7]
    s_waitcnt lgkmcnt(4)
    ds_read_b128 a[80:83], v181 offset:8192
    ds_read_b128 a[220:223], v200 offset:16384
    v_mfma_f32_16x16x32_bf16 v[4:7], a[176:179], a[48:51], v[4:7]
    s_waitcnt lgkmcnt(5)
    ds_read_b128 a[84:87], v181 offset:9216
    v_max_f32 v194, v0, v1
    v_mfma_f32_16x16x32_bf16 v[4:7], a[180:183], a[52:55], v[4:7]
    s_waitcnt lgkmcnt(5)
    ds_read_b128 a[88:91], v181 offset:10240
    v_max3_f32 v194, v194, v2, v3
    v_mfma_f32_16x16x32_bf16 v[4:7], a[184:187], a[56:59], v[4:7]
    s_waitcnt lgkmcnt(5)
    buffer_load_dwordx4 v218, s[44:47], s94 offen offset:2048 nt lds
    v_mfma_f32_16x16x32_bf16 v[4:7], a[188:191], a[60:63], v[4:7]
    ds_read_b128 a[92:95], v181 offset:11264
    v_mov_b32 v242, v194
    v_mfma_f32_16x16x32_bf16 v[8:11], a[160:163], a[64:67], 0
    s_nop 0
    v_permlane32_swap_b32 v242, v194
    v_mfma_f32_16x16x32_bf16 v[8:11], a[164:167], a[68:71], v[8:11]
    ds_read_b128 a[224:227], v201 offset:16384
    v_max_f32 v194, v194, v242
    v_mfma_f32_16x16x32_bf16 v[8:11], a[168:171], a[72:75], v[8:11]
    s_waitcnt lgkmcnt(6)
    ds_write_b32 v224, v194 offset:0
    v_mfma_f32_16x16x32_bf16 v[8:11], a[172:175], a[76:79], v[8:11]
    s_waitcnt lgkmcnt(5)
    buffer_load_dwordx4 v219, s[44:47], s94 offen offset:3072 nt lds
    v_mfma_f32_16x16x32_bf16 v[8:11], a[176:179], a[80:83], v[8:11]
    s_waitcnt lgkmcnt(4)
    ds_read_b128 a[228:231], v202 offset:16384
    ds_read_b128 a[108:111], v180 offset:15360
    v_mfma_f32_16x16x32_bf16 v[8:11], a[180:183], a[84:87], v[8:11]
    s_waitcnt lgkmcnt(5)
    ds_read_b128 a[112:115], v181 offset:12288
    ds_read_b128 a[116:119], v181 offset:13312
    v_mfma_f32_16x16x32_bf16 v[8:11], a[184:187], a[88:91], v[8:11]
    s_waitcnt lgkmcnt(6)
    ds_read_b128 a[232:235], v203 offset:16384
    v_max_f32 v195, v4, v5
    v_mfma_f32_16x16x32_bf16 v[8:11], a[188:191], a[92:95], v[8:11]
    s_add_u32 s94, s94, 16384
    ds_read_b128 a[120:123], v181 offset:14336
    v_max3_f32 v195, v195, v6, v7
    v_mfma_f32_16x16x32_bf16 v[12:15], a[160:163], a[96:99], 0
    s_add_u32 m0, s92, 16384
    ds_read_b128 a[124:127], v181 offset:15360
    v_mov_b32 v243, v195
    v_mfma_f32_16x16x32_bf16 v[12:15], a[164:167], a[100:103], v[12:15]
    s_nop 0
    v_permlane32_swap_b32 v243, v195
    v_mfma_f32_16x16x32_bf16 v[12:15], a[168:171], a[104:107], v[12:15]
    s_waitcnt lgkmcnt(5)
    buffer_load_dwordx4 v216, s[44:47], s94 offen offset:0 nt lds
    v_mfma_f32_16x16x32_bf16 v[12:15], a[172:175], a[108:111], v[12:15]
    s_waitcnt lgkmcnt(4)
    ds_read_b128 a[236:239], v245 offset:16384
    v_max_f32 v195, v195, v243
    v_mfma_f32_16x16x32_bf16 v[12:15], a[176:179], a[112:115], v[12:15]
    s_waitcnt lgkmcnt(4)
    ds_write_b32 v224, v195 offset:256
    v_mfma_f32_16x16x32_bf16 v[12:15], a[180:183], a[116:119], v[12:15]
    s_waitcnt lgkmcnt(3)
    ds_read_b128 a[140:143], v180 offset:19456
    ds_read_b128 a[240:243], v246 offset:16384
    v_mfma_f32_16x16x32_bf16 v[12:15], a[184:187], a[120:123], v[12:15]
    s_waitcnt lgkmcnt(4)
    ds_read_b128 a[144:147], v181 offset:16384
    ds_read_b128 a[148:151], v181 offset:17408
    v_mfma_f32_16x16x32_bf16 v[12:15], a[188:191], a[124:127], v[12:15]
    buffer_load_dwordx4 v217, s[44:47], s94 offen offset:1024 nt lds
    v_mfma_f32_16x16x32_bf16 v[16:19], a[160:163], a[128:131], 0
    ds_read_b128 a[152:155], v181 offset:18432
    ds_read_b128 a[244:247], v247 offset:16384
    v_mfma_f32_16x16x32_bf16 v[16:19], a[164:167], a[132:135], v[16:19]
    ds_read_b128 a[156:159], v181 offset:19456
    v_max_f32 v196, v8, v9
    v_mfma_f32_16x16x32_bf16 v[16:19], a[168:171], a[136:139], v[16:19]
    s_waitcnt lgkmcnt(6)
    ds_read_b128 a[248:251], v248 offset:16384
    v_max3_f32 v196, v196, v10, v11
    v_mfma_f32_16x16x32_bf16 v[16:19], a[172:175], a[140:143], v[16:19]
    s_waitcnt lgkmcnt(5)
    v_mov_b32 v242, v196
    v_mfma_f32_16x16x32_bf16 v[16:19], a[176:179], a[144:147], v[16:19]
    s_waitcnt lgkmcnt(4)
    v_permlane32_swap_b32 v242, v196
    v_mfma_f32_16x16x32_bf16 v[16:19], a[180:183], a[148:151], v[16:19]
    s_waitcnt lgkmcnt(3)
    v_max_f32 v196, v196, v242
    v_mfma_f32_16x16x32_bf16 v[16:19], a[184:187], a[152:155], v[16:19]
    s_waitcnt lgkmcnt(1)
    ds_write_b32 v224, v196 offset:512
    v_mfma_f32_16x16x32_bf16 v[16:19], a[188:191], a[156:159], v[16:19]
    v_max_f32 v197, v12, v13
    v_max3_f32 v197, v197, v14, v15
    v_mov_b32 v243, v197
    s_nop 1
    v_permlane32_swap_b32 v243, v197
    v_max_f32 v197, v197, v243
    ds_write_b32 v224, v197 offset:768
    v_max_f32 v198, v16, v17
    v_max3_f32 v198, v198, v18, v19
    v_mov_b32 v242, v198
    s_nop 1
    v_permlane32_swap_b32 v242, v198
    v_max_f32 v198, v198, v242
    ds_write_b32 v224, v198 offset:1024
L_attn1:
    s_waitcnt lgkmcnt(0)
    s_barrier
    v_mfma_f32_16x16x32_bf16 v[160:163], a[220:223], a[0:3], 0
    ds_read_b128 v[32:35], v225 offset:0
    v_mfma_f32_16x16x32_bf16 v[160:163], a[224:227], a[4:7], v[160:163]
    ds_read_b128 v[36:39], v225 offset:256
    v_mfma_f32_16x16x32_bf16 v[160:163], a[228:231], a[8:11], v[160:163]
    s_add_u32 m0, s92, 98304
    s_nop 0
    buffer_load_dwordx4 v212, s[40:43], s93 offen offset:0 nt lds
    v_mfma_f32_16x16x32_bf16 v[160:163], a[232:235], a[12:15], v[160:163]
    ds_read_b128 v[40:43], v225 offset:512
    v_mfma_f32_16x16x32_bf16 v[160:163], a[236:239], a[16:19], v[160:163]
    ds_read_b128 v[44:47], v225 offset:768
    v_mfma_f32_16x16x32_bf16 v[160:163], a[240:243], a[20:23], v[160:163]
    ds_read_b128 v[48:51], v225 offset:1024
    v_mov_b32 v189, 0
    v_mfma_f32_16x16x32_bf16 v[160:163], a[244:247], a[24:27], v[160:163]
    v_mov_b32 v190, 0
    v_mov_b32 v191, 0
    v_mfma_f32_16x16x32_bf16 v[160:163], a[248:251], a[28:31], v[160:163]
    buffer_load_dwordx4 v213, s[40:43], s93 offen offset:1024 nt lds
    v_mfma_f32_16x16x32_bf16 v[164:167], a[220:223], a[32:35], 0
    v_mov_b32 v192, 0
    v_mov_b32 v193, 0
    v_mfma_f32_16x16x32_bf16 v[164:167], a[224:227], a[36:39], v[164:167]
    s_waitcnt lgkmcnt(3)
    v_max_f32 v194, v32, v33
    v_max3_f32 v194, v194, v34, v35
    v_mfma_f32_16x16x32_bf16 v[164:167], a[228:231], a[40:43], v[164:167]
    v_max_f32 v195, v36, v37
    v_max3_f32 v195, v195, v38, v39
    v_mfma_f32_16x16x32_bf16 v[164:167], a[232:235], a[44:47], v[164:167]
    buffer_load_dwordx4 v214, s[40:43], s93 offen offset:2048 nt lds
    v_mfma_f32_16x16x32_bf16 v[164:167], a[236:239], a[48:51], v[164:167]
    s_waitcnt lgkmcnt(1)
    v_max_f32 v196, v40, v41
    v_max3_f32 v196, v196, v42, v43
    v_mfma_f32_16x16x32_bf16 v[164:167], a[240:243], a[52:55], v[164:167]
    v_max_f32 v197, v44, v45
    v_max3_f32 v197, v197, v46, v47
    v_mfma_f32_16x16x32_bf16 v[164:167], a[244:247], a[56:59], v[164:167]
    s_waitcnt lgkmcnt(0)
    v_max_f32 v198, v48, v49
    v_max3_f32 v198, v198, v50, v51
    v_mfma_f32_16x16x32_bf16 v[164:167], a[248:251], a[60:63], v[164:167]
    s_cmp_lg_u32 s96, 0
    s_cbranch_scc1 L_keepm
    v_mul_f32 v184, s99, v194
    v_mul_f32 v185, s99, v195
    v_mul_f32 v186, s99, v196
    v_mul_f32 v187, s99, v197
    v_mul_f32 v188, s99, v198
L_keepm:
    v_mfma_f32_16x16x32_bf16 v[168:171], a[220:223], a[64:67], 0
    s_mov_b32 s95, 0
    buffer_load_dwordx4 v215, s[40:43], s93 offen offset:3072 nt lds
    v_mfma_f32_16x16x32_bf16 v[168:171], a[224:227], a[68:71], v[168:171]
    v_fma_f32 v0, v0, s98, v184
    v_fma_f32 v1, v1, s98, v184
    v_exp_f32 v0, v0
    v_mfma_f32_16x16x32_bf16 v[168:171], a[228:231], a[72:75], v[168:171]
    v_fma_f32 v2, v2, s98, v184
    v_fma_f32 v3, v3, s98, v184
    v_exp_f32 v1, v1
    v_mfma_f32_16x16x32_bf16 v[168:171], a[232:235], a[76:79], v[168:171]
    v_exp_f32 v2, v2
    v_add_f32 v189, v189, v0
    v_cvt_pk_bf16_f32 v180, v0, v1
    v_mfma_f32_16x16x32_bf16 v[168:171], a[236:239], a[80:83], v[168:171]
    s_add_u32 s93, s93, 16384
    v_exp_f32 v3, v3
    v_add_f32 v189, v189, v1
    v_add_f32 v189, v189, v2
    v_mfma_f32_16x16x32_bf16 v[168:171], a[240:243], a[84:87], v[168:171]
    s_add_u32 m0, s92, 16384
    s_nop 0
    buffer_load_dwordx4 v218, s[44:47], s94 offen offset:2048 nt lds
    v_cvt_pk_bf16_f32 v181, v2, v3
    v_add_f32 v189, v189, v3
    v_mfma_f32_16x16x32_bf16 v[168:171], a[244:247], a[88:91], v[168:171]
    ds_write_b64 v220, v[180:181] offset:0
    v_fma_f32 v4, v4, s98, v185
    v_fma_f32 v5, v5, s98, v185
    v_mfma_f32_16x16x32_bf16 v[168:171], a[248:251], a[92:95], v[168:171]
    v_exp_f32 v4, v4
    v_fma_f32 v6, v6, s98, v185
    v_fma_f32 v7, v7, s98, v185
    v_mfma_f32_16x16x32_bf16 v[172:175], a[220:223], a[96:99], 0
    v_exp_f32 v5, v5
    v_exp_f32 v6, v6
    v_mfma_f32_16x16x32_bf16 v[172:175], a[224:227], a[100:103], v[172:175]
    buffer_load_dwordx4 v219, s[44:47], s94 offen offset:3072 nt lds
    v_add_f32 v190, v190, v4
    v_cvt_pk_bf16_f32 v182, v4, v5
    v_mfma_f32_16x16x32_bf16 v[172:175], a[228:231], a[104:107], v[172:175]
    v_exp_f32 v7, v7
    v_add_f32 v190, v190, v5
    v_add_f32 v190, v190, v6
    v_mfma_f32_16x16x32_bf16 v[172:175], a[232:235], a[108:111], v[172:175]
    v_cvt_pk_bf16_f32 v183, v6, v7
    v_add_f32 v190, v190, v7
    v_mfma_f32_16x16x32_bf16 v[172:175], a[236:239], a[112:115], v[172:175]
    ds_write_b64 v220, v[182:183] offset:1024
    v_fma_f32 v8, v8, s98, v186
    v_fma_f32 v9, v9, s98, v186
    v_mfma_f32_16x16x32_bf16 v[172:175], a[240:243], a[116:119], v[172:175]
    v_exp_f32 v8, v8
    v_fma_f32 v10, v10, s98, v186
    v_fma_f32 v11, v11, s98, v186
    v_mfma_f32_16x16x32_bf16 v[172:175], a[244:247], a[120:123], v[172:175]
    s_add_u32 s94, s94, 16384
    v_exp_f32 v9, v9
    v_exp_f32 v10, v10
    v_mfma_f32_16x16x32_bf16 v[172:175], a[248:251], a[124:127], v[172:175]
    v_add_f32 v191, v191, v8
    v_cvt_pk_bf16_f32 v180, v8, v9
    v_exp_f32 v11, v11
    v_mfma_f32_16x16x32_bf16 v[176:179], a[220:223], a[128:131], 0
    v_add_f32 v191, v191, v9
    v_add_f32 v191, v191, v10
    v_cvt_pk_bf16_f32 v181, v10, v11
    v_add_f32 v191, v191, v11
    ds_write_b64 v220, v[180:181] offset:2048
    v_fma_f32 v12, v12, s98, v187
    v_fma_f32 v13, v13, s98, v187
    v_exp_f32 v12, v12
    v_fma_f32 v14, v14, s98, v187
    v_fma_f32 v15, v15, s98, v187
    v_exp_f32 v13, v13
    v_exp_f32 v14, v14
    v_add_f32 v192, v192, v12
    v_cvt_pk_bf16_f32 v182, v12, v13
    v_exp_f32 v15, v15
    v_add_f32 v192, v192, v13
    v_add_f32 v192, v192, v14
    v_cvt_pk_bf16_f32 v183, v14, v15
    v_add_f32 v192, v192, v15
    ds_write_b64 v220, v[182:183] offset:3072
    v_fma_f32 v16, v16, s98, v188
    v_fma_f32 v17, v17, s98, v188
    v_exp_f32 v16, v16
    v_fma_f32 v18, v18, s98, v188
    v_fma_f32 v19, v19, s98, v188
    v_exp_f32 v17, v17
    v_exp_f32 v18, v18
    v_add_f32 v193, v193, v16
    v_cvt_pk_bf16_f32 v180, v16, v17
    v_exp_f32 v19, v19
    v_add_f32 v193, v193, v17
    v_add_f32 v193, v193, v18
    v_cvt_pk_bf16_f32 v181, v18, v19
    v_add_f32 v193, v193, v19
    ds_write_b64 v220, v[180:181] offset:4096
    s_waitcnt vmcnt(8) lgkmcnt(0)
    s_barrier
    ds_read_b128 a[192:195], v221 offset:0
    v_mfma_f32_16x16x32_bf16 v[176:179], a[224:227], a[132:135], v[176:179]
L_pg3:
    s_cbranch_execz L_pg7
    ds_read_b64_tr_b16 a[212:213], v204 offset:0
    ds_read_b64_tr_b16 a[214:215], v204 offset:8192
    v_mfma_f32_16x16x32_bf16 v[176:179], a[228:231], a[136:139], v[176:179]
    ds_read_b128 a[196:199], v221 offset:1024
    ds_read_b128 a[200:203], v221 offset:2048
    v_mfma_f32_16x16x32_bf16 v[176:179], a[232:235], a[140:143], v[176:179]
    ds_read_b128 a[204:207], v221 offset:3072
    ds_read_b128 a[208:211], v221 offset:4096
    v_mfma_f32_16x16x32_bf16 v[176:179], a[236:239], a[144:147], v[176:179]
    ds_read_b64_tr_b16 a[216:217], v205 offset:0
    ds_read_b64_tr_b16 a[218:219], v205 offset:8192
    v_mfma_f32_16x16x32_bf16 v[176:179], a[240:243], a[148:151], v[176:179]
    v_mfma_f32_16x16x32_bf16 v[176:179], a[244:247], a[152:155], v[176:179]
    v_mfma_f32_16x16x32_bf16 v[176:179], a[248:251], a[156:159], v[176:179]
    s_waitcnt lgkmcnt(6)
    v_mfma_f32_16x16x32_bf16 v[0:3], a[212:215], a[192:195], 0
    s_waitcnt lgkmcnt(5)
    ds_read_b64_tr_b16 a[220:221], v206 offset:0
    v_fma_f32 v160, v160, s98, v184
    v_mfma_f32_16x16x32_bf16 v[32:35], a[212:215], a[196:199], 0
    s_waitcnt lgkmcnt(5)
    ds_read_b64_tr_b16 a[222:223], v206 offset:8192
    v_fma_f32 v161, v161, s98, v184
    v_mfma_f32_16x16x32_bf16 v[64:67], a[212:215], a[200:203], 0
    s_waitcnt lgkmcnt(5)
    ds_read_b64_tr_b16 a[224:225], v207 offset:0
    ds_read_b64_tr_b16 a[226:227], v207 offset:8192
    v_mfma_f32_16x16x32_bf16 v[96:99], a[212:215], a[204:207], 0
    s_waitcnt lgkmcnt(6)
    v_exp_f32 v160, v160
    v_mfma_f32_16x16x32_bf16 v[128:131], a[212:215], a[208:211], 0
    s_waitcnt lgkmcnt(4)
    v_fma_f32 v162, v162, s98, v184
    v_fma_f32 v163, v163, s98, v184
    v_mfma_f32_16x16x32_bf16 v[132:135], a[216:219], a[208:211], 0
    s_add_u32 m0, s92, 114688
    s_nop 0
    buffer_load_dwordx4 v212, s[40:43], s93 offen offset:0 nt lds
    v_mfma_f32_16x16x32_bf16 v[100:103], a[216:219], a[204:207], 0
    v_exp_f32 v161, v161
    v_mfma_f32_16x16x32_bf16 v[68:71], a[216:219], a[200:203], 0
    v_exp_f32 v162, v162
    v_mfma_f32_16x16x32_bf16 v[36:39], a[216:219], a[196:199], 0
    v_add_f32 v189, v189, v160
    v_cvt_pk_bf16_f32 v180, v160, v161
    v_mfma_f32_16x16x32_bf16 v[4:7], a[216:219], a[192:195], 0
    s_waitcnt lgkmcnt(2)
    v_exp_f32 v163, v163
    v_mfma_f32_16x16x32_bf16 v[8:11], a[220:223], a[192:195], 0
    v_add_f32 v189, v189, v161
    v_add_f32 v189, v189, v162
    v_mfma_f32_16x16x32_bf16 v[40:43], a[220:223], a[196:199], 0
    buffer_load_dwordx4 v213, s[40:43], s93 offen offset:1024 nt lds
    v_mfma_f32_16x16x32_bf16 v[72:75], a[220:223], a[200:203], 0
    ds_read_b64_tr_b16 a[228:229], v208 offset:0
    v_cvt_pk_bf16_f32 v181, v162, v163
    v_mfma_f32_16x16x32_bf16 v[104:107], a[220:223], a[204:207], 0
    ds_read_b64_tr_b16 a[230:231], v208 offset:8192
    v_add_f32 v189, v189, v163
    v_mfma_f32_16x16x32_bf16 v[136:139], a[220:223], a[208:211], 0
    s_waitcnt lgkmcnt(2)
    ds_write_b64 v220, v[180:181] offset:10240
    v_mfma_f32_16x16x32_bf16 v[140:143], a[224:227], a[208:211], 0
    v_fma_f32 v164, v164, s98, v185
    v_fma_f32 v165, v165, s98, v185
    v_exp_f32 v164, v164
    v_mfma_f32_16x16x32_bf16 v[108:111], a[224:227], a[204:207], 0
    ds_read_b64_tr_b16 a[232:233], v209 offset:0
    v_fma_f32 v166, v166, s98, v185
    v_fma_f32 v167, v167, s98, v185
    v_mfma_f32_16x16x32_bf16 v[76:79], a[224:227], a[200:203], 0
    v_exp_f32 v165, v165
    v_exp_f32 v166, v166
    v_mfma_f32_16x16x32_bf16 v[44:47], a[224:227], a[196:199], 0
    buffer_load_dwordx4 v214, s[40:43], s93 offen offset:2048 nt lds
    v_add_f32 v190, v190, v164
    v_cvt_pk_bf16_f32 v182, v164, v165
    v_mfma_f32_16x16x32_bf16 v[12:15], a[224:227], a[192:195], 0
    s_waitcnt lgkmcnt(2)
    v_exp_f32 v167, v167
    v_add_f32 v190, v190, v165
    v_add_f32 v190, v190, v166
    v_mfma_f32_16x16x32_bf16 v[16:19], a[228:231], a[192:195], 0
    ds_read_b64_tr_b16 a[234:235], v209 offset:8192
    v_cvt_pk_bf16_f32 v183, v166, v167
    v_add_f32 v190, v190, v167
    v_mfma_f32_16x16x32_bf16 v[48:51], a[228:231], a[196:199], 0
    ds_write_b64 v220, v[182:183] offset:11264
    v_fma_f32 v168, v168, s98, v186
    v_fma_f32 v169, v169, s98, v186
    v_mfma_f32_16x16x32_bf16 v[80:83], a[228:231], a[200:203], 0
    v_exp_f32 v168, v168
    v_fma_f32 v170, v170, s98, v186
    v_fma_f32 v171, v171, s98, v186
    v_mfma_f32_16x16x32_bf16 v[112:115], a[228:231], a[204:207], 0
    v_exp_f32 v169, v169
    v_exp_f32 v170, v170
    v_mfma_f32_16x16x32_bf16 v[144:147], a[228:231], a[208:211], 0
    s_waitcnt lgkmcnt(1)
    ds_read_b64_tr_b16 a[236:237], v210 offset:0
    ds_read_b64_tr_b16 a[238:239], v210 offset:8192
    v_add_f32 v191, v191, v168
    v_cvt_pk_bf16_f32 v180, v168, v169
    v_mfma_f32_16x16x32_bf16 v[148:151], a[232:235], a[208:211], 0
    v_exp_f32 v171, v171
    v_add_f32 v191, v191, v169
    v_mfma_f32_16x16x32_bf16 v[116:119], a[232:235], a[204:207], 0
    buffer_load_dwordx4 v215, s[40:43], s93 offen offset:3072 nt lds
    v_add_f32 v191, v191, v170
    v_cvt_pk_bf16_f32 v181, v170, v171
    v_mfma_f32_16x16x32_bf16 v[84:87], a[232:235], a[200:203], 0
    ds_read_b64_tr_b16 a[240:241], v211 offset:0
    v_add_f32 v191, v191, v171
    v_mfma_f32_16x16x32_bf16 v[52:55], a[232:235], a[196:199], 0
    ds_write_b64 v220, v[180:181] offset:12288
    v_fma_f32 v172, v172, s98, v187
    v_fma_f32 v173, v173, s98, v187
    v_mfma_f32_16x16x32_bf16 v[20:23], a[232:235], a[192:195], 0
    s_waitcnt lgkmcnt(2)
    v_exp_f32 v172, v172
    v_fma_f32 v174, v174, s98, v187
    v_fma_f32 v175, v175, s98, v187
    v_mfma_f32_16x16x32_bf16 v[24:27], a[236:239], a[192:195], 0
    s_add_u32 s93, s93, 16384
    v_exp_f32 v173, v173
    v_exp_f32 v174, v174
    v_mfma_f32_16x16x32_bf16 v[56:59], a[236:239], a[196:199], 0
    ds_read_b64_tr_b16 a[242:243], v211 offset:8192
    v_add_f32 v192, v192, v172
    v_cvt_pk_bf16_f32 v182, v172, v173
    v_exp_f32 v175, v175
    v_mfma_f32_16x16x32_bf16 v[88:91], a[236:239], a[200:203], 0
    v_add_f32 v192, v192, v173
    v_add_f32 v192, v192, v174
    v_cvt_pk_bf16_f32 v183, v174, v175
    v_add_f32 v192, v192, v175
    ds_write_b64 v220, v[182:183] offset:13312
    v_fma_f32 v176, v176, s98, v188
    v_fma_f32 v177, v177, s98, v188
    v_exp_f32 v176, v176
    v_fma_f32 v178, v178, s98, v188
    v_fma_f32 v179, v179, s98, v188
    v_exp_f32 v177, v177
    v_exp_f32 v178, v178
    v_add_f32 v193, v193, v176
    v_cvt_pk_bf16_f32 v180, v176, v177
    v_exp_f32 v179, v179
    v_add_f32 v193, v193, v177
    v_add_f32 v193, v193, v178
    v_cvt_pk_bf16_f32 v181, v178, v179
    v_add_f32 v193, v193, v179
    ds_write_b64 v220, v[180:181] offset:14336
    s_waitcnt vmcnt(4) lgkmcnt(0)
    s_barrier
    ds_read_b128 a[160:163], v200 offset:32768
    v_mfma_f32_16x16x32_bf16 v[120:123], a[236:239], a[204:207], 0
    ds_read_b128 a[164:167], v201 offset:32768
    ds_read_b128 a[168:171], v202 offset:32768
    v_mfma_f32_16x16x32_bf16 v[152:155], a[236:239], a[208:211], 0
    ds_read_b128 a[172:175], v203 offset:32768
    v_mfma_f32_16x16x32_bf16 v[156:159], a[240:243], a[208:211], 0
    ds_read_b128 a[176:179], v245 offset:32768
    v_mfma_f32_16x16x32_bf16 v[124:127], a[240:243], a[204:207], 0
    ds_read_b128 a[180:183], v246 offset:32768
    v_mfma_f32_16x16x32_bf16 v[92:95], a[240:243], a[200:203], 0
    ds_read_b128 a[184:187], v247 offset:32768
    v_mfma_f32_16x16x32_bf16 v[60:63], a[240:243], a[196:199], 0
    s_add_u32 s95, s95, 1
    ds_read_b128 a[188:191], v248 offset:32768
    v_mfma_f32_16x16x32_bf16 v[28:31], a[240:243], a[192:195], 0
L_loop:
    s_waitcnt lgkmcnt(7)
    v_mfma_f32_16x16x32_bf16 v[160:163], a[160:163], a[0:3], 0
    s_waitcnt lgkmcnt(6)
    v_mfma_f32_16x16x32_bf16 v[160:163], a[164:167], a[4:7], v[160:163]
    s_waitcnt lgkmcnt(5)
    v_mfma_f32_16x16x32_bf16 v[160:163], a[168:171], a[8:11], v[160:163]
    s_waitcnt lgkmcnt(4)
    ds_read_b128 a[192:195], v221 offset:10240
    v_mfma_f32_16x16x32_bf16 v[160:163], a[172:175], a[12:15], v[160:163]
    s_waitcnt lgkmcnt(4)
    ds_read_b64_tr_b16 a[212:213], v204 offset:16384
    s_add_u32 m0, s92, 32768
    v_mfma_f32_16x16x32_bf16 v[160:163], a[176:179], a[16:19], v[160:163]
    s_waitcnt lgkmcnt(4)
    buffer_load_dwordx4 v216, s[44:47], s94 offen offset:0 nt lds
    v_mfma_f32_16x16x32_bf16 v[160:163], a[180:183], a[20:23], v[160:163]
    s_waitcnt lgkmcnt(3)
    ds_read_b64_tr_b16 a[214:215], v204 offset:24576
    ds_read_b128 a[196:199], v221 offset:11264
    v_mfma_f32_16x16x32_bf16 v[160:163], a[184:187], a[24:27], v[160:163]
    s_waitcnt lgkmcnt(4)
    v_mfma_f32_16x16x32_bf16 v[160:163], a[188:191], a[28:31], v[160:163]
    ds_read_b128 a[200:203], v221 offset:12288
    v_mfma_f32_16x16x32_bf16 v[164:167], a[160:163], a[32:35], 0
    ds_read_b128 a[204:207], v221 offset:13312
    v_mfma_f32_16x16x32_bf16 v[164:167], a[164:167], a[36:39], v[164:167]
    buffer_load_dwordx4 v217, s[44:47], s94 offen offset:1024 nt lds
    v_mfma_f32_16x16x32_bf16 v[164:167], a[168:171], a[40:43], v[164:167]
    ds_read_b128 a[208:211], v221 offset:14336
    ds_read_b64_tr_b16 a[216:217], v205 offset:16384
    v_mfma_f32_16x16x32_bf16 v[164:167], a[172:175], a[44:47], v[164:167]
    ds_read_b64_tr_b16 a[218:219], v205 offset:24576
    v_fma_f32 v160, v160, s98, v184
    v_mfma_f32_16x16x32_bf16 v[164:167], a[176:179], a[48:51], v[164:167]
    ds_read_b64_tr_b16 a[220:221], v206 offset:16384
    v_fma_f32 v161, v161, s98, v184
    v_mfma_f32_16x16x32_bf16 v[164:167], a[180:183], a[52:55], v[164:167]
    v_exp_f32 v160, v160
    v_mfma_f32_16x16x32_bf16 v[164:167], a[184:187], a[56:59], v[164:167]
    ds_read_b64_tr_b16 a[222:223], v206 offset:24576
    v_fma_f32 v162, v162, s98, v184
    v_mfma_f32_16x16x32_bf16 v[164:167], a[188:191], a[60:63], v[164:167]
    s_waitcnt lgkmcnt(6)
    v_fma_f32 v163, v163, s98, v184
    v_mfma_f32_16x16x32_bf16 v[0:3], a[212:215], a[192:195], v[0:3]
    v_exp_f32 v161, v161
    v_mfma_f32_16x16x32_bf16 v[32:35], a[212:215], a[196:199], v[32:35]
    v_exp_f32 v162, v162
    v_mfma_f32_16x16x32_bf16 v[64:67], a[212:215], a[200:203], v[64:67]
    s_waitcnt lgkmcnt(3)
    buffer_load_dwordx4 v218, s[44:47], s94 offen offset:2048 nt lds
    v_mfma_f32_16x16x32_bf16 v[96:99], a[212:215], a[204:207], v[96:99]
    v_add_f32 v189, v189, v160
    v_cvt_pk_bf16_f32 v180, v160, v161
    v_mfma_f32_16x16x32_bf16 v[128:131], a[212:215], a[208:211], v[128:131]
    s_waitcnt lgkmcnt(1)
    v_exp_f32 v163, v163
    v_mfma_f32_16x16x32_bf16 v[132:135], a[216:219], a[208:211], v[132:135]
    v_add_f32 v189, v189, v161
    v_add_f32 v189, v189, v162
    v_mfma_f32_16x16x32_bf16 v[100:103], a[216:219], a[204:207], v[100:103]
    v_cvt_pk_bf16_f32 v181, v162, v163
    v_add_f32 v189, v189, v163
    v_mfma_f32_16x16x32_bf16 v[68:71], a[216:219], a[200:203], v[68:71]
    ds_write_b64 v220, v[180:181] offset:0
    v_mfma_f32_16x16x32_bf16 v[36:39], a[216:219], a[196:199], v[36:39]
    ds_read_b64_tr_b16 a[224:225], v207 offset:16384
    v_fma_f32 v164, v164, s98, v185
    v_mfma_f32_16x16x32_bf16 v[4:7], a[216:219], a[192:195], v[4:7]
    ds_read_b64_tr_b16 a[226:227], v207 offset:24576
    v_fma_f32 v165, v165, s98, v185
    v_mfma_f32_16x16x32_bf16 v[168:171], a[160:163], a[64:67], 0
    v_exp_f32 v164, v164
    v_mfma_f32_16x16x32_bf16 v[168:171], a[164:167], a[68:71], v[168:171]
    buffer_load_dwordx4 v219, s[44:47], s94 offen offset:3072 nt lds
    v_mfma_f32_16x16x32_bf16 v[168:171], a[168:171], a[72:75], v[168:171]
    v_fma_f32 v166, v166, s98, v185
    v_fma_f32 v167, v167, s98, v185
    v_mfma_f32_16x16x32_bf16 v[168:171], a[172:175], a[76:79], v[168:171]
    v_exp_f32 v165, v165
    v_mfma_f32_16x16x32_bf16 v[168:171], a[176:179], a[80:83], v[168:171]
    v_exp_f32 v166, v166
    v_mfma_f32_16x16x32_bf16 v[168:171], a[180:183], a[84:87], v[168:171]
    v_add_f32 v190, v190, v164
    v_cvt_pk_bf16_f32 v182, v164, v165
    v_mfma_f32_16x16x32_bf16 v[168:171], a[184:187], a[88:91], v[168:171]
    v_exp_f32 v167, v167
    v_mfma_f32_16x16x32_bf16 v[168:171], a[188:191], a[92:95], v[168:171]
    s_waitcnt lgkmcnt(0)
    v_add_f32 v190, v190, v165
    v_add_f32 v190, v190, v166
    v_mfma_f32_16x16x32_bf16 v[8:11], a[220:223], a[192:195], v[8:11]
    s_add_u32 s94, s94, 16384
    v_cvt_pk_bf16_f32 v183, v166, v167
    v_mfma_f32_16x16x32_bf16 v[40:43], a[220:223], a[196:199], v[40:43]
    v_add_f32 v190, v190, v167
    v_mfma_f32_16x16x32_bf16 v[72:75], a[220:223], a[200:203], v[72:75]
    s_add_u32 m0, s92, 65536
    ds_write_b64 v220, v[182:183] offset:1024
    v_mfma_f32_16x16x32_bf16 v[104:107], a[220:223], a[204:207], v[104:107]
    buffer_load_dwordx4 v212, s[40:43], s93 offen offset:0 nt lds
    v_mfma_f32_16x16x32_bf16 v[136:139], a[220:223], a[208:211], v[136:139]
    ds_read_b64_tr_b16 a[228:229], v208 offset:16384
    v_fma_f32 v168, v168, s98, v186
    v_mfma_f32_16x16x32_bf16 v[172:175], a[160:163], a[96:99], 0
    ds_read_b64_tr_b16 a[230:231], v208 offset:24576
    v_fma_f32 v169, v169, s98, v186
    v_mfma_f32_16x16x32_bf16 v[172:175], a[164:167], a[100:103], v[172:175]
    v_exp_f32 v168, v168
    v_mfma_f32_16x16x32_bf16 v[172:175], a[168:171], a[104:107], v[172:175]
    ds_read_b64_tr_b16 a[232:233], v209 offset:16384
    v_fma_f32 v170, v170, s98, v186
    v_mfma_f32_16x16x32_bf16 v[172:175], a[172:175], a[108:111], v[172:175]
    ds_read_b64_tr_b16 a[234:235], v209 offset:24576
    v_fma_f32 v171, v171, s98, v186
    v_mfma_f32_16x16x32_bf16 v[172:175], a[176:179], a[112:115], v[172:175]
    v_exp_f32 v169, v169
    v_mfma_f32_16x16x32_bf16 v[172:175], a[180:183], a[116:119], v[172:175]
    v_exp_f32 v170, v170
    v_mfma_f32_16x16x32_bf16 v[172:175], a[184:187], a[120:123], v[172:175]
    buffer_load_dwordx4 v213, s[40:43], s93 offen offset:1024 nt lds
    v_mfma_f32_16x16x32_bf16 v[172:175], a[188:191], a[124:127], v[172:175]
    v_add_f32 v191, v191, v168
    v_cvt_pk_bf16_f32 v180, v168, v169
    v_mfma_f32_16x16x32_bf16 v[140:143], a[224:227], a[208:211], v[140:143]
    v_exp_f32 v171, v171
    v_mfma_f32_16x16x32_bf16 v[108:111], a[224:227], a[204:207], v[108:111]
    ds_read_b64_tr_b16 a[236:237], v210 offset:16384
    v_add_f32 v191, v191, v169
    v_mfma_f32_16x16x32_bf16 v[76:79], a[224:227], a[200:203], v[76:79]
    v_add_f32 v191, v191, v170
    v_cvt_pk_bf16_f32 v181, v170, v171
    v_mfma_f32_16x16x32_bf16 v[44:47], a[224:227], a[196:199], v[44:47]
    ds_read_b64_tr_b16 a[238:239], v210 offset:24576
    v_add_f32 v191, v191, v171
    v_mfma_f32_16x16x32_bf16 v[12:15], a[224:227], a[192:195], v[12:15]
    ds_write_b64 v220, v[180:181] offset:2048
    v_mfma_f32_16x16x32_bf16 v[176:179], a[160:163], a[128:131], 0
    ds_read_b64_tr_b16 a[240:241], v211 offset:16384
    v_fma_f32 v172, v172, s98, v187
    v_mfma_f32_16x16x32_bf16 v[176:179], a[164:167], a[132:135], v[176:179]
    ds_read_b64_tr_b16 a[242:243], v211 offset:24576
    v_fma_f32 v173, v173, s98, v187
    v_mfma_f32_16x16x32_bf16 v[176:179], a[168:171], a[136:139], v[176:179]
    v_exp_f32 v172, v172
    v_mfma_f32_16x16x32_bf16 v[176:179], a[172:175], a[140:143], v[176:179]
    buffer_load_dwordx4 v214, s[40:43], s93 offen offset:2048 nt lds
    v_mfma_f32_16x16x32_bf16 v[176:179], a[176:179], a[144:147], v[176:179]
    v_fma_f32 v174, v174, s98, v187
    v_fma_f32 v175, v175, s98, v187
    v_mfma_f32_16x16x32_bf16 v[176:179], a[180:183], a[148:151], v[176:179]
    v_exp_f32 v173, v173
    v_mfma_f32_16x16x32_bf16 v[176:179], a[184:187], a[152:155], v[176:179]
    v_exp_f32 v174, v174
    v_mfma_f32_16x16x32_bf16 v[176:179], a[188:191], a[156:159], v[176:179]
    s_waitcnt lgkmcnt(2)
    buffer_load_dwordx4 v215, s[40:43], s93 offen offset:3072 nt lds
    v_mfma_f32_16x16x32_bf16 v[16:19], a[228:231], a[192:195], v[16:19]
    v_add_f32 v192, v192, v172
    v_cvt_pk_bf16_f32 v182, v172, v173
    v_mfma_f32_16x16x32_bf16 v[48:51], a[228:231], a[196:199], v[48:51]
    v_exp_f32 v175, v175
    v_mfma_f32_16x16x32_bf16 v[80:83], a[228:231], a[200:203], v[80:83]
    v_add_f32 v192, v192, v173
    v_add_f32 v192, v192, v174
    v_mfma_f32_16x16x32_bf16 v[112:115], a[228:231], a[204:207], v[112:115]
    v_cvt_pk_bf16_f32 v183, v174, v175
    v_add_f32 v192, v192, v175
    v_mfma_f32_16x16x32_bf16 v[144:147], a[228:231], a[208:211], v[144:147]
    ds_write_b64 v220, v[182:183] offset:3072
    v_mfma_f32_16x16x32_bf16 v[148:151], a[232:235], a[208:211], v[148:151]
    v_fma_f32 v176, v176, s98, v188
    v_fma_f32 v177, v177, s98, v188
    v_mfma_f32_16x16x32_bf16 v[116:119], a[232:235], a[204:207], v[116:119]
    v_exp_f32 v176, v176
    v_mfma_f32_16x16x32_bf16 v[84:87], a[232:235], a[200:203], v[84:87]
    s_add_u32 s93, s93, 16384
    v_fma_f32 v178, v178, s98, v188
    v_fma_f32 v179, v179, s98, v188
    v_mfma_f32_16x16x32_bf16 v[52:55], a[232:235], a[196:199], v[52:55]
    v_exp_f32 v177, v177
    v_mfma_f32_16x16x32_bf16 v[20:23], a[232:235], a[192:195], v[20:23]
    v_exp_f32 v178, v178
    v_mfma_f32_16x16x32_bf16 v[24:27], a[236:239], a[192:195], v[24:27]
    v_add_f32 v193, v193, v176
    v_cvt_pk_bf16_f32 v180, v176, v177
    v_mfma_f32_16x16x32_bf16 v[56:59], a[236:239], a[196:199], v[56:59]
    v_exp_f32 v179, v179
    v_mfma_f32_16x16x32_bf16 v[88:91], a[236:239], a[200:203], v[88:91]
    v_add_f32 v193, v193, v177
    v_add_f32 v193, v193, v178
    v_cvt_pk_bf16_f32 v181, v178, v179
    v_add_f32 v193, v193, v179
    ds_write_b64 v220, v[180:181] offset:4096
    s_waitcnt vmcnt(4) lgkmcnt(0)
    s_barrier
    ds_read_b128 a[160:163], v200 offset:49152
    v_mfma_f32_16x16x32_bf16 v[120:123], a[236:239], a[204:207], v[120:123]
    ds_read_b128 a[164:167], v201 offset:49152
    ds_read_b128 a[168:171], v202 offset:49152
    v_mfma_f32_16x16x32_bf16 v[152:155], a[236:239], a[208:211], v[152:155]
    ds_read_b128 a[172:175], v203 offset:49152
    v_mfma_f32_16x16x32_bf16 v[156:159], a[240:243], a[208:211], v[156:159]
    ds_read_b128 a[176:179], v245 offset:49152
    v_mfma_f32_16x16x32_bf16 v[124:127], a[240:243], a[204:207], v[124:127]
    ds_read_b128 a[180:183], v246 offset:49152
    v_mfma_f32_16x16x32_bf16 v[92:95], a[240:243], a[200:203], v[92:95]
    ds_read_b128 a[184:187], v247 offset:49152
    v_mfma_f32_16x16x32_bf16 v[60:63], a[240:243], a[196:199], v[60:63]
    ds_read_b128 a[188:191], v248 offset:49152
    v_mfma_f32_16x16x32_bf16 v[28:31], a[240:243], a[192:195], v[28:31]
    s_waitcnt lgkmcnt(7)
    v_mfma_f32_16x16x32_bf16 v[160:163], a[160:163], a[0:3], 0
    s_waitcnt lgkmcnt(6)
    v_mfma_f32_16x16x32_bf16 v[160:163], a[164:167], a[4:7], v[160:163]
    s_waitcnt lgkmcnt(5)
    v_mfma_f32_16x16x32_bf16 v[160:163], a[168:171], a[8:11], v[160:163]
    s_waitcnt lgkmcnt(4)
    ds_read_b128 a[192:195], v221 offset:0
    v_mfma_f32_16x16x32_bf16 v[160:163], a[172:175], a[12:15], v[160:163]
    s_waitcnt lgkmcnt(4)
    ds_read_b64_tr_b16 a[212:213], v204 offset:32768
    s_add_u32 m0, s92, 49152
    v_mfma_f32_16x16x32_bf16 v[160:163], a[176:179], a[16:19], v[160:163]
    s_waitcnt lgkmcnt(4)
    buffer_load_dwordx4 v216, s[44:47], s94 offen offset:0 nt lds
    v_mfma_f32_16x16x32_bf16 v[160:163], a[180:183], a[20:23], v[160:163]
    s_waitcnt lgkmcnt(3)
    ds_read_b64_tr_b16 a[214:215], v204 offset:40960
    ds_read_b128 a[196:199], v221 offset:1024
    v_mfma_f32_16x16x32_bf16 v[160:163], a[184:187], a[24:27], v[160:163]
    s_waitcnt lgkmcnt(4)
    v_mfma_f32_16x16x32_bf16 v[160:163], a[188:191], a[28:31], v[160:163]
    ds_read_b128 a[200:203], v221 offset:2048
    v_mfma_f32_16x16x32_bf16 v[164:167], a[160:163], a[32:35], 0
    ds_read_b128 a[204:207], v221 offset:3072
    v_mfma_f32_16x16x32_bf16 v[164:167], a[164:167], a[36:39], v[164:167]
    buffer_load_dwordx4 v217, s[44:47], s94 offen offset:1024 nt lds
    v_mfma_f32_16x16x32_bf16 v[164:167], a[168:171], a[40:43], v[164:167]
    ds_read_b128 a[208:211], v221 offset:4096
    ds_read_b64_tr_b16 a[216:217], v205 offset:32768
    v_mfma_f32_16x16x32_bf16 v[164:167], a[172:175], a[44:47], v[164:167]
    ds_read_b64_tr_b16 a[218:219], v205 offset:40960
    v_fma_f32 v160, v160, s98, v184
    v_mfma_f32_16x16x32_bf16 v[164:167], a[176:179], a[48:51], v[164:167]
    ds_read_b64_tr_b16 a[220:221], v206 offset:32768
    v_fma_f32 v161, v161, s98, v184
    v_mfma_f32_16x16x32_bf16 v[164:167], a[180:183], a[52:55], v[164:167]
    v_exp_f32 v160, v160
    v_mfma_f32_16x16x32_bf16 v[164:167], a[184:187], a[56:59], v[164:167]
    ds_read_b64_tr_b16 a[222:223], v206 offset:40960
    v_fma_f32 v162, v162, s98, v184
    v_mfma_f32_16x16x32_bf16 v[164:167], a[188:191], a[60:63], v[164:167]
    s_waitcnt lgkmcnt(6)
    v_fma_f32 v163, v163, s98, v184
    v_mfma_f32_16x16x32_bf16 v[0:3], a[212:215], a[192:195], v[0:3]
    v_exp_f32 v161, v161
    v_mfma_f32_16x16x32_bf16 v[32:35], a[212:215], a[196:199], v[32:35]
    v_exp_f32 v162, v162
    v_mfma_f32_16x16x32_bf16 v[64:67], a[212:215], a[200:203], v[64:67]
    s_waitcnt lgkmcnt(3)
    buffer_load_dwordx4 v218, s[44:47], s94 offen offset:2048 nt lds
    v_mfma_f32_16x16x32_bf16 v[96:99], a[212:215], a[204:207], v[96:99]
    v_add_f32 v189, v189, v160
    v_cvt_pk_bf16_f32 v180, v160, v161
    v_mfma_f32_16x16x32_bf16 v[128:131], a[212:215], a[208:211], v[128:131]
    s_waitcnt lgkmcnt(1)
    v_exp_f32 v163, v163
    v_mfma_f32_16x16x32_bf16 v[132:135], a[216:219], a[208:211], v[132:135]
    v_add_f32 v189, v189, v161
    v_add_f32 v189, v189, v162
    v_mfma_f32_16x16x32_bf16 v[100:103], a[216:219], a[204:207], v[100:103]
    v_cvt_pk_bf16_f32 v181, v162, v163
    v_add_f32 v189, v189, v163
    v_mfma_f32_16x16x32_bf16 v[68:71], a[216:219], a[200:203], v[68:71]
    ds_write_b64 v220, v[180:181] offset:10240
    v_mfma_f32_16x16x32_bf16 v[36:39], a[216:219], a[196:199], v[36:39]
    ds_read_b64_tr_b16 a[224:225], v207 offset:32768
    v_fma_f32 v164, v164, s98, v185
    v_mfma_f32_16x16x32_bf16 v[4:7], a[216:219], a[192:195], v[4:7]
    ds_read_b64_tr_b16 a[226:227], v207 offset:40960
    v_fma_f32 v165, v165, s98, v185
    v_mfma_f32_16x16x32_bf16 v[168:171], a[160:163], a[64:67], 0
    v_exp_f32 v164, v164
    v_mfma_f32_16x16x32_bf16 v[168:171], a[164:167], a[68:71], v[168:171]
    buffer_load_dwordx4 v219, s[44:47], s94 offen offset:3072 nt lds
    v_mfma_f32_16x16x32_bf16 v[168:171], a[168:171], a[72:75], v[168:171]
    v_fma_f32 v166, v166, s98, v185
    v_fma_f32 v167, v167, s98, v185
    v_mfma_f32_16x16x32_bf16 v[168:171], a[172:175], a[76:79], v[168:171]
    v_exp_f32 v165, v165
    v_mfma_f32_16x16x32_bf16 v[168:171], a[176:179], a[80:83], v[168:171]
    v_exp_f32 v166, v166
    v_mfma_f32_16x16x32_bf16 v[168:171], a[180:183], a[84:87], v[168:171]
    v_add_f32 v190, v190, v164
    v_cvt_pk_bf16_f32 v182, v164, v165
    v_mfma_f32_16x16x32_bf16 v[168:171], a[184:187], a[88:91], v[168:171]
    v_exp_f32 v167, v167
    v_mfma_f32_16x16x32_bf16 v[168:171], a[188:191], a[92:95], v[168:171]
    s_waitcnt lgkmcnt(0)
    v_add_f32 v190, v190, v165
    v_add_f32 v190, v190, v166
    v_mfma_f32_16x16x32_bf16 v[8:11], a[220:223], a[192:195], v[8:11]
    s_add_u32 s94, s94, 16384
    v_cvt_pk_bf16_f32 v183, v166, v167
    v_mfma_f32_16x16x32_bf16 v[40:43], a[220:223], a[196:199], v[40:43]
    v_add_f32 v190, v190, v167
    v_mfma_f32_16x16x32_bf16 v[72:75], a[220:223], a[200:203], v[72:75]
    s_add_u32 m0, s92, 81920
    ds_write_b64 v220, v[182:183] offset:11264
    v_mfma_f32_16x16x32_bf16 v[104:107], a[220:223], a[204:207], v[104:107]
    buffer_load_dwordx4 v212, s[40:43], s93 offen offset:0 nt lds
    v_mfma_f32_16x16x32_bf16 v[136:139], a[220:223], a[208:211], v[136:139]
    ds_read_b64_tr_b16 a[228:229], v208 offset:32768
    v_fma_f32 v168, v168, s98, v186
    v_mfma_f32_16x16x32_bf16 v[172:175], a[160:163], a[96:99], 0
    ds_read_b64_tr_b16 a[230:231], v208 offset:40960
    v_fma_f32 v169, v169, s98, v186
    v_mfma_f32_16x16x32_bf16 v[172:175], a[164:167], a[100:103], v[172:175]
    v_exp_f32 v168, v168
    v_mfma_f32_16x16x32_bf16 v[172:175], a[168:171], a[104:107], v[172:175]
    ds_read_b64_tr_b16 a[232:233], v209 offset:32768
    v_fma_f32 v170, v170, s98, v186
    v_mfma_f32_16x16x32_bf16 v[172:175], a[172:175], a[108:111], v[172:175]
    ds_read_b64_tr_b16 a[234:235], v209 offset:40960
    v_fma_f32 v171, v171, s98, v186
    v_mfma_f32_16x16x32_bf16 v[172:175], a[176:179], a[112:115], v[172:175]
    v_exp_f32 v169, v169
    v_mfma_f32_16x16x32_bf16 v[172:175], a[180:183], a[116:119], v[172:175]
    v_exp_f32 v170, v170
    v_mfma_f32_16x16x32_bf16 v[172:175], a[184:187], a[120:123], v[172:175]
    buffer_load_dwordx4 v213, s[40:43], s93 offen offset:1024 nt lds
    v_mfma_f32_16x16x32_bf16 v[172:175], a[188:191], a[124:127], v[172:175]
    v_add_f32 v191, v191, v168
    v_cvt_pk_bf16_f32 v180, v168, v169
    v_mfma_f32_16x16x32_bf16 v[140:143], a[224:227], a[208:211], v[140:143]
    v_exp_f32 v171, v171
    v_mfma_f32_16x16x32_bf16 v[108:111], a[224:227], a[204:207], v[108:111]
    ds_read_b64_tr_b16 a[236:237], v210 offset:32768
    v_add_f32 v191, v191, v169
    v_mfma_f32_16x16x32_bf16 v[76:79], a[224:227], a[200:203], v[76:79]
    v_add_f32 v191, v191, v170
    v_cvt_pk_bf16_f32 v181, v170, v171
    v_mfma_f32_16x16x32_bf16 v[44:47], a[224:227], a[196:199], v[44:47]
    ds_read_b64_tr_b16 a[238:239], v210 offset:40960
    v_add_f32 v191, v191, v171
    v_mfma_f32_16x16x32_bf16 v[12:15], a[224:227], a[192:195], v[12:15]
    ds_write_b64 v220, v[180:181] offset:12288
    v_mfma_f32_16x16x32_bf16 v[176:179], a[160:163], a[128:131], 0
    ds_read_b64_tr_b16 a[240:241], v211 offset:32768
    v_fma_f32 v172, v172, s98, v187
    v_mfma_f32_16x16x32_bf16 v[176:179], a[164:167], a[132:135], v[176:179]
    ds_read_b64_tr_b16 a[242:243], v211 offset:40960
    v_fma_f32 v173, v173, s98, v187
    v_mfma_f32_16x16x32_bf16 v[176:179], a[168:171], a[136:139], v[176:179]
    v_exp_f32 v172, v172
    v_mfma_f32_16x16x32_bf16 v[176:179], a[172:175], a[140:143], v[176:179]
    buffer_load_dwordx4 v214, s[40:43], s93 offen offset:2048 nt lds
    v_mfma_f32_16x16x32_bf16 v[176:179], a[176:179], a[144:147], v[176:179]
    v_fma_f32 v174, v174, s98, v187
    v_fma_f32 v175, v175, s98, v187
    v_mfma_f32_16x16x32_bf16 v[176:179], a[180:183], a[148:151], v[176:179]
    v_exp_f32 v173, v173
    v_mfma_f32_16x16x32_bf16 v[176:179], a[184:187], a[152:155], v[176:179]
    v_exp_f32 v174, v174
    v_mfma_f32_16x16x32_bf16 v[176:179], a[188:191], a[156:159], v[176:179]
    s_waitcnt lgkmcnt(2)
    buffer_load_dwordx4 v215, s[40:43], s93 offen offset:3072 nt lds
    v_mfma_f32_16x16x32_bf16 v[16:19], a[228:231], a[192:195], v[16:19]
    v_add_f32 v192, v192, v172
    v_cvt_pk_bf16_f32 v182, v172, v173
    v_mfma_f32_16x16x32_bf16 v[48:51], a[228:231], a[196:199], v[48:51]
    v_exp_f32 v175, v175
    v_mfma_f32_16x16x32_bf16 v[80:83], a[228:231], a[200:203], v[80:83]
    v_add_f32 v192, v192, v173
    v_add_f32 v192, v192, v174
    v_mfma_f32_16x16x32_bf16 v[112:115], a[228:231], a[204:207], v[112:115]
    v_cvt_pk_bf16_f32 v183, v174, v175
    v_add_f32 v192, v192, v175
    v_mfma_f32_16x16x32_bf16 v[144:147], a[228:231], a[208:211], v[144:147]
    ds_write_b64 v220, v[182:183] offset:13312
    v_mfma_f32_16x16x32_bf16 v[148:151], a[232:235], a[208:211], v[148:151]
    v_fma_f32 v176, v176, s98, v188
    v_fma_f32 v177, v177, s98, v188
    v_mfma_f32_16x16x32_bf16 v[116:119], a[232:235], a[204:207], v[116:119]
    v_exp_f32 v176, v176
    v_mfma_f32_16x16x32_bf16 v[84:87], a[232:235], a[200:203], v[84:87]
    s_add_u32 s93, s93, 16384
    v_fma_f32 v178, v178, s98, v188
    v_fma_f32 v179, v179, s98, v188
    v_mfma_f32_16x16x32_bf16 v[52:55], a[232:235], a[196:199], v[52:55]
    v_exp_f32 v177, v177
    v_mfma_f32_16x16x32_bf16 v[20:23], a[232:235], a[192:195], v[20:23]
    v_exp_f32 v178, v178
    v_mfma_f32_16x16x32_bf16 v[24:27], a[236:239], a[192:195], v[24:27]
    v_add_f32 v193, v193, v176
    v_cvt_pk_bf16_f32 v180, v176, v177
    v_mfma_f32_16x16x32_bf16 v[56:59], a[236:239], a[196:199], v[56:59]
    v_exp_f32 v179, v179
    v_mfma_f32_16x16x32_bf16 v[88:91], a[236:239], a[200:203], v[88:91]
    v_add_f32 v193, v193, v177
    v_add_f32 v193, v193, v178
    v_cvt_pk_bf16_f32 v181, v178, v179
    v_add_f32 v193, v193, v179
    ds_write_b64 v220, v[180:181] offset:14336
    s_waitcnt vmcnt(4) lgkmcnt(0)
    s_barrier
    ds_read_b128 a[160:163], v200 offset:0
    v_mfma_f32_16x16x32_bf16 v[120:123], a[236:239], a[204:207], v[120:123]
    ds_read_b128 a[164:167], v201 offset:0
    ds_read_b128 a[168:171], v202 offset:0
    v_mfma_f32_16x16x32_bf16 v[152:155], a[236:239], a[208:211], v[152:155]
    ds_read_b128 a[172:175], v203 offset:0
    v_mfma_f32_16x16x32_bf16 v[156:159], a[240:243], a[208:211], v[156:159]
    ds_read_b128 a[176:179], v245 offset:0
    v_mfma_f32_16x16x32_bf16 v[124:127], a[240:243], a[204:207], v[124:127]
    ds_read_b128 a[180:183], v246 offset:0
    v_mfma_f32_16x16x32_bf16 v[92:95], a[240:243], a[200:203], v[92:95]
    ds_read_b128 a[184:187], v247 offset:0
    v_mfma_f32_16x16x32_bf16 v[60:63], a[240:243], a[196:199], v[60:63]
L_pg4:
    s_cbranch_execz L_pg8
    ds_read_b128 a[188:191], v248 offset:0
    v_mfma_f32_16x16x32_bf16 v[28:31], a[240:243], a[192:195], v[28:31]
    s_waitcnt lgkmcnt(7)
    v_mfma_f32_16x16x32_bf16 v[160:163], a[160:163], a[0:3], 0
    s_waitcnt lgkmcnt(6)
    v_mfma_f32_16x16x32_bf16 v[160:163], a[164:167], a[4:7], v[160:163]
    s_waitcnt lgkmcnt(5)
    v_mfma_f32_16x16x32_bf16 v[160:163], a[168:171], a[8:11], v[160:163]
    s_waitcnt lgkmcnt(4)
    ds_read_b128 a[192:195], v221 offset:10240
    v_mfma_f32_16x16x32_bf16 v[160:163], a[172:175], a[12:15], v[160:163]
    s_waitcnt lgkmcnt(4)
    ds_read_b64_tr_b16 a[212:213], v204 offset:49152
    s_add_u32 m0, s92, 0
    v_mfma_f32_16x16x32_bf16 v[160:163], a[176:179], a[16:19], v[160:163]
    s_waitcnt lgkmcnt(4)
    buffer_load_dwordx4 v216, s[44:47], s94 offen offset:0 nt lds
    v_mfma_f32_16x16x32_bf16 v[160:163], a[180:183], a[20:23], v[160:163]
    s_waitcnt lgkmcnt(3)
    ds_read_b64_tr_b16 a[214:215], v204 offset:57344
    ds_read_b128 a[196:199], v221 offset:11264
    v_mfma_f32_16x16x32_bf16 v[160:163], a[184:187], a[24:27], v[160:163]
    s_waitcnt lgkmcnt(4)
    v_mfma_f32_16x16x32_bf16 v[160:163], a[188:191], a[28:31], v[160:163]
    ds_read_b128 a[200:203], v221 offset:12288
    v_mfma_f32_16x16x32_bf16 v[164:167], a[160:163], a[32:35], 0
    ds_read_b128 a[204:207], v221 offset:13312
    v_mfma_f32_16x16x32_bf16 v[164:167], a[164:167], a[36:39], v[164:167]
    buffer_load_dwordx4 v217, s[44:47], s94 offen offset:1024 nt lds
    v_mfma_f32_16x16x32_bf16 v[164:167], a[168:171], a[40:43], v[164:167]
    ds_read_b128 a[208:211], v221 offset:14336
    ds_read_b64_tr_b16 a[216:217], v205 offset:49152
    v_mfma_f32_16x16x32_bf16 v[164:167], a[172:175], a[44:47], v[164:167]
    ds_read_b64_tr_b16 a[218:219], v205 offset:57344
    v_fma_f32 v160, v160, s98, v184
    v_mfma_f32_16x16x32_bf16 v[164:167], a[176:179], a[48:51], v[164:167]
    ds_read_b64_tr_b16 a[220:221], v206 offset:49152
    v_fma_f32 v161, v161, s98, v184
    v_mfma_f32_16x16x32_bf16 v[164:167], a[180:183], a[52:55], v[164:167]
    v_exp_f32 v160, v160
    v_mfma_f32_16x16x32_bf16 v[164:167], a[184:187], a[56:59], v[164:167]
    ds_read_b64_tr_b16 a[222:223], v206 offset:57344
    v_fma_f32 v162, v162, s98, v184
    v_mfma_f32_16x16x32_bf16 v[164:167], a[188:191], a[60:63], v[164:167]
    s_waitcnt lgkmcnt(6)
    v_fma_f32 v163, v163, s98, v184
    v_mfma_f32_16x16x32_bf16 v[0:3], a[212:215], a[192:195], v[0:3]
    v_exp_f32 v161, v161
    v_mfma_f32_16x16x32_bf16 v[32:35], a[212:215], a[196:199], v[32:35]
    v_exp_f32 v162, v162
    v_mfma_f32_16x16x32_bf16 v[64:67], a[212:215], a[200:203], v[64:67]
    s_waitcnt lgkmcnt(3)
    buffer_load_dwordx4 v218, s[44:47], s94 offen offset:2048 nt lds
    v_mfma_f32_16x16x32_bf16 v[96:99], a[212:215], a[204:207], v[96:99]
    v_add_f32 v189, v189, v160
    v_cvt_pk_bf16_f32 v180, v160, v161
    v_mfma_f32_16x16x32_bf16 v[128:131], a[212:215], a[208:211], v[128:131]
    s_waitcnt lgkmcnt(1)
    v_exp_f32 v163, v163
    v_mfma_f32_16x16x32_bf16 v[132:135], a[216:219], a[208:211], v[132:135]
    v_add_f32 v189, v189, v161
    v_add_f32 v189, v189, v162
    v_mfma_f32_16x16x32_bf16 v[100:103], a[216:219], a[204:207], v[100:103]
    v_cvt_pk_bf16_f32 v181, v162, v163
    v_add_f32 v189, v189, v163
    v_mfma_f32_16x16x32_bf16 v[68:71], a[216:219], a[200:203], v[68:71]
    ds_write_b64 v220, v[180:181] offset:0
    v_mfma_f32_16x16x32_bf16 v[36:39], a[216:219], a[196:199], v[36:39]
    ds_read_b64_tr_b16 a[224:225], v207 offset:49152
    v_fma_f32 v164, v164, s98, v185
    v_mfma_f32_16x16x32_bf16 v[4:7], a[216:219], a[192:195], v[4:7]
    ds_read_b64_tr_b16 a[226:227], v207 offset:57344
    v_fma_f32 v165, v165, s98, v185
    v_mfma_f32_16x16x32_bf16 v[168:171], a[160:163], a[64:67], 0
    v_exp_f32 v164, v164
    v_mfma_f32_16x16x32_bf16 v[168:171], a[164:167], a[68:71], v[168:171]
    buffer_load_dwordx4 v219, s[44:47], s94 offen offset:3072 nt lds
    v_mfma_f32_16x16x32_bf16 v[168:171], a[168:171], a[72:75], v[168:171]
    v_fma_f32 v166, v166, s98, v185
    v_fma_f32 v167, v167, s98, v185
    v_mfma_f32_16x16x32_bf16 v[168:171], a[172:175], a[76:79], v[168:171]
    v_exp_f32 v165, v165
    v_mfma_f32_16x16x32_bf16 v[168:171], a[176:179], a[80:83], v[168:171]
    v_exp_f32 v166, v166
    v_mfma_f32_16x16x32_bf16 v[168:171], a[180:183], a[84:87], v[168:171]
    v_add_f32 v190, v190, v164
    v_cvt_pk_bf16_f32 v182, v164, v165
    v_mfma_f32_16x16x32_bf16 v[168:171], a[184:187], a[88:91], v[168:171]
    v_exp_f32 v167, v167
    v_mfma_f32_16x16x32_bf16 v[168:171], a[188:191], a[92:95], v[168:171]
    s_waitcnt lgkmcnt(0)
    v_add_f32 v190, v190, v165
    v_add_f32 v190, v190, v166
    v_mfma_f32_16x16x32_bf16 v[8:11], a[220:223], a[192:195], v[8:11]
    s_add_u32 s94, s94, 16384
    v_cvt_pk_bf16_f32 v183, v166, v167
    v_mfma_f32_16x16x32_bf16 v[40:43], a[220:223], a[196:199], v[40:43]
    v_add_f32 v190, v190, v167
    v_mfma_f32_16x16x32_bf16 v[72:75], a[220:223], a[200:203], v[72:75]
    s_add_u32 m0, s92, 98304
    ds_write_b64 v220, v[182:183] offset:1024
    v_mfma_f32_16x16x32_bf16 v[104:107], a[220:223], a[204:207], v[104:107]
    buffer_load_dwordx4 v212, s[40:43], s93 offen offset:0 nt lds
    v_mfma_f32_16x16x32_bf16 v[136:139], a[220:223], a[208:211], v[136:139]
    ds_read_b64_tr_b16 a[228:229], v208 offset:49152
    v_fma_f32 v168, v168, s98, v186
    v_mfma_f32_16x16x32_bf16 v[172:175], a[160:163], a[96:99], 0
    ds_read_b64_tr_b16 a[230:231], v208 offset:57344
    v_fma_f32 v169, v169, s98, v186
    v_mfma_f32_16x16x32_bf16 v[172:175], a[164:167], a[100:103], v[172:175]
    v_exp_f32 v168, v168
    v_mfma_f32_16x16x32_bf16 v[172:175], a[168:171], a[104:107], v[172:175]
    ds_read_b64_tr_b16 a[232:233], v209 offset:49152
    v_fma_f32 v170, v170, s98, v186
    v_mfma_f32_16x16x32_bf16 v[172:175], a[172:175], a[108:111], v[172:175]
    ds_read_b64_tr_b16 a[234:235], v209 offset:57344
    v_fma_f32 v171, v171, s98, v186
    v_mfma_f32_16x16x32_bf16 v[172:175], a[176:179], a[112:115], v[172:175]
    v_exp_f32 v169, v169
    v_mfma_f32_16x16x32_bf16 v[172:175], a[180:183], a[116:119], v[172:175]
    v_exp_f32 v170, v170
    v_mfma_f32_16x16x32_bf16 v[172:175], a[184:187], a[120:123], v[172:175]
    buffer_load_dwordx4 v213, s[40:43], s93 offen offset:1024 nt lds
    v_mfma_f32_16x16x32_bf16 v[172:175], a[188:191], a[124:127], v[172:175]
    v_add_f32 v191, v191, v168
    v_cvt_pk_bf16_f32 v180, v168, v169
    v_mfma_f32_16x16x32_bf16 v[140:143], a[224:227], a[208:211], v[140:143]
    v_exp_f32 v171, v171
    v_mfma_f32_16x16x32_bf16 v[108:111], a[224:227], a[204:207], v[108:111]
    ds_read_b64_tr_b16 a[236:237], v210 offset:49152
    v_add_f32 v191, v191, v169
    v_mfma_f32_16x16x32_bf16 v[76:79], a[224:227], a[200:203], v[76:79]
    v_add_f32 v191, v191, v170
    v_cvt_pk_bf16_f32 v181, v170, v171
    v_mfma_f32_16x16x32_bf16 v[44:47], a[224:227], a[196:199], v[44:47]
    ds_read_b64_tr_b16 a[238:239], v210 offset:57344
    v_add_f32 v191, v191, v171
    v_mfma_f32_16x16x32_bf16 v[12:15], a[224:227], a[192:195], v[12:15]
    ds_write_b64 v220, v[180:181] offset:2048
    v_mfma_f32_16x16x32_bf16 v[176:179], a[160:163], a[128:131], 0
    ds_read_b64_tr_b16 a[240:241], v211 offset:49152
    v_fma_f32 v172, v172, s98, v187
    v_mfma_f32_16x16x32_bf16 v[176:179], a[164:167], a[132:135], v[176:179]
    ds_read_b64_tr_b16 a[242:243], v211 offset:57344
    v_fma_f32 v173, v173, s98, v187
    v_mfma_f32_16x16x32_bf16 v[176:179], a[168:171], a[136:139], v[176:179]
    v_exp_f32 v172, v172
    v_mfma_f32_16x16x32_bf16 v[176:179], a[172:175], a[140:143], v[176:179]
    buffer_load_dwordx4 v214, s[40:43], s93 offen offset:2048 nt lds
    v_mfma_f32_16x16x32_bf16 v[176:179], a[176:179], a[144:147], v[176:179]
    v_fma_f32 v174, v174, s98, v187
    v_fma_f32 v175, v175, s98, v187
    v_mfma_f32_16x16x32_bf16 v[176:179], a[180:183], a[148:151], v[176:179]
    v_exp_f32 v173, v173
    v_mfma_f32_16x16x32_bf16 v[176:179], a[184:187], a[152:155], v[176:179]
    v_exp_f32 v174, v174
    v_mfma_f32_16x16x32_bf16 v[176:179], a[188:191], a[156:159], v[176:179]
    s_waitcnt lgkmcnt(2)
    buffer_load_dwordx4 v215, s[40:43], s93 offen offset:3072 nt lds
    v_mfma_f32_16x16x32_bf16 v[16:19], a[228:231], a[192:195], v[16:19]
    v_add_f32 v192, v192, v172
    v_cvt_pk_bf16_f32 v182, v172, v173
    v_mfma_f32_16x16x32_bf16 v[48:51], a[228:231], a[196:199], v[48:51]
    v_exp_f32 v175, v175
    v_mfma_f32_16x16x32_bf16 v[80:83], a[228:231], a[200:203], v[80:83]
    v_add_f32 v192, v192, v173
    v_add_f32 v192, v192, v174
    v_mfma_f32_16x16x32_bf16 v[112:115], a[228:231], a[204:207], v[112:115]
    v_cvt_pk_bf16_f32 v183, v174, v175
    v_add_f32 v192, v192, v175
    v_mfma_f32_16x16x32_bf16 v[144:147], a[228:231], a[208:211], v[144:147]
    ds_write_b64 v220, v[182:183] offset:3072
    v_mfma_f32_16x16x32_bf16 v[148:151], a[232:235], a[208:211], v[148:151]
    v_fma_f32 v176, v176, s98, v188
    v_fma_f32 v177, v177, s98, v188
    v_mfma_f32_16x16x32_bf16 v[116:119], a[232:235], a[204:207], v[116:119]
    v_exp_f32 v176, v176
    v_mfma_f32_16x16x32_bf16 v[84:87], a[232:235], a[200:203], v[84:87]
    s_add_u32 s93, s93, 16384
    v_fma_f32 v178, v178, s98, v188
    v_fma_f32 v179, v179, s98, v188
    v_mfma_f32_16x16x32_bf16 v[52:55], a[232:235], a[196:199], v[52:55]
    v_exp_f32 v177, v177
    v_mfma_f32_16x16x32_bf16 v[20:23], a[232:235], a[192:195], v[20:23]
    v_exp_f32 v178, v178
    v_mfma_f32_16x16x32_bf16 v[24:27], a[236:239], a[192:195], v[24:27]
    v_add_f32 v193, v193, v176
    v_cvt_pk_bf16_f32 v180, v176, v177
    v_mfma_f32_16x16x32_bf16 v[56:59], a[236:239], a[196:199], v[56:59]
    v_exp_f32 v179, v179
    v_mfma_f32_16x16x32_bf16 v[88:91], a[236:239], a[200:203], v[88:91]
    v_add_f32 v193, v193, v177
    v_add_f32 v193, v193, v178
    v_cvt_pk_bf16_f32 v181, v178, v179
    v_add_f32 v193, v193, v179
    ds_write_b64 v220, v[180:181] offset:4096
    s_waitcnt vmcnt(4) lgkmcnt(0)
    s_barrier
    ds_read_b128 a[160:163], v200 offset:16384
    v_mfma_f32_16x16x32_bf16 v[120:123], a[236:239], a[204:207], v[120:123]
    ds_read_b128 a[164:167], v201 offset:16384
    ds_read_b128 a[168:171], v202 offset:16384
    v_mfma_f32_16x16x32_bf16 v[152:155], a[236:239], a[208:211], v[152:155]
    ds_read_b128 a[172:175], v203 offset:16384
    v_mfma_f32_16x16x32_bf16 v[156:159], a[240:243], a[208:211], v[156:159]
    ds_read_b128 a[176:179], v245 offset:16384
    v_mfma_f32_16x16x32_bf16 v[124:127], a[240:243], a[204:207], v[124:127]
    ds_read_b128 a[180:183], v246 offset:16384
    v_mfma_f32_16x16x32_bf16 v[92:95], a[240:243], a[200:203], v[92:95]
    ds_read_b128 a[184:187], v247 offset:16384
    v_mfma_f32_16x16x32_bf16 v[60:63], a[240:243], a[196:199], v[60:63]
    ds_read_b128 a[188:191], v248 offset:16384
    v_mfma_f32_16x16x32_bf16 v[28:31], a[240:243], a[192:195], v[28:31]
    s_waitcnt lgkmcnt(7)
    v_mfma_f32_16x16x32_bf16 v[160:163], a[160:163], a[0:3], 0
    s_waitcnt lgkmcnt(6)
    v_mfma_f32_16x16x32_bf16 v[160:163], a[164:167], a[4:7], v[160:163]
    s_waitcnt lgkmcnt(5)
    v_mfma_f32_16x16x32_bf16 v[160:163], a[168:171], a[8:11], v[160:163]
    s_waitcnt lgkmcnt(4)
    ds_read_b128 a[192:195], v221 offset:0
    v_mfma_f32_16x16x32_bf16 v[160:163], a[172:175], a[12:15], v[160:163]
    s_waitcnt lgkmcnt(4)
    ds_read_b64_tr_b16 a[212:213], v204 offset:0
    s_add_u32 m0, s92, 16384
    v_mfma_f32_16x16x32_bf16 v[160:163], a[176:179], a[16:19], v[160:163]
    s_waitcnt lgkmcnt(4)
    buffer_load_dwordx4 v216, s[44:47], s94 offen offset:0 nt lds
    v_mfma_f32_16x16x32_bf16 v[160:163], a[180:183], a[20:23], v[160:163]
    s_waitcnt lgkmcnt(3)
    ds_read_b64_tr_b16 a[214:215], v204 offset:8192
    ds_read_b128 a[196:199], v221 offset:1024
    v_mfma_f32_16x16x32_bf16 v[160:163], a[184:187], a[24:27], v[160:163]
    s_waitcnt lgkmcnt(4)
    v_mfma_f32_16x16x32_bf16 v[160:163], a[188:191], a[28:31], v[160:163]
    ds_read_b128 a[200:203], v221 offset:2048
    v_mfma_f32_16x16x32_bf16 v[164:167], a[160:163], a[32:35], 0
    ds_read_b128 a[204:207], v221 offset:3072
    v_mfma_f32_16x16x32_bf16 v[164:167], a[164:167], a[36:39], v[164:167]
    buffer_load_dwordx4 v217, s[44:47], s94 offen offset:1024 nt lds
    v_mfma_f32_16x16x32_bf16 v[164:167], a[168:171], a[40:43], v[164:167]
    ds_read_b128 a[208:211], v221 offset:4096
    ds_read_b64_tr_b16 a[216:217], v205 offset:0
    v_mfma_f32_16x16x32_bf16 v[164:167], a[172:175], a[44:47], v[164:167]
    ds_read_b64_tr_b16 a[218:219], v205 offset:8192
    v_fma_f32 v160, v160, s98, v184
    v_mfma_f32_16x16x32_bf16 v[164:167], a[176:179], a[48:51], v[164:167]
    ds_read_b64_tr_b16 a[220:221], v206 offset:0
    v_fma_f32 v161, v161, s98, v184
    v_mfma_f32_16x16x32_bf16 v[164:167], a[180:183], a[52:55], v[164:167]
    v_exp_f32 v160, v160
    v_mfma_f32_16x16x32_bf16 v[164:167], a[184:187], a[56:59], v[164:167]
    ds_read_b64_tr_b16 a[222:223], v206 offset:8192
    v_fma_f32 v162, v162, s98, v184
    v_mfma_f32_16x16x32_bf16 v[164:167], a[188:191], a[60:63], v[164:167]
    s_waitcnt lgkmcnt(6)
    v_fma_f32 v163, v163, s98, v184
    v_mfma_f32_16x16x32_bf16 v[0:3], a[212:215], a[192:195], v[0:3]
    v_exp_f32 v161, v161
    v_mfma_f32_16x16x32_bf16 v[32:35], a[212:215], a[196:199], v[32:35]
    v_exp_f32 v162, v162
    v_mfma_f32_16x16x32_bf16 v[64:67], a[212:215], a[200:203], v[64:67]
    s_waitcnt lgkmcnt(3)
    buffer_load_dwordx4 v218, s[44:47], s94 offen offset:2048 nt lds
    v_mfma_f32_16x16x32_bf16 v[96:99], a[212:215], a[204:207], v[96:99]
    v_add_f32 v189, v189, v160
    v_cvt_pk_bf16_f32 v180, v160, v161
    v_mfma_f32_16x16x32_bf16 v[128:131], a[212:215], a[208:211], v[128:131]
    s_waitcnt lgkmcnt(1)
    v_exp_f32 v163, v163
    v_mfma_f32_16x16x32_bf16 v[132:135], a[216:219], a[208:211], v[132:135]
    v_add_f32 v189, v189, v161
    v_add_f32 v189, v189, v162
    v_mfma_f32_16x16x32_bf16 v[100:103], a[216:219], a[204:207], v[100:103]
    v_cvt_pk_bf16_f32 v181, v162, v163
    v_add_f32 v189, v189, v163
    v_mfma_f32_16x16x32_bf16 v[68:71], a[216:219], a[200:203], v[68:71]
    ds_write_b64 v220, v[180:181] offset:10240
    v_mfma_f32_16x16x32_bf16 v[36:39], a[216:219], a[196:199], v[36:39]
    ds_read_b64_tr_b16 a[224:225], v207 offset:0
    v_fma_f32 v164, v164, s98, v185
    v_mfma_f32_16x16x32_bf16 v[4:7], a[216:219], a[192:195], v[4:7]
    ds_read_b64_tr_b16 a[226:227], v207 offset:8192
    v_fma_f32 v165, v165, s98, v185
    v_mfma_f32_16x16x32_bf16 v[168:171], a[160:163], a[64:67], 0
    v_exp_f32 v164, v164
    v_mfma_f32_16x16x32_bf16 v[168:171], a[164:167], a[68:71], v[168:171]
    buffer_load_dwordx4 v219, s[44:47], s94 offen offset:3072 nt lds
    v_mfma_f32_16x16x32_bf16 v[168:171], a[168:171], a[72:75], v[168:171]
    v_fma_f32 v166, v166, s98, v185
    v_fma_f32 v167, v167, s98, v185
    v_mfma_f32_16x16x32_bf16 v[168:171], a[172:175], a[76:79], v[168:171]
    v_exp_f32 v165, v165
    v_mfma_f32_16x16x32_bf16 v[168:171], a[176:179], a[80:83], v[168:171]
    v_exp_f32 v166, v166
    v_mfma_f32_16x16x32_bf16 v[168:171], a[180:183], a[84:87], v[168:171]
    v_add_f32 v190, v190, v164
    v_cvt_pk_bf16_f32 v182, v164, v165
    v_mfma_f32_16x16x32_bf16 v[168:171], a[184:187], a[88:91], v[168:171]
    v_exp_f32 v167, v167
    v_mfma_f32_16x16x32_bf16 v[168:171], a[188:191], a[92:95], v[168:171]
    s_waitcnt lgkmcnt(0)
    v_add_f32 v190, v190, v165
    v_add_f32 v190, v190, v166
    v_mfma_f32_16x16x32_bf16 v[8:11], a[220:223], a[192:195], v[8:11]
    s_add_u32 s94, s94, 16384
    v_cvt_pk_bf16_f32 v183, v166, v167
    v_mfma_f32_16x16x32_bf16 v[40:43], a[220:223], a[196:199], v[40:43]
    v_add_f32 v190, v190, v167
    v_mfma_f32_16x16x32_bf16 v[72:75], a[220:223], a[200:203], v[72:75]
    s_add_u32 m0, s92, 114688
    ds_write_b64 v220, v[182:183] offset:11264
    v_mfma_f32_16x16x32_bf16 v[104:107], a[220:223], a[204:207], v[104:107]
    buffer_load_dwordx4 v212, s[40:43], s93 offen offset:0 nt lds
    v_mfma_f32_16x16x32_bf16 v[136:139], a[220:223], a[208:211], v[136:139]
    ds_read_b64_tr_b16 a[228:229], v208 offset:0
    v_fma_f32 v168, v168, s98, v186
    v_mfma_f32_16x16x32_bf16 v[172:175], a[160:163], a[96:99], 0
    ds_read_b64_tr_b16 a[230:231], v208 offset:8192
    v_fma_f32 v169, v169, s98, v186
    v_mfma_f32_16x16x32_bf16 v[172:175], a[164:167], a[100:103], v[172:175]
    v_exp_f32 v168, v168
    v_mfma_f32_16x16x32_bf16 v[172:175], a[168:171], a[104:107], v[172:175]
    ds_read_b64_tr_b16 a[232:233], v209 offset:0
    v_fma_f32 v170, v170, s98, v186
    v_mfma_f32_16x16x32_bf16 v[172:175], a[172:175], a[108:111], v[172:175]
    ds_read_b64_tr_b16 a[234:235], v209 offset:8192
    v_fma_f32 v171, v171, s98, v186
    v_mfma_f32_16x16x32_bf16 v[172:175], a[176:179], a[112:115], v[172:175]
    v_exp_f32 v169, v169
    v_mfma_f32_16x16x32_bf16 v[172:175], a[180:183], a[116:119], v[172:175]
    v_exp_f32 v170, v170
    v_mfma_f32_16x16x32_bf16 v[172:175], a[184:187], a[120:123], v[172:175]
    buffer_load_dwordx4 v213, s[40:43], s93 offen offset:1024 nt lds
    v_mfma_f32_16x16x32_bf16 v[172:175], a[188:191], a[124:127], v[172:175]
    v_add_f32 v191, v191, v168
    v_cvt_pk_bf16_f32 v180, v168, v169
    v_mfma_f32_16x16x32_bf16 v[140:143], a[224:227], a[208:211], v[140:143]
    v_exp_f32 v171, v171
    v_mfma_f32_16x16x32_bf16 v[108:111], a[224:227], a[204:207], v[108:111]
    ds_read_b64_tr_b16 a[236:237], v210 offset:0
    v_add_f32 v191, v191, v169
    v_mfma_f32_16x16x32_bf16 v[76:79], a[224:227], a[200:203], v[76:79]
    v_add_f32 v191, v191, v170
    v_cvt_pk_bf16_f32 v181, v170, v171
    v_mfma_f32_16x16x32_bf16 v[44:47], a[224:227], a[196:199], v[44:47]
    ds_read_b64_tr_b16 a[238:239], v210 offset:8192
    v_add_f32 v191, v191, v171
    v_mfma_f32_16x16x32_bf16 v[12:15], a[224:227], a[192:195], v[12:15]
    ds_write_b64 v220, v[180:181] offset:12288
    v_mfma_f32_16x16x32_bf16 v[176:179], a[160:163], a[128:131], 0
    ds_read_b64_tr_b16 a[240:241], v211 offset:0
    v_fma_f32 v172, v172, s98, v187
    v_mfma_f32_16x16x32_bf16 v[176:179], a[164:167], a[132:135], v[176:179]
    ds_read_b64_tr_b16 a[242:243], v211 offset:8192
    v_fma_f32 v173, v173, s98, v187
    v_mfma_f32_16x16x32_bf16 v[176:179], a[168:171], a[136:139], v[176:179]
    v_exp_f32 v172, v172
    v_mfma_f32_16x16x32_bf16 v[176:179], a[172:175], a[140:143], v[176:179]
    buffer_load_dwordx4 v214, s[40:43], s93 offen offset:2048 nt lds
    v_mfma_f32_16x16x32_bf16 v[176:179], a[176:179], a[144:147], v[176:179]
    v_fma_f32 v174, v174, s98, v187
    v_fma_f32 v175, v175, s98, v187
    v_mfma_f32_16x16x32_bf16 v[176:179], a[180:183], a[148:151], v[176:179]
    v_exp_f32 v173, v173
    v_mfma_f32_16x16x32_bf16 v[176:179], a[184:187], a[152:155], v[176:179]
    v_exp_f32 v174, v174
    v_mfma_f32_16x16x32_bf16 v[176:179], a[188:191], a[156:159], v[176:179]
    s_waitcnt lgkmcnt(2)
    buffer_load_dwordx4 v215, s[40:43], s93 offen offset:3072 nt lds
    v_mfma_f32_16x16x32_bf16 v[16:19], a[228:231], a[192:195], v[16:19]
    v_add_f32 v192, v192, v172
    v_cvt_pk_bf16_f32 v182, v172, v173
    v_mfma_f32_16x16x32_bf16 v[48:51], a[228:231], a[196:199], v[48:51]
    v_exp_f32 v175, v175
    v_mfma_f32_16x16x32_bf16 v[80:83], a[228:231], a[200:203], v[80:83]
    v_add_f32 v192, v192, v173
    v_add_f32 v192, v192, v174
    v_mfma_f32_16x16x32_bf16 v[112:115], a[228:231], a[204:207], v[112:115]
    v_cvt_pk_bf16_f32 v183, v174, v175
    v_add_f32 v192, v192, v175
    v_mfma_f32_16x16x32_bf16 v[144:147], a[228:231], a[208:211], v[144:147]
    ds_write_b64 v220, v[182:183] offset:13312
    v_mfma_f32_16x16x32_bf16 v[148:151], a[232:235], a[208:211], v[148:151]
    v_fma_f32 v176, v176, s98, v188
    v_fma_f32 v177, v177, s98, v188
    v_mfma_f32_16x16x32_bf16 v[116:119], a[232:235], a[204:207], v[116:119]
    v_exp_f32 v176, v176
    v_mfma_f32_16x16x32_bf16 v[84:87], a[232:235], a[200:203], v[84:87]
    s_add_u32 s93, s93, 16384
    v_fma_f32 v178, v178, s98, v188
    v_fma_f32 v179, v179, s98, v188
    v_mfma_f32_16x16x32_bf16 v[52:55], a[232:235], a[196:199], v[52:55]
    v_exp_f32 v177, v177
    v_mfma_f32_16x16x32_bf16 v[20:23], a[232:235], a[192:195], v[20:23]
    v_exp_f32 v178, v178
    v_mfma_f32_16x16x32_bf16 v[24:27], a[236:239], a[192:195], v[24:27]
    v_add_f32 v193, v193, v176
    v_cvt_pk_bf16_f32 v180, v176, v177
    v_mfma_f32_16x16x32_bf16 v[56:59], a[236:239], a[196:199], v[56:59]
    v_exp_f32 v179, v179
    v_mfma_f32_16x16x32_bf16 v[88:91], a[236:239], a[200:203], v[88:91]
    v_add_f32 v193, v193, v177
    v_add_f32 v193, v193, v178
    v_cvt_pk_bf16_f32 v181, v178, v179
    v_add_f32 v193, v193, v179
    ds_write_b64 v220, v[180:181] offset:14336
    s_waitcnt vmcnt(4) lgkmcnt(0)
    s_barrier
    ds_read_b128 a[160:163], v200 offset:32768
    v_mfma_f32_16x16x32_bf16 v[120:123], a[236:239], a[204:207], v[120:123]
    ds_read_b128 a[164:167], v201 offset:32768
    ds_read_b128 a[168:171], v202 offset:32768
    v_mfma_f32_16x16x32_bf16 v[152:155], a[236:239], a[208:211], v[152:155]
    ds_read_b128 a[172:175], v203 offset:32768
    v_mfma_f32_16x16x32_bf16 v[156:159], a[240:243], a[208:211], v[156:159]
    ds_read_b128 a[176:179], v245 offset:32768
    v_mfma_f32_16x16x32_bf16 v[124:127], a[240:243], a[204:207], v[124:127]
    ds_read_b128 a[180:183], v246 offset:32768
    v_mfma_f32_16x16x32_bf16 v[92:95], a[240:243], a[200:203], v[92:95]
    ds_read_b128 a[184:187], v247 offset:32768
    v_mfma_f32_16x16x32_bf16 v[60:63], a[240:243], a[196:199], v[60:63]
    s_add_u32 s95, s95, 1
    ds_read_b128 a[188:191], v248 offset:32768
    v_mfma_f32_16x16x32_bf16 v[28:31], a[240:243], a[192:195], v[28:31]
    s_cmp_lt_u32 s95, 8
    s_cbranch_scc1 L_loop
L_tail:
    s_waitcnt lgkmcnt(7)
    v_mfma_f32_16x16x32_bf16 v[160:163], a[160:163], a[0:3], 0
    s_waitcnt lgkmcnt(6)
    v_mfma_f32_16x16x32_bf16 v[160:163], a[164:167], a[4:7], v[160:163]
    s_waitcnt lgkmcnt(5)
    v_mfma_f32_16x16x32_bf16 v[160:163], a[168:171], a[8:11], v[160:163]
    s_waitcnt lgkmcnt(4)
    ds_read_b128 a[192:195], v221 offset:10240
    v_mfma_f32_16x16x32_bf16 v[160:163], a[172:175], a[12:15], v[160:163]
    s_waitcnt lgkmcnt(4)
    ds_read_b64_tr_b16 a[212:213], v204 offset:16384
    s_add_u32 m0, s92, 32768
    v_mfma_f32_16x16x32_bf16 v[160:163], a[176:179], a[16:19], v[160:163]
    s_waitcnt lgkmcnt(4)
    buffer_load_dwordx4 v216, s[44:47], s94 offen offset:0 nt lds
    v_mfma_f32_16x16x32_bf16 v[160:163], a[180:183], a[20:23], v[160:163]
    s_waitcnt lgkmcnt(3)
    ds_read_b64_tr_b16 a[214:215], v204 offset:24576
    ds_read_b128 a[196:199], v221 offset:11264
    v_mfma_f32_16x16x32_bf16 v[160:163], a[184:187], a[24:27], v[160:163]
    s_waitcnt lgkmcnt(4)
    v_mfma_f32_16x16x32_bf16 v[160:163], a[188:191], a[28:31], v[160:163]
    ds_read_b128 a[200:203], v221 offset:12288
    v_mfma_f32_16x16x32_bf16 v[164:167], a[160:163], a[32:35], 0
    ds_read_b128 a[204:207], v221 offset:13312
    v_mfma_f32_16x16x32_bf16 v[164:167], a[164:167], a[36:39], v[164:167]
    buffer_load_dwordx4 v217, s[44:47], s94 offen offset:1024 nt lds
    v_mfma_f32_16x16x32_bf16 v[164:167], a[168:171], a[40:43], v[164:167]
    ds_read_b128 a[208:211], v221 offset:14336
    ds_read_b64_tr_b16 a[216:217], v205 offset:16384
    v_mfma_f32_16x16x32_bf16 v[164:167], a[172:175], a[44:47], v[164:167]
    ds_read_b64_tr_b16 a[218:219], v205 offset:24576
    v_fma_f32 v160, v160, s98, v184
    v_mfma_f32_16x16x32_bf16 v[164:167], a[176:179], a[48:51], v[164:167]
    ds_read_b64_tr_b16 a[220:221], v206 offset:16384
    v_fma_f32 v161, v161, s98, v184
    v_mfma_f32_16x16x32_bf16 v[164:167], a[180:183], a[52:55], v[164:167]
    v_exp_f32 v160, v160
    v_mfma_f32_16x16x32_bf16 v[164:167], a[184:187], a[56:59], v[164:167]
    ds_read_b64_tr_b16 a[222:223], v206 offset:24576
    v_fma_f32 v162, v162, s98, v184
    v_mfma_f32_16x16x32_bf16 v[164:167], a[188:191], a[60:63], v[164:167]
    s_waitcnt lgkmcnt(6)
    v_fma_f32 v163, v163, s98, v184
    v_mfma_f32_16x16x32_bf16 v[0:3], a[212:215], a[192:195], v[0:3]
    v_exp_f32 v161, v161
    v_mfma_f32_16x16x32_bf16 v[32:35], a[212:215], a[196:199], v[32:35]
    v_exp_f32 v162, v162
    v_mfma_f32_16x16x32_bf16 v[64:67], a[212:215], a[200:203], v[64:67]
    s_waitcnt lgkmcnt(3)
    buffer_load_dwordx4 v218, s[44:47], s94 offen offset:2048 nt lds
    v_mfma_f32_16x16x32_bf16 v[96:99], a[212:215], a[204:207], v[96:99]
    v_add_f32 v189, v189, v160
    v_cvt_pk_bf16_f32 v180, v160, v161
    v_mfma_f32_16x16x32_bf16 v[128:131], a[212:215], a[208:211], v[128:131]
    s_waitcnt lgkmcnt(1)
    v_exp_f32 v163, v163
    v_mfma_f32_16x16x32_bf16 v[132:135], a[216:219], a[208:211], v[132:135]
    v_add_f32 v189, v189, v161
    v_add_f32 v189, v189, v162
    v_mfma_f32_16x16x32_bf16 v[100:103], a[216:219], a[204:207], v[100:103]
    v_cvt_pk_bf16_f32 v181, v162, v163
    v_add_f32 v189, v189, v163
    v_mfma_f32_16x16x32_bf16 v[68:71], a[216:219], a[200:203], v[68:71]
    ds_write_b64 v220, v[180:181] offset:0
    v_mfma_f32_16x16x32_bf16 v[36:39], a[216:219], a[196:199], v[36:39]
    ds_read_b64_tr_b16 a[224:225], v207 offset:16384
    v_fma_f32 v164, v164, s98, v185
    v_mfma_f32_16x16x32_bf16 v[4:7], a[216:219], a[192:195], v[4:7]
    ds_read_b64_tr_b16 a[226:227], v207 offset:24576
    v_fma_f32 v165, v165, s98, v185
    v_mfma_f32_16x16x32_bf16 v[168:171], a[160:163], a[64:67], 0
    v_exp_f32 v164, v164
    v_mfma_f32_16x16x32_bf16 v[168:171], a[164:167], a[68:71], v[168:171]
    buffer_load_dwordx4 v219, s[44:47], s94 offen offset:3072 nt lds
    v_mfma_f32_16x16x32_bf16 v[168:171], a[168:171], a[72:75], v[168:171]
    v_fma_f32 v166, v166, s98, v185
    v_fma_f32 v167, v167, s98, v185
    v_mfma_f32_16x16x32_bf16 v[168:171], a[172:175], a[76:79], v[168:171]
    v_exp_f32 v165, v165
    v_mfma_f32_16x16x32_bf16 v[168:171], a[176:179], a[80:83], v[168:171]
    v_exp_f32 v166, v166
    v_mfma_f32_16x16x32_bf16 v[168:171], a[180:183], a[84:87], v[168:171]
    v_add_f32 v190, v190, v164
    v_cvt_pk_bf16_f32 v182, v164, v165
    v_mfma_f32_16x16x32_bf16 v[168:171], a[184:187], a[88:91], v[168:171]
    v_exp_f32 v167, v167
    v_mfma_f32_16x16x32_bf16 v[168:171], a[188:191], a[92:95], v[168:171]
    s_waitcnt lgkmcnt(0)
    v_add_f32 v190, v190, v165
    v_add_f32 v190, v190, v166
    v_mfma_f32_16x16x32_bf16 v[8:11], a[220:223], a[192:195], v[8:11]
    s_add_u32 s94, s94, 16384
    v_cvt_pk_bf16_f32 v183, v166, v167
    v_mfma_f32_16x16x32_bf16 v[40:43], a[220:223], a[196:199], v[40:43]
    v_add_f32 v190, v190, v167
    v_mfma_f32_16x16x32_bf16 v[72:75], a[220:223], a[200:203], v[72:75]
    s_add_u32 m0, s92, 49152
    ds_write_b64 v220, v[182:183] offset:1024
    v_mfma_f32_16x16x32_bf16 v[104:107], a[220:223], a[204:207], v[104:107]
    buffer_load_dwordx4 v216, s[44:47], s94 offen offset:0 nt lds
    v_mfma_f32_16x16x32_bf16 v[136:139], a[220:223], a[208:211], v[136:139]
    ds_read_b64_tr_b16 a[228:229], v208 offset:16384
    v_fma_f32 v168, v168, s98, v186
    v_mfma_f32_16x16x32_bf16 v[172:175], a[160:163], a[96:99], 0
    ds_read_b64_tr_b16 a[230:231], v208 offset:24576
    v_fma_f32 v169, v169, s98, v186
    v_mfma_f32_16x16x32_bf16 v[172:175], a[164:167], a[100:103], v[172:175]
    v_exp_f32 v168, v168
    v_mfma_f32_16x16x32_bf16 v[172:175], a[168:171], a[104:107], v[172:175]
    ds_read_b64_tr_b16 a[232:233], v209 offset:16384
    v_fma_f32 v170, v170, s98, v186
    v_mfma_f32_16x16x32_bf16 v[172:175], a[172:175], a[108:111], v[172:175]
    ds_read_b64_tr_b16 a[234:235], v209 offset:24576
    v_fma_f32 v171, v171, s98, v186
    v_mfma_f32_16x16x32_bf16 v[172:175], a[176:179], a[112:115], v[172:175]
    v_exp_f32 v169, v169
    v_mfma_f32_16x16x32_bf16 v[172:175], a[180:183], a[116:119], v[172:175]
    v_exp_f32 v170, v170
    v_mfma_f32_16x16x32_bf16 v[172:175], a[184:187], a[120:123], v[172:175]
    buffer_load_dwordx4 v217, s[44:47], s94 offen offset:1024 nt lds
    v_mfma_f32_16x16x32_bf16 v[172:175], a[188:191], a[124:127], v[172:175]
    v_add_f32 v191, v191, v168
    v_cvt_pk_bf16_f32 v180, v168, v169
    v_mfma_f32_16x16x32_bf16 v[140:143], a[224:227], a[208:211], v[140:143]
    v_exp_f32 v171, v171
    v_mfma_f32_16x16x32_bf16 v[108:111], a[224:227], a[204:207], v[108:111]
    ds_read_b64_tr_b16 a[236:237], v210 offset:16384
    v_add_f32 v191, v191, v169
    v_mfma_f32_16x16x32_bf16 v[76:79], a[224:227], a[200:203], v[76:79]
    v_add_f32 v191, v191, v170
    v_cvt_pk_bf16_f32 v181, v170, v171
    v_mfma_f32_16x16x32_bf16 v[44:47], a[224:227], a[196:199], v[44:47]
    ds_read_b64_tr_b16 a[238:239], v210 offset:24576
    v_add_f32 v191, v191, v171
    v_mfma_f32_16x16x32_bf16 v[12:15], a[224:227], a[192:195], v[12:15]
    ds_write_b64 v220, v[180:181] offset:2048
    v_mfma_f32_16x16x32_bf16 v[176:179], a[160:163], a[128:131], 0
    ds_read_b64_tr_b16 a[240:241], v211 offset:16384
    v_fma_f32 v172, v172, s98, v187
    v_mfma_f32_16x16x32_bf16 v[176:179], a[164:167], a[132:135], v[176:179]
    ds_read_b64_tr_b16 a[242:243], v211 offset:24576
    v_fma_f32 v173, v173, s98, v187
    v_mfma_f32_16x16x32_bf16 v[176:179], a[168:171], a[136:139], v[176:179]
    v_exp_f32 v172, v172
    v_mfma_f32_16x16x32_bf16 v[176:179], a[172:175], a[140:143], v[176:179]
    buffer_load_dwordx4 v218, s[44:47], s94 offen offset:2048 nt lds
    v_mfma_f32_16x16x32_bf16 v[176:179], a[176:179], a[144:147], v[176:179]
    v_fma_f32 v174, v174, s98, v187
    v_fma_f32 v175, v175, s98, v187
    v_mfma_f32_16x16x32_bf16 v[176:179], a[180:183], a[148:151], v[176:179]
    v_exp_f32 v173, v173
    v_mfma_f32_16x16x32_bf16 v[176:179], a[184:187], a[152:155], v[176:179]
    v_exp_f32 v174, v174
    v_mfma_f32_16x16x32_bf16 v[176:179], a[188:191], a[156:159], v[176:179]
    s_waitcnt lgkmcnt(2)
    buffer_load_dwordx4 v219, s[44:47], s94 offen offset:3072 nt lds
    v_mfma_f32_16x16x32_bf16 v[16:19], a[228:231], a[192:195], v[16:19]
    v_add_f32 v192, v192, v172
    v_cvt_pk_bf16_f32 v182, v172, v173
    v_mfma_f32_16x16x32_bf16 v[48:51], a[228:231], a[196:199], v[48:51]
L_pg5:
    s_cbranch_execz L_pg9
    v_exp_f32 v175, v175
    v_mfma_f32_16x16x32_bf16 v[80:83], a[228:231], a[200:203], v[80:83]
    v_add_f32 v192, v192, v173
    v_add_f32 v192, v192, v174
    v_mfma_f32_16x16x32_bf16 v[112:115], a[228:231], a[204:207], v[112:115]
    v_cvt_pk_bf16_f32 v183, v174, v175
    v_add_f32 v192, v192, v175
    v_mfma_f32_16x16x32_bf16 v[144:147], a[228:231], a[208:211], v[144:147]
    ds_write_b64 v220, v[182:183] offset:3072
    v_mfma_f32_16x16x32_bf16 v[148:151], a[232:235], a[208:211], v[148:151]
    v_fma_f32 v176, v176, s98, v188
    v_fma_f32 v177, v177, s98, v188
    v_mfma_f32_16x16x32_bf16 v[116:119], a[232:235], a[204:207], v[116:119]
    v_exp_f32 v176, v176
    v_mfma_f32_16x16x32_bf16 v[84:87], a[232:235], a[200:203], v[84:87]
    s_add_u32 s94, s94, 16384
    v_fma_f32 v178, v178, s98, v188
    v_fma_f32 v179, v179, s98, v188
    v_mfma_f32_16x16x32_bf16 v[52:55], a[232:235], a[196:199], v[52:55]
    v_exp_f32 v177, v177
    v_mfma_f32_16x16x32_bf16 v[20:23], a[232:235], a[192:195], v[20:23]
    v_exp_f32 v178, v178
    v_mfma_f32_16x16x32_bf16 v[24:27], a[236:239], a[192:195], v[24:27]
    v_add_f32 v193, v193, v176
    v_cvt_pk_bf16_f32 v180, v176, v177
    v_mfma_f32_16x16x32_bf16 v[56:59], a[236:239], a[196:199], v[56:59]
    v_exp_f32 v179, v179
    v_mfma_f32_16x16x32_bf16 v[88:91], a[236:239], a[200:203], v[88:91]
    v_add_f32 v193, v193, v177
    v_add_f32 v193, v193, v178
    v_cvt_pk_bf16_f32 v181, v178, v179
    v_add_f32 v193, v193, v179
    ds_write_b64 v220, v[180:181] offset:4096
    s_waitcnt vmcnt(4) lgkmcnt(0)
    s_barrier
    ds_read_b128 a[160:163], v200 offset:49152
    v_mfma_f32_16x16x32_bf16 v[120:123], a[236:239], a[204:207], v[120:123]
    ds_read_b128 a[164:167], v201 offset:49152
    ds_read_b128 a[168:171], v202 offset:49152
    v_mfma_f32_16x16x32_bf16 v[152:155], a[236:239], a[208:211], v[152:155]
    ds_read_b128 a[172:175], v203 offset:49152
    v_mfma_f32_16x16x32_bf16 v[156:159], a[240:243], a[208:211], v[156:159]
    ds_read_b128 a[176:179], v245 offset:49152
    v_mfma_f32_16x16x32_bf16 v[124:127], a[240:243], a[204:207], v[124:127]
    ds_read_b128 a[180:183], v246 offset:49152
    v_mfma_f32_16x16x32_bf16 v[92:95], a[240:243], a[200:203], v[92:95]
    ds_read_b128 a[184:187], v247 offset:49152
    v_mfma_f32_16x16x32_bf16 v[60:63], a[240:243], a[196:199], v[60:63]
    ds_read_b128 a[188:191], v248 offset:49152
    v_mfma_f32_16x16x32_bf16 v[28:31], a[240:243], a[192:195], v[28:31]
    s_waitcnt lgkmcnt(7)
    v_mfma_f32_16x16x32_bf16 v[160:163], a[160:163], a[0:3], 0
    s_waitcnt lgkmcnt(6)
    v_mfma_f32_16x16x32_bf16 v[160:163], a[164:167], a[4:7], v[160:163]
    s_waitcnt lgkmcnt(5)
    v_mfma_f32_16x16x32_bf16 v[160:163], a[168:171], a[8:11], v[160:163]
    s_waitcnt lgkmcnt(4)
    ds_read_b128 a[192:195], v221 offset:0
    v_mfma_f32_16x16x32_bf16 v[160:163], a[172:175], a[12:15], v[160:163]
    s_waitcnt lgkmcnt(4)
    ds_read_b64_tr_b16 a[212:213], v204 offset:32768
    v_mfma_f32_16x16x32_bf16 v[160:163], a[176:179], a[16:19], v[160:163]
    s_waitcnt lgkmcnt(4)
    ds_read_b64_tr_b16 a[214:215], v204 offset:40960
    v_mfma_f32_16x16x32_bf16 v[160:163], a[180:183], a[20:23], v[160:163]
    s_waitcnt lgkmcnt(4)
    ds_read_b128 a[196:199], v221 offset:1024
    v_mfma_f32_16x16x32_bf16 v[160:163], a[184:187], a[24:27], v[160:163]
    s_waitcnt lgkmcnt(4)
    ds_read_b128 a[200:203], v221 offset:2048
    v_mfma_f32_16x16x32_bf16 v[160:163], a[188:191], a[28:31], v[160:163]
    s_add_u32 m0, s92, 65536
    s_mov_b32 s97, 0
    v_mfma_f32_16x16x32_bf16 v[164:167], a[160:163], a[32:35], 0
    buffer_load_dwordx4 v223, s[48:51], s97 offen offset:0 lds
    v_mfma_f32_16x16x32_bf16 v[164:167], a[164:167], a[36:39], v[164:167]
    ds_read_b128 a[204:207], v221 offset:3072
    v_mfma_f32_16x16x32_bf16 v[164:167], a[168:171], a[40:43], v[164:167]
    ds_read_b128 a[208:211], v221 offset:4096
    v_mfma_f32_16x16x32_bf16 v[164:167], a[172:175], a[44:47], v[164:167]
    ds_read_b64_tr_b16 a[216:217], v205 offset:32768
    v_fma_f32 v160, v160, s98, v184
    v_mfma_f32_16x16x32_bf16 v[164:167], a[176:179], a[48:51], v[164:167]
    s_mov_b32 s97, 6144
    ds_read_b64_tr_b16 a[218:219], v205 offset:40960
    v_fma_f32 v161, v161, s98, v184
    v_mfma_f32_16x16x32_bf16 v[164:167], a[180:183], a[52:55], v[164:167]
    v_exp_f32 v160, v160
    v_mfma_f32_16x16x32_bf16 v[164:167], a[184:187], a[56:59], v[164:167]
    buffer_load_dwordx4 v223, s[48:51], s97 offen offset:1024 lds
    v_mfma_f32_16x16x32_bf16 v[164:167], a[188:191], a[60:63], v[164:167]
    s_waitcnt lgkmcnt(4)
    ds_read_b64_tr_b16 a[220:221], v206 offset:32768
    v_fma_f32 v162, v162, s98, v184
    v_mfma_f32_16x16x32_bf16 v[0:3], a[212:215], a[192:195], v[0:3]
    ds_read_b64_tr_b16 a[222:223], v206 offset:40960
    v_fma_f32 v163, v163, s98, v184
    v_mfma_f32_16x16x32_bf16 v[32:35], a[212:215], a[196:199], v[32:35]
    v_exp_f32 v161, v161
    v_mfma_f32_16x16x32_bf16 v[64:67], a[212:215], a[200:203], v[64:67]
    s_waitcnt lgkmcnt(4)
    v_exp_f32 v162, v162
    v_mfma_f32_16x16x32_bf16 v[96:99], a[212:215], a[204:207], v[96:99]
    v_add_f32 v189, v189, v160
    v_cvt_pk_bf16_f32 v180, v160, v161
    v_mfma_f32_16x16x32_bf16 v[128:131], a[212:215], a[208:211], v[128:131]
    s_waitcnt lgkmcnt(2)
    v_exp_f32 v163, v163
    v_mfma_f32_16x16x32_bf16 v[132:135], a[216:219], a[208:211], v[132:135]
    s_mov_b32 s97, 12288
    buffer_load_dwordx4 v223, s[48:51], s97 offen offset:2048 lds
    v_mfma_f32_16x16x32_bf16 v[100:103], a[216:219], a[204:207], v[100:103]
    v_add_f32 v189, v189, v161
    v_add_f32 v189, v189, v162
    v_mfma_f32_16x16x32_bf16 v[68:71], a[216:219], a[200:203], v[68:71]
    v_cvt_pk_bf16_f32 v181, v162, v163
    v_add_f32 v189, v189, v163
    v_mfma_f32_16x16x32_bf16 v[36:39], a[216:219], a[196:199], v[36:39]
    ds_write_b64 v220, v[180:181] offset:10240
    v_mfma_f32_16x16x32_bf16 v[4:7], a[216:219], a[192:195], v[4:7]
    ds_read_b64_tr_b16 a[224:225], v207 offset:32768
    v_mov_b32 v242, v189
    v_mfma_f32_16x16x32_bf16 v[168:171], a[160:163], a[64:67], 0
    s_nop 0
    v_permlane32_swap_b32 v242, v189
    v_mfma_f32_16x16x32_bf16 v[168:171], a[164:167], a[68:71], v[168:171]
    ds_read_b64_tr_b16 a[226:227], v207 offset:40960
    v_add_f32 v189, v189, v242
    v_mfma_f32_16x16x32_bf16 v[168:171], a[168:171], a[72:75], v[168:171]
    s_mov_b32 s97, 18432
    ds_write_b32 v224, v189 offset:0
    v_mfma_f32_16x16x32_bf16 v[168:171], a[172:175], a[76:79], v[168:171]
    buffer_load_dwordx4 v223, s[48:51], s97 offen offset:3072 lds
    v_mfma_f32_16x16x32_bf16 v[168:171], a[176:179], a[80:83], v[168:171]
    v_fma_f32 v164, v164, s98, v185
    v_fma_f32 v165, v165, s98, v185
    v_mfma_f32_16x16x32_bf16 v[168:171], a[180:183], a[84:87], v[168:171]
    v_exp_f32 v164, v164
    v_mfma_f32_16x16x32_bf16 v[168:171], a[184:187], a[88:91], v[168:171]
    v_fma_f32 v166, v166, s98, v185
    v_fma_f32 v167, v167, s98, v185
    v_mfma_f32_16x16x32_bf16 v[168:171], a[188:191], a[92:95], v[168:171]
    s_waitcnt lgkmcnt(2)
    v_exp_f32 v165, v165
    v_mfma_f32_16x16x32_bf16 v[8:11], a[220:223], a[192:195], v[8:11]
    v_exp_f32 v166, v166
    v_mfma_f32_16x16x32_bf16 v[40:43], a[220:223], a[196:199], v[40:43]
    v_add_f32 v190, v190, v164
    v_cvt_pk_bf16_f32 v182, v164, v165
    v_mfma_f32_16x16x32_bf16 v[72:75], a[220:223], a[200:203], v[72:75]
    s_add_u32 m0, s92, 81920
    v_exp_f32 v167, v167
    v_mfma_f32_16x16x32_bf16 v[104:107], a[220:223], a[204:207], v[104:107]
    s_mov_b32 s97, 114688
    v_add_f32 v190, v190, v165
    v_add_f32 v190, v190, v166
    v_mfma_f32_16x16x32_bf16 v[136:139], a[220:223], a[208:211], v[136:139]
    v_cvt_pk_bf16_f32 v183, v166, v167
    v_add_f32 v190, v190, v167
    v_mfma_f32_16x16x32_bf16 v[172:175], a[160:163], a[96:99], 0
    ds_write_b64 v220, v[182:183] offset:11264
    v_mfma_f32_16x16x32_bf16 v[172:175], a[164:167], a[100:103], v[172:175]
    buffer_load_dwordx4 v223, s[48:51], s97 offen offset:0 lds
    v_mfma_f32_16x16x32_bf16 v[172:175], a[168:171], a[104:107], v[172:175]
    ds_read_b64_tr_b16 a[228:229], v208 offset:32768
    v_mov_b32 v243, v190
    v_mfma_f32_16x16x32_bf16 v[172:175], a[172:175], a[108:111], v[172:175]
    s_nop 0
    v_permlane32_swap_b32 v243, v190
    v_mfma_f32_16x16x32_bf16 v[172:175], a[176:179], a[112:115], v[172:175]
    ds_read_b64_tr_b16 a[230:231], v208 offset:40960
    v_add_f32 v190, v190, v243
    v_mfma_f32_16x16x32_bf16 v[172:175], a[180:183], a[116:119], v[172:175]
    s_mov_b32 s97, 120832
    ds_write_b32 v224, v190 offset:256
    v_mfma_f32_16x16x32_bf16 v[172:175], a[184:187], a[120:123], v[172:175]
    v_fma_f32 v168, v168, s98, v186
    v_fma_f32 v169, v169, s98, v186
    v_mfma_f32_16x16x32_bf16 v[172:175], a[188:191], a[124:127], v[172:175]
    s_waitcnt lgkmcnt(4)
    v_exp_f32 v168, v168
    v_mfma_f32_16x16x32_bf16 v[140:143], a[224:227], a[208:211], v[140:143]
    v_fma_f32 v170, v170, s98, v186
    v_fma_f32 v171, v171, s98, v186
    v_mfma_f32_16x16x32_bf16 v[108:111], a[224:227], a[204:207], v[108:111]
    v_exp_f32 v169, v169
    v_mfma_f32_16x16x32_bf16 v[76:79], a[224:227], a[200:203], v[76:79]
    v_exp_f32 v170, v170
    v_mfma_f32_16x16x32_bf16 v[44:47], a[224:227], a[196:199], v[44:47]
    buffer_load_dwordx4 v223, s[48:51], s97 offen offset:1024 lds
    v_mfma_f32_16x16x32_bf16 v[12:15], a[224:227], a[192:195], v[12:15]
    v_add_f32 v191, v191, v168
    v_cvt_pk_bf16_f32 v180, v168, v169
    v_mfma_f32_16x16x32_bf16 v[176:179], a[160:163], a[128:131], 0
    s_mov_b32 s97, 126976
    v_exp_f32 v171, v171
    v_mfma_f32_16x16x32_bf16 v[176:179], a[164:167], a[132:135], v[176:179]
    v_add_f32 v191, v191, v169
    v_add_f32 v191, v191, v170
    v_mfma_f32_16x16x32_bf16 v[176:179], a[168:171], a[136:139], v[176:179]
    v_cvt_pk_bf16_f32 v181, v170, v171
    v_add_f32 v191, v191, v171
    v_mfma_f32_16x16x32_bf16 v[176:179], a[172:175], a[140:143], v[176:179]
    ds_write_b64 v220, v[180:181] offset:12288
    v_mfma_f32_16x16x32_bf16 v[176:179], a[176:179], a[144:147], v[176:179]
    buffer_load_dwordx4 v223, s[48:51], s97 offen offset:2048 lds
    v_mov_b32 v242, v191
    s_nop 1
    v_permlane32_swap_b32 v242, v191
    v_mfma_f32_16x16x32_bf16 v[176:179], a[180:183], a[148:151], v[176:179]
    ds_read_b64_tr_b16 a[232:233], v209 offset:32768
    v_add_f32 v191, v191, v242
    v_mfma_f32_16x16x32_bf16 v[176:179], a[184:187], a[152:155], v[176:179]
    ds_write_b32 v224, v191 offset:512
    v_mfma_f32_16x16x32_bf16 v[176:179], a[188:191], a[156:159], v[176:179]
    s_waitcnt lgkmcnt(3)
    ds_read_b64_tr_b16 a[234:235], v209 offset:40960
    v_fma_f32 v172, v172, s98, v187
    v_fma_f32 v173, v173, s98, v187
    v_mfma_f32_16x16x32_bf16 v[16:19], a[228:231], a[192:195], v[16:19]
    s_mov_b32 s97, 133120
    v_exp_f32 v172, v172
    v_mfma_f32_16x16x32_bf16 v[48:51], a[228:231], a[196:199], v[48:51]
    ds_read_b64_tr_b16 a[236:237], v210 offset:32768
    v_fma_f32 v174, v174, s98, v187
    v_fma_f32 v175, v175, s98, v187
    v_mfma_f32_16x16x32_bf16 v[80:83], a[228:231], a[200:203], v[80:83]
    v_exp_f32 v173, v173
    v_mfma_f32_16x16x32_bf16 v[112:115], a[228:231], a[204:207], v[112:115]
    v_exp_f32 v174, v174
    v_mfma_f32_16x16x32_bf16 v[144:147], a[228:231], a[208:211], v[144:147]
    s_waitcnt lgkmcnt(1)
    buffer_load_dwordx4 v223, s[48:51], s97 offen offset:3072 lds
    v_add_f32 v192, v192, v172
    v_cvt_pk_bf16_f32 v182, v172, v173
    v_mfma_f32_16x16x32_bf16 v[148:151], a[232:235], a[208:211], v[148:151]
    v_exp_f32 v175, v175
    v_mfma_f32_16x16x32_bf16 v[116:119], a[232:235], a[204:207], v[116:119]
    ds_read_b64_tr_b16 a[238:239], v210 offset:40960
    v_add_f32 v192, v192, v173
    v_add_f32 v192, v192, v174
    v_mfma_f32_16x16x32_bf16 v[84:87], a[232:235], a[200:203], v[84:87]
    ds_read_b64_tr_b16 a[240:241], v211 offset:32768
    v_cvt_pk_bf16_f32 v183, v174, v175
    v_add_f32 v192, v192, v175
    v_mfma_f32_16x16x32_bf16 v[52:55], a[232:235], a[196:199], v[52:55]
    ds_write_b64 v220, v[182:183] offset:13312
    v_mfma_f32_16x16x32_bf16 v[20:23], a[232:235], a[192:195], v[20:23]
    s_waitcnt lgkmcnt(2)
    ds_read_b64_tr_b16 a[242:243], v211 offset:40960
    v_mov_b32 v243, v192
    s_nop 1
    v_permlane32_swap_b32 v243, v192
    v_mfma_f32_16x16x32_bf16 v[24:27], a[236:239], a[192:195], v[24:27]
    v_add_f32 v192, v192, v243
    v_mfma_f32_16x16x32_bf16 v[56:59], a[236:239], a[196:199], v[56:59]
    ds_write_b32 v224, v192 offset:768
    v_mfma_f32_16x16x32_bf16 v[88:91], a[236:239], a[200:203], v[88:91]
    v_fma_f32 v176, v176, s98, v188
    v_fma_f32 v177, v177, s98, v188
    v_exp_f32 v176, v176
    v_fma_f32 v178, v178, s98, v188
    v_fma_f32 v179, v179, s98, v188
    v_exp_f32 v177, v177
    v_exp_f32 v178, v178
    v_add_f32 v193, v193, v176
    v_cvt_pk_bf16_f32 v180, v176, v177
    v_exp_f32 v179, v179
    v_add_f32 v193, v193, v177
    v_add_f32 v193, v193, v178
    v_cvt_pk_bf16_f32 v181, v178, v179
    v_add_f32 v193, v193, v179
    ds_write_b64 v220, v[180:181] offset:14336
    v_mov_b32 v242, v193
    s_nop 1
    v_permlane32_swap_b32 v242, v193
    v_add_f32 v193, v193, v242
    ds_write_b32 v224, v193 offset:1024
    v_add_f32 v244, v189, v190
    v_add_f32 v244, v244, v191
    v_add_f32 v244, v244, v192
    v_add_f32 v244, v244, v193
    ds_write_b32 v226, v244
    s_waitcnt vmcnt(8) lgkmcnt(0)
    s_barrier
    ds_read_b128 a[160:163], v221 offset:10240
    v_mfma_f32_16x16x32_bf16 v[120:123], a[236:239], a[204:207], v[120:123]
    s_mov_b32 s12, 65536
    ds_read_b128 v[180:183], v227
    ds_read_b64_tr_b16 a[212:213], v204 offset:49152
    v_mfma_f32_16x16x32_bf16 v[152:155], a[236:239], a[208:211], v[152:155]
    s_cmp_eq_u32 s10, 0
    s_cselect_b32 s5, s12, 81920
    s_cselect_b32 s6, 81920, s12
    ds_read_b128 v[160:163], v225 offset:0
    ds_read_b64_tr_b16 a[214:215], v204 offset:57344
    v_mfma_f32_16x16x32_bf16 v[156:159], a[240:243], a[208:211], v[156:159]
    ds_read_b128 a[164:167], v221 offset:11264
    ds_read_b128 a[168:171], v221 offset:12288
    v_mfma_f32_16x16x32_bf16 v[124:127], a[240:243], a[204:207], v[124:127]
    ds_read_b128 v[164:167], v225 offset:256
    ds_read_b128 a[172:175], v221 offset:13312
    v_mfma_f32_16x16x32_bf16 v[92:95], a[240:243], a[200:203], v[92:95]
    ds_read_b128 v[168:171], v225 offset:512
    ds_read_b128 a[176:179], v221 offset:14336
    v_mfma_f32_16x16x32_bf16 v[60:63], a[240:243], a[196:199], v[60:63]
    ds_read_b64_tr_b16 a[216:217], v205 offset:49152
    ds_read_b64_tr_b16 a[218:219], v205 offset:57344
    v_mfma_f32_16x16x32_bf16 v[28:31], a[240:243], a[192:195], v[28:31]
    s_waitcnt lgkmcnt(8)
    ds_read_b128 v[172:175], v225 offset:768
    v_add_u32 v230, s5, v238
    v_mfma_f32_16x16x32_bf16 v[0:3], a[212:215], a[160:163], v[0:3]
    s_waitcnt lgkmcnt(8)
    ds_read_b128 v[176:179], v225 offset:1024
    v_add_u32 v231, s6, v238
    v_mfma_f32_16x16x32_bf16 v[32:35], a[212:215], a[164:167], v[32:35]
    s_waitcnt lgkmcnt(8)
    ds_read_b64_tr_b16 a[220:221], v206 offset:49152
    ds_read_b64_tr_b16 a[222:223], v206 offset:57344
    v_mfma_f32_16x16x32_bf16 v[64:67], a[212:215], a[168:171], v[64:67]
    s_waitcnt lgkmcnt(8)
    v_add_u32 v232, s5, v239
    v_add_f32 v180, v180, v181
    v_mfma_f32_16x16x32_bf16 v[96:99], a[212:215], a[172:175], v[96:99]
    s_waitcnt lgkmcnt(6)
    ds_read_b64_tr_b16 a[224:225], v207 offset:49152
    v_add_f32 v180, v180, v182
    v_mfma_f32_16x16x32_bf16 v[128:131], a[212:215], a[176:179], v[128:131]
    s_waitcnt lgkmcnt(5)
    v_add_u32 v233, s6, v239
    v_add_f32 v180, v180, v183
    v_mfma_f32_16x16x32_bf16 v[132:135], a[216:219], a[176:179], v[132:135]
    v_cmp_nge_f32 vcc, 1400897536, v180
    v_add_f32 v160, v160, v161
    v_mfma_f32_16x16x32_bf16 v[100:103], a[216:219], a[172:175], v[100:103]
    ds_read_b64_tr_b16 a[226:227], v207 offset:57344
    v_add_f32 v164, v164, v165
    v_mfma_f32_16x16x32_bf16 v[68:71], a[216:219], a[168:171], v[68:71]
    v_add_f32 v168, v168, v169
    s_waitcnt lgkmcnt(5)
    v_add_f32 v172, v172, v173
    v_mfma_f32_16x16x32_bf16 v[36:39], a[216:219], a[164:167], v[36:39]
    ds_read_b64_tr_b16 a[228:229], v208 offset:49152
    s_waitcnt lgkmcnt(5)
    v_add_f32 v176, v176, v177
    v_mfma_f32_16x16x32_bf16 v[4:7], a[216:219], a[160:163], v[4:7]
    s_waitcnt lgkmcnt(3)
    ds_read_b64_tr_b16 a[230:231], v208 offset:57344
    ds_read_b64_tr_b16 a[232:233], v209 offset:49152
    v_mfma_f32_16x16x32_bf16 v[8:11], a[220:223], a[160:163], v[8:11]
    s_cmp_eq_u32 s96, 0
    s_cselect_b64 vcc, vcc, 0
    s_nop 4
    s_cbranch_vccnz L_fallback
    v_add_f32 v160, v160, v162
    v_add_f32 v164, v164, v166
    v_mfma_f32_16x16x32_bf16 v[40:43], a[220:223], a[164:167], v[40:43]
    v_add_f32 v168, v168, v170
    v_add_f32 v172, v172, v174
    v_mfma_f32_16x16x32_bf16 v[72:75], a[220:223], a[168:171], v[72:75]
    v_add_f32 v176, v176, v178
    v_add_f32 v160, v160, v163
    v_add_f32 v164, v164, v167
    v_add_f32 v168, v168, v171
    v_add_f32 v172, v172, v175
    v_add_f32 v176, v176, v179
    v_mfma_f32_16x16x32_bf16 v[104:107], a[220:223], a[172:175], v[104:107]
    ds_read_b64_tr_b16 a[234:235], v209 offset:57344
    v_cvt_pk_bf16_f32 v0, v0, v1
    v_mfma_f32_16x16x32_bf16 v[136:139], a[220:223], a[176:179], v[136:139]
    s_waitcnt lgkmcnt(4)
    ds_read_b64_tr_b16 a[236:237], v210 offset:49152
    v_cvt_pk_bf16_f32 v1, v2, v3
    v_mfma_f32_16x16x32_bf16 v[140:143], a[224:227], a[176:179], v[140:143]
    ds_read_b64_tr_b16 a[238:239], v210 offset:57344
    v_cvt_pk_bf16_f32 v2, v4, v5
    v_mfma_f32_16x16x32_bf16 v[108:111], a[224:227], a[172:175], v[108:111]
    ds_read_b64_tr_b16 a[240:241], v211 offset:49152
    v_cvt_pk_bf16_f32 v3, v6, v7
    v_mfma_f32_16x16x32_bf16 v[76:79], a[224:227], a[168:171], v[76:79]
    v_cvt_pk_bf16_f32 v32, v32, v33
    v_cvt_pk_bf16_f32 v33, v34, v35
    v_mfma_f32_16x16x32_bf16 v[44:47], a[224:227], a[164:167], v[44:47]
    v_cvt_pk_bf16_f32 v34, v36, v37
    v_cvt_pk_bf16_f32 v35, v38, v39
    v_mfma_f32_16x16x32_bf16 v[12:15], a[224:227], a[160:163], v[12:15]
    s_waitcnt lgkmcnt(4)
    v_cvt_pk_bf16_f32 v64, v64, v65
    v_cvt_pk_bf16_f32 v65, v66, v67
    v_mfma_f32_16x16x32_bf16 v[16:19], a[228:231], a[160:163], v[16:19]
    v_cvt_pk_bf16_f32 v66, v68, v69
    v_cvt_pk_bf16_f32 v67, v70, v71
    v_mfma_f32_16x16x32_bf16 v[48:51], a[228:231], a[164:167], v[48:51]
    v_cvt_pk_bf16_f32 v96, v96, v97
    v_cvt_pk_bf16_f32 v97, v98, v99
    v_mfma_f32_16x16x32_bf16 v[80:83], a[228:231], a[168:171], v[80:83]
    v_cvt_pk_bf16_f32 v98, v100, v101
    v_cvt_pk_bf16_f32 v99, v102, v103
    v_mfma_f32_16x16x32_bf16 v[112:115], a[228:231], a[172:175], v[112:115]
    v_cvt_pk_bf16_f32 v128, v128, v129
    v_cvt_pk_bf16_f32 v129, v130, v131
    v_mfma_f32_16x16x32_bf16 v[144:147], a[228:231], a[176:179], v[144:147]
    s_waitcnt lgkmcnt(0)
    v_cvt_pk_bf16_f32 v130, v132, v133
    v_cvt_pk_bf16_f32 v131, v134, v135
    v_mfma_f32_16x16x32_bf16 v[148:151], a[232:235], a[176:179], v[148:151]
    ds_read_b64_tr_b16 a[242:243], v211 offset:57344
    v_cvt_pk_bf16_f32 v8, v8, v9
    v_mfma_f32_16x16x32_bf16 v[116:119], a[232:235], a[172:175], v[116:119]
    ds_write_b128 v228, v[0:3] offset:0
    v_mfma_f32_16x16x32_bf16 v[84:87], a[232:235], a[168:171], v[84:87]
    v_cvt_pk_bf16_f32 v9, v10, v11
    v_cvt_pk_bf16_f32 v10, v12, v13
    v_mfma_f32_16x16x32_bf16 v[52:55], a[232:235], a[164:167], v[52:55]
    ds_write_b128 v228, v[32:35] offset:4096
    v_mfma_f32_16x16x32_bf16 v[20:23], a[232:235], a[160:163], v[20:23]
    v_cvt_pk_bf16_f32 v11, v14, v15
    v_cvt_pk_bf16_f32 v40, v40, v41
    v_mfma_f32_16x16x32_bf16 v[24:27], a[236:239], a[160:163], v[24:27]
    ds_write_b128 v228, v[64:67] offset:8192
    v_mfma_f32_16x16x32_bf16 v[56:59], a[236:239], a[164:167], v[56:59]
    s_waitcnt vmcnt(0) lgkmcnt(0)
    s_barrier
    v_cvt_pk_bf16_f32 v41, v42, v43
    v_mfma_f32_16x16x32_bf16 v[88:91], a[236:239], a[168:171], v[88:91]
    s_add_u32 m0, s92, 49152
    ds_read_b64_tr_b16 a[80:81], v230 offset:0
    v_cvt_pk_bf16_f32 v42, v44, v45
    v_mfma_f32_16x16x32_bf16 v[120:123], a[236:239], a[172:175], v[120:123]
    s_mov_b32 s97, 128
    ds_read_b64_tr_b16 a[82:83], v230 offset:2048
    v_cvt_pk_bf16_f32 v43, v46, v47
    v_mfma_f32_16x16x32_bf16 v[152:155], a[236:239], a[176:179], v[152:155]
    v_cvt_pk_bf16_f32 v72, v72, v73
    v_cvt_pk_bf16_f32 v73, v74, v75
    v_mfma_f32_16x16x32_bf16 v[156:159], a[240:243], a[176:179], v[156:159]
    ds_write_b128 v228, v[96:99] offset:12288
    v_mfma_f32_16x16x32_bf16 v[124:127], a[240:243], a[172:175], v[124:127]
    buffer_load_dwordx4 v223, s[48:51], s97 offen offset:0 lds
    v_cvt_pk_bf16_f32 v74, v76, v77
    v_cvt_pk_bf16_f32 v75, v78, v79
    v_cvt_pk_bf16_f32 v104, v104, v105
    v_cvt_pk_bf16_f32 v105, v106, v107
    v_cvt_pk_bf16_f32 v106, v108, v109
    v_cvt_pk_bf16_f32 v107, v110, v111
    v_cvt_pk_bf16_f32 v136, v136, v137
    v_cvt_pk_bf16_f32 v137, v138, v139
    v_cvt_pk_bf16_f32 v138, v140, v141
    v_cvt_pk_bf16_f32 v139, v142, v143
    v_mfma_f32_16x16x32_bf16 v[92:95], a[240:243], a[168:171], v[92:95]
    s_mov_b32 s97, 6272
    ds_write_b128 v228, v[128:131] offset:16384
    v_mfma_f32_16x16x32_bf16 v[60:63], a[240:243], a[164:167], v[60:63]
    ds_read_b64_tr_b16 a[96:97], v232 offset:0
    ds_read_b64_tr_b16 a[98:99], v232 offset:2048
    v_mfma_f32_16x16x32_bf16 v[28:31], a[240:243], a[160:163], v[28:31]
    s_waitcnt lgkmcnt(4)
    v_cvt_pk_bf16_f32 v16, v16, v17
    v_cvt_pk_bf16_f32 v17, v18, v19
    v_mfma_f32_16x16x32_bf16 v[4:7], a[80:83], v[0:3], 0
    ds_write_b128 v228, v[8:11] offset:1024
    v_mfma_f32_16x16x32_bf16 v[36:39], a[80:83], v[32:35], 0
    buffer_load_dwordx4 v223, s[48:51], s97 offen offset:1024 lds
    v_mfma_f32_16x16x32_bf16 v[68:71], a[80:83], v[64:67], 0
    s_mov_b32 s97, 12416
    ds_write_b128 v228, v[40:43] offset:5120
    v_cvt_pk_bf16_f32 v18, v20, v21
    v_mfma_f32_16x16x32_bf16 v[100:103], a[80:83], v[96:99], 0
    ds_read_b64_tr_b16 a[84:85], v230 offset:4096
    ds_read_b64_tr_b16 a[86:87], v230 offset:6144
    v_cvt_pk_bf16_f32 v19, v22, v23
    v_cvt_pk_bf16_f32 v48, v48, v49
    v_mfma_f32_16x16x32_bf16 v[132:135], a[80:83], v[128:131], 0
    s_waitcnt lgkmcnt(4)
    ds_write_b128 v228, v[72:75] offset:9216
    v_cvt_pk_bf16_f32 v49, v50, v51
    v_cvt_pk_bf16_f32 v50, v52, v53
    v_mfma_f32_16x16x32_bf16 v[12:15], a[96:99], v[0:3], 0
    v_cvt_pk_bf16_f32 v51, v54, v55
    v_cvt_pk_bf16_f32 v80, v80, v81
    v_mfma_f32_16x16x32_bf16 v[44:47], a[96:99], v[32:35], 0
    buffer_load_dwordx4 v223, s[48:51], s97 offen offset:2048 lds
    v_cvt_pk_bf16_f32 v81, v82, v83
    v_cvt_pk_bf16_f32 v82, v84, v85
    v_mfma_f32_16x16x32_bf16 v[76:79], a[96:99], v[64:67], 0
    s_mov_b32 s97, 18560
    ds_write_b128 v228, v[104:107] offset:13312
    v_cvt_pk_bf16_f32 v83, v86, v87
    v_cvt_pk_bf16_f32 v112, v112, v113
    v_cvt_pk_bf16_f32 v113, v114, v115
    v_cvt_pk_bf16_f32 v114, v116, v117
    v_cvt_pk_bf16_f32 v115, v118, v119
    v_cvt_pk_bf16_f32 v144, v144, v145
    v_cvt_pk_bf16_f32 v145, v146, v147
    v_cvt_pk_bf16_f32 v146, v148, v149
    v_cvt_pk_bf16_f32 v147, v150, v151
    v_mfma_f32_16x16x32_bf16 v[108:111], a[96:99], v[96:99], 0
    ds_write_b128 v228, v[136:139] offset:17408
    v_mfma_f32_16x16x32_bf16 v[140:143], a[96:99], v[128:131], 0
    s_waitcnt lgkmcnt(3)
    ds_read_b64_tr_b16 a[100:101], v232 offset:4096
    ds_read_b64_tr_b16 a[102:103], v232 offset:6144
    v_mfma_f32_16x16x32_bf16 v[4:7], a[84:87], v[8:11], v[4:7]
    v_cvt_pk_bf16_f32 v24, v24, v25
    v_cvt_pk_bf16_f32 v25, v26, v27
    v_mfma_f32_16x16x32_bf16 v[36:39], a[84:87], v[40:43], v[36:39]
    buffer_load_dwordx4 v223, s[48:51], s97 offen offset:3072 lds
    v_mfma_f32_16x16x32_bf16 v[68:71], a[84:87], v[72:75], v[68:71]
    ds_write_b128 v228, v[16:19] offset:2048
    v_cvt_pk_bf16_f32 v26, v28, v29
    v_mfma_f32_16x16x32_bf16 v[100:103], a[84:87], v[104:107], v[100:103]
    s_add_u32 m0, s92, 147456
    ds_write_b128 v228, v[48:51] offset:6144
    v_cvt_pk_bf16_f32 v27, v30, v31
    v_cvt_pk_bf16_f32 v56, v56, v57
    v_mfma_f32_16x16x32_bf16 v[132:135], a[84:87], v[136:139], v[132:135]
    s_waitcnt lgkmcnt(2)
    ds_read_b64_tr_b16 a[88:89], v230 offset:8192
    ds_read_b64_tr_b16 a[90:91], v230 offset:10240
    v_cvt_pk_bf16_f32 v57, v58, v59
    v_cvt_pk_bf16_f32 v58, v60, v61
    v_mfma_f32_16x16x32_bf16 v[12:15], a[100:103], v[8:11], v[12:15]
    s_mov_b32 s97, 114816
    ds_write_b128 v228, v[80:83] offset:10240
    v_cvt_pk_bf16_f32 v59, v62, v63
    v_cvt_pk_bf16_f32 v88, v88, v89
    v_mfma_f32_16x16x32_bf16 v[44:47], a[100:103], v[40:43], v[44:47]
    ds_read_b64_tr_b16 a[104:105], v232 offset:8192
    v_cvt_pk_bf16_f32 v89, v90, v91
    v_cvt_pk_bf16_f32 v90, v92, v93
    v_cvt_pk_bf16_f32 v91, v94, v95
    v_mfma_f32_16x16x32_bf16 v[76:79], a[100:103], v[72:75], v[76:79]
    buffer_load_dwordx4 v223, s[48:51], s97 offen offset:0 lds
    v_cvt_pk_bf16_f32 v120, v120, v121
    v_cvt_pk_bf16_f32 v121, v122, v123
    v_mfma_f32_16x16x32_bf16 v[108:111], a[100:103], v[104:107], v[108:111]
    s_mov_b32 s97, 120960
    ds_write_b128 v228, v[112:115] offset:14336
    v_cvt_pk_bf16_f32 v122, v124, v125
    v_cvt_pk_bf16_f32 v123, v126, v127
    v_cvt_pk_bf16_f32 v152, v152, v153
    v_cvt_pk_bf16_f32 v153, v154, v155
    v_cvt_pk_bf16_f32 v154, v156, v157
    v_cvt_pk_bf16_f32 v155, v158, v159
    v_mfma_f32_16x16x32_bf16 v[140:143], a[100:103], v[136:139], v[140:143]
    s_waitcnt lgkmcnt(3)
    ds_write_b128 v228, v[144:147] offset:18432
    v_mfma_f32_16x16x32_bf16 v[4:7], a[88:91], v[16:19], v[4:7]
    ds_read_b64_tr_b16 a[106:107], v232 offset:10240
    ds_read_b64_tr_b16 a[92:93], v230 offset:12288
    v_mfma_f32_16x16x32_bf16 v[36:39], a[88:91], v[48:51], v[36:39]
    ds_read_b64_tr_b16 a[94:95], v230 offset:14336
    ds_read_b64_tr_b16 a[108:109], v232 offset:12288
    v_mfma_f32_16x16x32_bf16 v[68:71], a[88:91], v[80:83], v[68:71]
    buffer_load_dwordx4 v223, s[48:51], s97 offen offset:1024 lds
    v_mfma_f32_16x16x32_bf16 v[100:103], a[88:91], v[112:115], v[100:103]
    s_mov_b32 s97, 127104
    ds_write_b128 v228, v[24:27] offset:3072
    v_mfma_f32_16x16x32_bf16 v[132:135], a[88:91], v[144:147], v[132:135]
    s_waitcnt lgkmcnt(4)
    ds_write_b128 v228, v[56:59] offset:7168
    v_mfma_f32_16x16x32_bf16 v[12:15], a[104:107], v[16:19], v[12:15]
    ds_write_b128 v228, v[88:91] offset:11264
    v_mfma_f32_16x16x32_bf16 v[44:47], a[104:107], v[48:51], v[44:47]
    ds_read_b64_tr_b16 a[110:111], v232 offset:14336
    ds_read_b64_tr_b16 a[112:113], v231 offset:0
    v_mfma_f32_16x16x32_bf16 v[76:79], a[104:107], v[80:83], v[76:79]
    buffer_load_dwordx4 v223, s[48:51], s97 offen offset:2048 lds
    v_mfma_f32_16x16x32_bf16 v[108:111], a[104:107], v[112:115], v[108:111]
    s_mov_b32 s97, 133248
    ds_write_b128 v228, v[120:123] offset:15360
    v_mfma_f32_16x16x32_bf16 v[140:143], a[104:107], v[144:147], v[140:143]
    s_waitcnt lgkmcnt(6)
    ds_write_b128 v228, v[152:155] offset:19456
    v_mfma_f32_16x16x32_bf16 v[4:7], a[92:95], v[24:27], v[4:7]
    buffer_load_dwordx4 v223, s[48:51], s97 offen offset:3072 lds
    v_mfma_f32_16x16x32_bf16 v[36:39], a[92:95], v[56:59], v[36:39]
    ds_read_b64_tr_b16 a[114:115], v231 offset:2048
    ds_read_b64_tr_b16 a[116:117], v231 offset:4096
    v_mfma_f32_16x16x32_bf16 v[68:71], a[92:95], v[88:91], v[68:71]
    ds_read_b64_tr_b16 a[118:119], v231 offset:6144
    ds_read_b64_tr_b16 a[120:121], v231 offset:8192
    v_mfma_f32_16x16x32_bf16 v[100:103], a[92:95], v[120:123], v[100:103]
L_pg6:
    s_cbranch_execz L_pgret
    ds_read_b64_tr_b16 a[122:123], v231 offset:10240
    ds_read_b64_tr_b16 a[124:125], v231 offset:12288
    v_mfma_f32_16x16x32_bf16 v[132:135], a[92:95], v[152:155], v[132:135]
    s_waitcnt lgkmcnt(0)
    s_barrier
    ds_read_b128 a[0:3], v229 offset:0
    ds_read_b128 a[4:7], v229 offset:1024
    v_mfma_f32_16x16x32_bf16 v[12:15], a[108:111], v[24:27], v[12:15]
    ds_read_b128 a[8:11], v229 offset:2048
    ds_read_b64_tr_b16 a[126:127], v231 offset:14336
    v_mfma_f32_16x16x32_bf16 v[44:47], a[108:111], v[56:59], v[44:47]
    ds_read_b128 a[12:15], v229 offset:3072
    ds_read_b64_tr_b16 a[128:129], v233 offset:0
    v_mfma_f32_16x16x32_bf16 v[76:79], a[108:111], v[88:91], v[76:79]
    ds_read_b64_tr_b16 a[130:131], v233 offset:2048
    ds_read_b64_tr_b16 a[132:133], v233 offset:4096
    v_mfma_f32_16x16x32_bf16 v[108:111], a[108:111], v[120:123], v[108:111]
    ds_read_b64_tr_b16 a[134:135], v233 offset:6144
    ds_read_b64_tr_b16 a[136:137], v233 offset:8192
    v_mfma_f32_16x16x32_bf16 v[140:143], a[108:111], v[152:155], v[140:143]
    s_waitcnt lgkmcnt(9)
    ds_read_b64_tr_b16 a[138:139], v233 offset:10240
    ds_read_b64_tr_b16 a[140:141], v233 offset:12288
    v_mfma_f32_16x16x32_bf16 v[4:7], a[112:115], a[0:3], v[4:7]
    s_waitcnt lgkmcnt(10)
    ds_read_b64_tr_b16 a[142:143], v233 offset:14336
    ds_read_b128 a[16:19], v229 offset:4096
    v_mfma_f32_16x16x32_bf16 v[4:7], a[116:119], a[4:7], v[4:7]
    s_waitcnt lgkmcnt(11)
    ds_read_b128 a[20:23], v229 offset:5120
    ds_read_b128 a[24:27], v229 offset:6144
    v_mfma_f32_16x16x32_bf16 v[4:7], a[120:123], a[8:11], v[4:7]
    s_waitcnt lgkmcnt(11)
    ds_read_b128 a[28:31], v229 offset:7168
    v_mfma_f32_16x16x32_bf16 v[4:7], a[124:127], a[12:15], v[4:7]
    s_waitcnt lgkmcnt(10)
    v_mfma_f32_16x16x32_bf16 v[12:15], a[128:131], a[0:3], v[12:15]
    s_waitcnt lgkmcnt(8)
    v_mfma_f32_16x16x32_bf16 v[12:15], a[132:135], a[4:7], v[12:15]
    s_waitcnt lgkmcnt(6)
    v_mfma_f32_16x16x32_bf16 v[12:15], a[136:139], a[8:11], v[12:15]
    s_waitcnt lgkmcnt(4)
    v_mfma_f32_16x16x32_bf16 v[12:15], a[140:143], a[12:15], v[12:15]
    s_waitcnt lgkmcnt(3)
    ds_read_b128 a[32:35], v229 offset:8192
    s_mov_b32 s12, 49152
    v_mfma_f32_16x16x32_bf16 v[36:39], a[112:115], a[16:19], v[36:39]
    s_waitcnt lgkmcnt(3)
    ds_read_b128 a[36:39], v229 offset:9216
    s_cmp_eq_u32 s10, 0
    s_cselect_b32 s5, s12, 147456
    s_cselect_b32 s6, 147456, s12
    v_mfma_f32_16x16x32_bf16 v[36:39], a[116:119], a[20:23], v[36:39]
    s_waitcnt lgkmcnt(3)
    ds_read_b128 a[40:43], v229 offset:10240
    v_add_u32 v234, s5, v238
    v_mfma_f32_16x16x32_bf16 v[36:39], a[120:123], a[24:27], v[36:39]
    s_waitcnt lgkmcnt(3)
    ds_read_b128 a[44:47], v229 offset:11264
    v_add_u32 v235, s6, v238
    v_mfma_f32_16x16x32_bf16 v[36:39], a[124:127], a[28:31], v[36:39]
    v_rcp_f32 v194, v160
    v_mfma_f32_16x16x32_bf16 v[44:47], a[128:131], a[16:19], v[44:47]
    v_add_u32 v236, s5, v239
    v_mul_f32 v4, v4, v194
    v_mfma_f32_16x16x32_bf16 v[44:47], a[132:135], a[20:23], v[44:47]
    v_mul_f32 v5, v5, v194
    v_mfma_f32_16x16x32_bf16 v[44:47], a[136:139], a[24:27], v[44:47]
    v_add_u32 v237, s6, v239
    v_mul_f32 v6, v6, v194
    v_mfma_f32_16x16x32_bf16 v[44:47], a[140:143], a[28:31], v[44:47]
    s_waitcnt lgkmcnt(3)
    ds_read_b128 a[48:51], v229 offset:12288
    v_mul_f32 v7, v7, v194
    v_mfma_f32_16x16x32_bf16 v[68:71], a[112:115], a[32:35], v[68:71]
    s_waitcnt lgkmcnt(3)
    ds_read_b128 a[52:55], v229 offset:13312
    v_cvt_pk_bf16_f32 v4, v4, v5
    v_mfma_f32_16x16x32_bf16 v[68:71], a[116:119], a[36:39], v[68:71]
    s_waitcnt lgkmcnt(3)
    ds_read_b128 a[56:59], v229 offset:14336
    v_cvt_pk_bf16_f32 v5, v6, v7
    v_mfma_f32_16x16x32_bf16 v[68:71], a[120:123], a[40:43], v[68:71]
    s_waitcnt lgkmcnt(3)
    ds_read_b128 a[60:63], v229 offset:15360
    v_mul_f32 v12, v12, v194
    v_mfma_f32_16x16x32_bf16 v[68:71], a[124:127], a[44:47], v[68:71]
    v_mul_f32 v13, v13, v194
    v_mul_f32 v14, v14, v194
    v_mfma_f32_16x16x32_bf16 v[76:79], a[128:131], a[32:35], v[76:79]
    v_mul_f32 v15, v15, v194
    v_mfma_f32_16x16x32_bf16 v[76:79], a[132:135], a[36:39], v[76:79]
    ds_read_b128 a[64:67], v229 offset:16384
    v_cvt_pk_bf16_f32 v6, v12, v13
    v_mfma_f32_16x16x32_bf16 v[76:79], a[136:139], a[40:43], v[76:79]
    ds_read_b128 a[68:71], v229 offset:17408
    v_cvt_pk_bf16_f32 v7, v14, v15
    v_mfma_f32_16x16x32_bf16 v[76:79], a[140:143], a[44:47], v[76:79]
    s_waitcnt lgkmcnt(5)
    buffer_store_dwordx4 v[4:7], v222, s[52:55], s4 offen sc1
    v_mfma_f32_16x16x32_bf16 v[100:103], a[112:115], a[48:51], v[100:103]
    s_waitcnt lgkmcnt(4)
    ds_read_b128 a[72:75], v229 offset:18432
    v_mfma_f32_16x16x32_bf16 v[100:103], a[116:119], a[52:55], v[100:103]
    s_waitcnt lgkmcnt(4)
    ds_read_b128 a[76:79], v229 offset:19456
    v_mfma_f32_16x16x32_bf16 v[100:103], a[120:123], a[56:59], v[100:103]
    s_waitcnt lgkmcnt(4)
    v_mfma_f32_16x16x32_bf16 v[100:103], a[124:127], a[60:63], v[100:103]
    s_add_u32 s4, s4, 2048
    v_rcp_f32 v195, v164
    v_mfma_f32_16x16x32_bf16 v[108:111], a[128:131], a[48:51], v[108:111]
    v_mul_f32 v36, v36, v195
    v_mul_f32 v37, v37, v195
    v_mfma_f32_16x16x32_bf16 v[108:111], a[132:135], a[52:55], v[108:111]
    v_mul_f32 v38, v38, v195
    v_mul_f32 v39, v39, v195
    v_mfma_f32_16x16x32_bf16 v[108:111], a[136:139], a[56:59], v[108:111]
    v_cvt_pk_bf16_f32 v36, v36, v37
    v_mfma_f32_16x16x32_bf16 v[108:111], a[140:143], a[60:63], v[108:111]
    s_waitcnt vmcnt(1) lgkmcnt(0)
    s_barrier
    ds_read_b64_tr_b16 a[144:145], v234 offset:0
    v_mfma_f32_16x16x32_bf16 v[132:135], a[112:115], a[64:67], v[132:135]
    s_add_u32 m0, s92, 0
    ds_read_b64_tr_b16 a[146:147], v234 offset:2048
    ds_read_b64_tr_b16 a[148:149], v234 offset:4096
    v_mfma_f32_16x16x32_bf16 v[132:135], a[116:119], a[68:71], v[132:135]
    s_mov_b32 s97, 256
    ds_read_b64_tr_b16 a[150:151], v234 offset:6144
    ds_read_b64_tr_b16 a[152:153], v234 offset:8192
    v_mfma_f32_16x16x32_bf16 v[132:135], a[120:123], a[72:75], v[132:135]
    ds_read_b64_tr_b16 a[154:155], v234 offset:10240
    v_cvt_pk_bf16_f32 v37, v38, v39
    v_mfma_f32_16x16x32_bf16 v[132:135], a[124:127], a[76:79], v[132:135]
    ds_read_b64_tr_b16 a[156:157], v234 offset:12288
    v_mul_f32 v44, v44, v195
    v_mfma_f32_16x16x32_bf16 v[140:143], a[128:131], a[64:67], v[140:143]
    buffer_load_dwordx4 v223, s[48:51], s97 offen offset:0 lds
    v_mfma_f32_16x16x32_bf16 v[140:143], a[132:135], a[68:71], v[140:143]
    s_mov_b32 s97, 6400
    ds_read_b64_tr_b16 a[158:159], v234 offset:14336
    ds_read_b64_tr_b16 a[80:81], v235 offset:0
    v_mfma_f32_16x16x32_bf16 v[140:143], a[136:139], a[72:75], v[140:143]
    ds_read_b64_tr_b16 a[82:83], v235 offset:2048
    ds_read_b64_tr_b16 a[84:85], v235 offset:4096
    v_mfma_f32_16x16x32_bf16 v[140:143], a[140:143], a[76:79], v[140:143]
    s_waitcnt lgkmcnt(9)
    ds_read_b64_tr_b16 a[86:87], v235 offset:6144
    ds_read_b64_tr_b16 a[88:89], v235 offset:8192
    v_mfma_f32_16x16x32_bf16 v[20:23], a[144:147], v[0:3], 0
    s_waitcnt lgkmcnt(9)
    buffer_load_dwordx4 v223, s[48:51], s97 offen offset:1024 lds
    v_mfma_f32_16x16x32_bf16 v[20:23], a[148:151], v[8:11], v[20:23]
    s_waitcnt lgkmcnt(7)
    ds_read_b64_tr_b16 a[90:91], v235 offset:10240
    ds_read_b64_tr_b16 a[92:93], v235 offset:12288
    v_mul_f32 v45, v45, v195
    v_mfma_f32_16x16x32_bf16 v[20:23], a[152:155], v[16:19], v[20:23]
    s_waitcnt lgkmcnt(7)
    ds_read_b64_tr_b16 a[94:95], v235 offset:14336
    v_mul_f32 v46, v46, v195
    v_mfma_f32_16x16x32_bf16 v[20:23], a[156:159], v[24:27], v[20:23]
    s_waitcnt lgkmcnt(6)
    v_mul_f32 v47, v47, v195
    v_cvt_pk_bf16_f32 v38, v44, v45
    v_mfma_f32_16x16x32_bf16 v[20:23], a[80:83], a[0:3], v[20:23]
    s_waitcnt lgkmcnt(4)
    ds_read_b64_tr_b16 a[96:97], v236 offset:0
    v_cvt_pk_bf16_f32 v39, v46, v47
    v_mfma_f32_16x16x32_bf16 v[20:23], a[84:87], a[4:7], v[20:23]
    s_waitcnt lgkmcnt(3)
    buffer_store_dwordx4 v[36:39], v222, s[52:55], s4 offen sc1
    v_mfma_f32_16x16x32_bf16 v[20:23], a[88:91], a[8:11], v[20:23]
    s_waitcnt lgkmcnt(1)
    ds_read_b64_tr_b16 a[98:99], v236 offset:2048
    ds_read_b64_tr_b16 a[100:101], v236 offset:4096
    v_mfma_f32_16x16x32_bf16 v[20:23], a[92:95], a[12:15], v[20:23]
    s_add_u32 s4, s4, 2048
    v_rcp_f32 v196, v168
    v_mfma_f32_16x16x32_bf16 v[52:55], a[144:147], v[32:35], 0
    s_mov_b32 s97, 12544
    buffer_load_dwordx4 v223, s[48:51], s97 offen offset:2048 lds
    v_mfma_f32_16x16x32_bf16 v[52:55], a[148:151], v[40:43], v[52:55]
    s_mov_b32 s97, 18688
    v_mul_f32 v68, v68, v196
    v_mul_f32 v69, v69, v196
    v_mfma_f32_16x16x32_bf16 v[52:55], a[152:155], v[48:51], v[52:55]
    buffer_load_dwordx4 v223, s[48:51], s97 offen offset:3072 lds
    v_mfma_f32_16x16x32_bf16 v[52:55], a[156:159], v[56:59], v[52:55]
    s_add_u32 m0, s92, 16384
    v_mul_f32 v70, v70, v196
    v_mul_f32 v71, v71, v196
    v_mfma_f32_16x16x32_bf16 v[52:55], a[80:83], a[16:19], v[52:55]
    s_mov_b32 s97, 114944
    v_cvt_pk_bf16_f32 v68, v68, v69
    v_cvt_pk_bf16_f32 v69, v70, v71
    v_mfma_f32_16x16x32_bf16 v[52:55], a[84:87], a[20:23], v[52:55]
    v_mul_f32 v76, v76, v196
    v_mul_f32 v77, v77, v196
    v_mfma_f32_16x16x32_bf16 v[52:55], a[88:91], a[24:27], v[52:55]
    v_mul_f32 v78, v78, v196
    v_mul_f32 v79, v79, v196
    v_mfma_f32_16x16x32_bf16 v[52:55], a[92:95], a[28:31], v[52:55]
    buffer_load_dwordx4 v223, s[48:51], s97 offen offset:0 lds
    v_mfma_f32_16x16x32_bf16 v[84:87], a[144:147], v[64:67], 0
    s_mov_b32 s97, 121088
    v_cvt_pk_bf16_f32 v70, v76, v77
    v_cvt_pk_bf16_f32 v71, v78, v79
    v_mfma_f32_16x16x32_bf16 v[84:87], a[148:151], v[72:75], v[84:87]
    buffer_store_dwordx4 v[68:71], v222, s[52:55], s4 offen sc1
    v_mfma_f32_16x16x32_bf16 v[84:87], a[152:155], v[80:83], v[84:87]
    s_add_u32 s4, s4, 2048
    v_rcp_f32 v197, v172
    v_mfma_f32_16x16x32_bf16 v[84:87], a[156:159], v[88:91], v[84:87]
    v_mul_f32 v100, v100, v197
    v_mul_f32 v101, v101, v197
    v_mfma_f32_16x16x32_bf16 v[84:87], a[80:83], a[32:35], v[84:87]
    buffer_load_dwordx4 v223, s[48:51], s97 offen offset:1024 lds
    v_mfma_f32_16x16x32_bf16 v[84:87], a[84:87], a[36:39], v[84:87]
    s_mov_b32 s97, 127232
    v_mul_f32 v102, v102, v197
    v_mul_f32 v103, v103, v197
    v_mfma_f32_16x16x32_bf16 v[84:87], a[88:91], a[40:43], v[84:87]
    v_cvt_pk_bf16_f32 v100, v100, v101
    v_cvt_pk_bf16_f32 v101, v102, v103
    v_mfma_f32_16x16x32_bf16 v[84:87], a[92:95], a[44:47], v[84:87]
    v_mul_f32 v108, v108, v197
    v_mul_f32 v109, v109, v197
    v_mfma_f32_16x16x32_bf16 v[116:119], a[144:147], v[96:99], 0
    v_mul_f32 v110, v110, v197
    v_mul_f32 v111, v111, v197
    v_mfma_f32_16x16x32_bf16 v[116:119], a[148:151], v[104:107], v[116:119]
    buffer_load_dwordx4 v223, s[48:51], s97 offen offset:2048 lds
    v_mfma_f32_16x16x32_bf16 v[116:119], a[152:155], v[112:115], v[116:119]
    s_mov_b32 s97, 133376
    v_cvt_pk_bf16_f32 v102, v108, v109
    v_cvt_pk_bf16_f32 v103, v110, v111
    v_mfma_f32_16x16x32_bf16 v[116:119], a[156:159], v[120:123], v[116:119]
    buffer_store_dwordx4 v[100:103], v222, s[52:55], s4 offen sc1
    v_mfma_f32_16x16x32_bf16 v[116:119], a[80:83], a[48:51], v[116:119]
    s_add_u32 s4, s4, 2048
    buffer_load_dwordx4 v223, s[48:51], s97 offen offset:3072 lds
    v_mfma_f32_16x16x32_bf16 v[116:119], a[84:87], a[52:55], v[116:119]
    v_rcp_f32 v198, v176
    v_mfma_f32_16x16x32_bf16 v[116:119], a[88:91], a[56:59], v[116:119]
    ds_read_b64_tr_b16 a[102:103], v236 offset:6144
    v_mul_f32 v132, v132, v198
    v_mfma_f32_16x16x32_bf16 v[116:119], a[92:95], a[60:63], v[116:119]
    s_add_u32 m0, s92, 98304
    ds_read_b64_tr_b16 a[104:105], v236 offset:8192
    v_mul_f32 v133, v133, v198
    v_mfma_f32_16x16x32_bf16 v[148:151], a[144:147], v[128:131], 0
    s_mov_b32 s97, 384
    ds_read_b64_tr_b16 a[106:107], v236 offset:10240
    v_mul_f32 v134, v134, v198
    v_mfma_f32_16x16x32_bf16 v[148:151], a[148:151], v[136:139], v[148:151]
    ds_read_b64_tr_b16 a[108:109], v236 offset:12288
    v_mul_f32 v135, v135, v198
    v_mfma_f32_16x16x32_bf16 v[148:151], a[152:155], v[144:147], v[148:151]
    ds_read_b64_tr_b16 a[110:111], v236 offset:14336
    v_cvt_pk_bf16_f32 v132, v132, v133
    v_mfma_f32_16x16x32_bf16 v[148:151], a[156:159], v[152:155], v[148:151]
    buffer_load_dwordx4 v223, s[48:51], s97 offen offset:0 lds
    v_mfma_f32_16x16x32_bf16 v[148:151], a[80:83], a[64:67], v[148:151]
    s_mov_b32 s97, 6528
    ds_read_b64_tr_b16 a[112:113], v237 offset:0
    v_cvt_pk_bf16_f32 v133, v134, v135
    v_mfma_f32_16x16x32_bf16 v[148:151], a[84:87], a[68:71], v[148:151]
    ds_read_b64_tr_b16 a[114:115], v237 offset:2048
    v_mul_f32 v140, v140, v198
    v_mfma_f32_16x16x32_bf16 v[148:151], a[88:91], a[72:75], v[148:151]
    ds_read_b64_tr_b16 a[116:117], v237 offset:4096
    ds_read_b64_tr_b16 a[118:119], v237 offset:6144
    v_mfma_f32_16x16x32_bf16 v[148:151], a[92:95], a[76:79], v[148:151]
    s_waitcnt lgkmcnt(7)
    buffer_load_dwordx4 v223, s[48:51], s97 offen offset:1024 lds
    v_mfma_f32_16x16x32_bf16 v[28:31], a[96:99], v[0:3], 0
    ds_read_b64_tr_b16 a[120:121], v237 offset:8192
    ds_read_b64_tr_b16 a[122:123], v237 offset:10240
    v_mfma_f32_16x16x32_bf16 v[28:31], a[100:103], v[8:11], v[28:31]
    s_waitcnt lgkmcnt(7)
    ds_read_b64_tr_b16 a[124:125], v237 offset:12288
    ds_read_b64_tr_b16 a[126:127], v237 offset:14336
    v_mfma_f32_16x16x32_bf16 v[28:31], a[104:107], v[16:19], v[28:31]
    s_waitcnt lgkmcnt(8)
    v_mul_f32 v141, v141, v198
    v_mul_f32 v142, v142, v198
    v_mfma_f32_16x16x32_bf16 v[28:31], a[108:111], v[24:27], v[28:31]
    s_waitcnt lgkmcnt(6)
    v_mul_f32 v143, v143, v198
    v_cvt_pk_bf16_f32 v134, v140, v141
    v_mfma_f32_16x16x32_bf16 v[28:31], a[112:115], a[0:3], v[28:31]
    s_waitcnt lgkmcnt(4)
    v_cvt_pk_bf16_f32 v135, v142, v143
    s_mov_b32 s97, 12672
    v_mfma_f32_16x16x32_bf16 v[28:31], a[116:119], a[4:7], v[28:31]
    s_waitcnt lgkmcnt(2)
    buffer_store_dwordx4 v[132:135], v222, s[52:55], s4 offen sc1
    v_mfma_f32_16x16x32_bf16 v[28:31], a[120:123], a[8:11], v[28:31]
    s_waitcnt lgkmcnt(0)
    buffer_load_dwordx4 v223, s[48:51], s97 offen offset:2048 lds
    v_mfma_f32_16x16x32_bf16 v[28:31], a[124:127], a[12:15], v[28:31]
    s_add_u32 s4, s4, 12288
    s_mov_b32 s12, 0
    s_cmp_eq_u32 s10, 0
    s_cselect_b32 s5, s12, 16384
    s_cselect_b32 s6, 16384, s12
    v_mfma_f32_16x16x32_bf16 v[60:63], a[96:99], v[32:35], 0
    s_mov_b32 s97, 18816
    buffer_load_dwordx4 v223, s[48:51], s97 offen offset:3072 lds
    v_mfma_f32_16x16x32_bf16 v[60:63], a[100:103], v[40:43], v[60:63]
    v_add_u32 v230, s5, v238
    v_add_u32 v231, s6, v238
    v_mfma_f32_16x16x32_bf16 v[60:63], a[104:107], v[48:51], v[60:63]
    s_add_u32 m0, s92, 114688
    v_mfma_f32_16x16x32_bf16 v[60:63], a[108:111], v[56:59], v[60:63]
    s_mov_b32 s97, 115072
    buffer_load_dwordx4 v223, s[48:51], s97 offen offset:0 lds
    v_mfma_f32_16x16x32_bf16 v[60:63], a[112:115], a[16:19], v[60:63]
    v_add_u32 v232, s5, v239
    v_mul_f32 v20, v20, v194
    v_mfma_f32_16x16x32_bf16 v[60:63], a[116:119], a[20:23], v[60:63]
    v_mul_f32 v21, v21, v194
    v_mul_f32 v22, v22, v194
    v_mfma_f32_16x16x32_bf16 v[60:63], a[120:123], a[24:27], v[60:63]
    v_mul_f32 v23, v23, v194
    v_add_u32 v233, s6, v239
    v_mfma_f32_16x16x32_bf16 v[60:63], a[124:127], a[28:31], v[60:63]
    s_mov_b32 s97, 121216
    v_cvt_pk_bf16_f32 v20, v20, v21
    v_cvt_pk_bf16_f32 v21, v22, v23
    v_mfma_f32_16x16x32_bf16 v[92:95], a[96:99], v[64:67], 0
    buffer_load_dwordx4 v223, s[48:51], s97 offen offset:1024 lds
    v_mfma_f32_16x16x32_bf16 v[92:95], a[100:103], v[72:75], v[92:95]
    v_mul_f32 v28, v28, v194
    v_mul_f32 v29, v29, v194
    v_mfma_f32_16x16x32_bf16 v[92:95], a[104:107], v[80:83], v[92:95]
    v_mul_f32 v30, v30, v194
    v_mfma_f32_16x16x32_bf16 v[92:95], a[108:111], v[88:91], v[92:95]
    v_mul_f32 v31, v31, v194
    v_mfma_f32_16x16x32_bf16 v[92:95], a[112:115], a[32:35], v[92:95]
    s_mov_b32 s97, 127360
    v_cvt_pk_bf16_f32 v22, v28, v29
    v_mfma_f32_16x16x32_bf16 v[92:95], a[116:119], a[36:39], v[92:95]
    buffer_load_dwordx4 v223, s[48:51], s97 offen offset:2048 lds
    v_mfma_f32_16x16x32_bf16 v[92:95], a[120:123], a[40:43], v[92:95]
    v_cvt_pk_bf16_f32 v23, v30, v31
    v_mfma_f32_16x16x32_bf16 v[92:95], a[124:127], a[44:47], v[92:95]
    buffer_store_dwordx4 v[20:23], v222, s[52:55], s4 offen sc1
    v_mfma_f32_16x16x32_bf16 v[124:127], a[96:99], v[96:99], 0
    s_add_u32 s4, s4, 2048
    v_mfma_f32_16x16x32_bf16 v[124:127], a[100:103], v[104:107], v[124:127]
    s_mov_b32 s97, 133504
    buffer_load_dwordx4 v223, s[48:51], s97 offen offset:3072 lds
    v_mfma_f32_16x16x32_bf16 v[124:127], a[104:107], v[112:115], v[124:127]
    v_mul_f32 v52, v52, v195
    v_mul_f32 v53, v53, v195
    v_mfma_f32_16x16x32_bf16 v[124:127], a[108:111], v[120:123], v[124:127]
    v_mul_f32 v54, v54, v195
    v_mul_f32 v55, v55, v195
    v_mfma_f32_16x16x32_bf16 v[124:127], a[112:115], a[48:51], v[124:127]
    v_cvt_pk_bf16_f32 v52, v52, v53
    v_mfma_f32_16x16x32_bf16 v[124:127], a[116:119], a[52:55], v[124:127]
    v_cvt_pk_bf16_f32 v53, v54, v55
    v_mfma_f32_16x16x32_bf16 v[124:127], a[120:123], a[56:59], v[124:127]
    v_mul_f32 v60, v60, v195
    v_mfma_f32_16x16x32_bf16 v[124:127], a[124:127], a[60:63], v[124:127]
    s_waitcnt vmcnt(10)
    s_barrier
    ds_read_b64_tr_b16 a[128:129], v230 offset:0
    v_mfma_f32_16x16x32_bf16 v[156:159], a[96:99], v[128:131], 0
    s_add_u32 m0, s92, 65536
    ds_read_b64_tr_b16 a[130:131], v230 offset:2048
    ds_read_b64_tr_b16 a[132:133], v230 offset:4096
    v_mfma_f32_16x16x32_bf16 v[156:159], a[100:103], v[136:139], v[156:159]
    s_mov_b32 s97, 512
    ds_read_b64_tr_b16 a[134:135], v230 offset:6144
    ds_read_b64_tr_b16 a[136:137], v230 offset:8192
    v_mfma_f32_16x16x32_bf16 v[156:159], a[104:107], v[144:147], v[156:159]
    ds_read_b64_tr_b16 a[138:139], v230 offset:10240
    v_mul_f32 v61, v61, v195
    v_mfma_f32_16x16x32_bf16 v[156:159], a[108:111], v[152:155], v[156:159]
    ds_read_b64_tr_b16 a[140:141], v230 offset:12288
    v_mul_f32 v62, v62, v195
    v_mfma_f32_16x16x32_bf16 v[156:159], a[112:115], a[64:67], v[156:159]
    ds_read_b64_tr_b16 a[142:143], v230 offset:14336
    v_mul_f32 v63, v63, v195
    v_mfma_f32_16x16x32_bf16 v[156:159], a[116:119], a[68:71], v[156:159]
    buffer_load_dwordx4 v223, s[48:51], s97 offen offset:0 lds
    v_mfma_f32_16x16x32_bf16 v[156:159], a[120:123], a[72:75], v[156:159]
    ds_read_b64_tr_b16 a[144:145], v231 offset:0
    ds_read_b64_tr_b16 a[146:147], v231 offset:2048
    v_mfma_f32_16x16x32_bf16 v[156:159], a[124:127], a[76:79], v[156:159]
    s_waitcnt lgkmcnt(8)
    ds_read_b64_tr_b16 a[148:149], v231 offset:4096
    ds_read_b64_tr_b16 a[150:151], v231 offset:6144
    v_mfma_f32_16x16x32_bf16 v[4:7], a[128:131], v[0:3], 0
    s_waitcnt lgkmcnt(8)
    ds_read_b64_tr_b16 a[152:153], v231 offset:8192
    ds_read_b64_tr_b16 a[154:155], v231 offset:10240
    v_mfma_f32_16x16x32_bf16 v[4:7], a[132:135], v[8:11], v[4:7]
    s_waitcnt lgkmcnt(8)
    ds_read_b64_tr_b16 a[156:157], v231 offset:12288
    ds_read_b64_tr_b16 a[158:159], v231 offset:14336
    v_mfma_f32_16x16x32_bf16 v[4:7], a[136:139], v[16:19], v[4:7]
    s_waitcnt lgkmcnt(8)
    v_cvt_pk_bf16_f32 v54, v60, v61
    v_cvt_pk_bf16_f32 v55, v62, v63
    v_mfma_f32_16x16x32_bf16 v[4:7], a[140:143], v[24:27], v[4:7]
    s_waitcnt lgkmcnt(6)
    buffer_store_dwordx4 v[52:55], v222, s[52:55], s4 offen sc1
    v_mfma_f32_16x16x32_bf16 v[4:7], a[144:147], a[0:3], v[4:7]
    s_waitcnt lgkmcnt(4)
    ds_read_b64_tr_b16 a[80:81], v232 offset:0
    ds_read_b64_tr_b16 a[82:83], v232 offset:2048
    v_mfma_f32_16x16x32_bf16 v[4:7], a[148:151], a[4:7], v[4:7]
    s_waitcnt lgkmcnt(4)
    ds_read_b64_tr_b16 a[84:85], v232 offset:4096
    ds_read_b64_tr_b16 a[86:87], v232 offset:6144
    v_mfma_f32_16x16x32_bf16 v[4:7], a[152:155], a[8:11], v[4:7]
    s_waitcnt lgkmcnt(4)
    ds_read_b64_tr_b16 a[88:89], v232 offset:8192
    ds_read_b64_tr_b16 a[90:91], v232 offset:10240
    v_mfma_f32_16x16x32_bf16 v[4:7], a[156:159], a[12:15], v[4:7]
    s_add_u32 s4, s4, 2048
    v_mul_f32 v84, v84, v196
    v_mul_f32 v85, v85, v196
    v_mfma_f32_16x16x32_bf16 v[36:39], a[128:131], v[32:35], 0
    s_mul_i32 s85, s14, 2293760
    v_mul_f32 v86, v86, v196
    v_mul_f32 v87, v87, v196
    v_mfma_f32_16x16x32_bf16 v[36:39], a[132:135], v[40:43], v[36:39]
    s_add_u32 s32, s28, s85
    s_addc_u32 s33, s29, 0
    v_cvt_pk_bf16_f32 v84, v84, v85
    v_cvt_pk_bf16_f32 v85, v86, v87
    v_mfma_f32_16x16x32_bf16 v[36:39], a[136:139], v[48:51], v[36:39]
    s_and_b32 s33, s33, 0xffff
    v_mul_f32 v92, v92, v196
    v_mul_f32 v93, v93, v196
    v_mfma_f32_16x16x32_bf16 v[36:39], a[140:143], v[56:59], v[36:39]
    s_mov_b32 s97, 6656
    buffer_load_dwordx4 v223, s[48:51], s97 offen offset:1024 lds
    s_mov_b32 s34, 2293760
    s_mov_b32 s35, 0x20000
    v_mfma_f32_16x16x32_bf16 v[36:39], a[144:147], a[16:19], v[36:39]
    s_add_u32 s36, s24, 0
    s_addc_u32 s37, s25, 0
    v_mul_f32 v94, v94, v196
    v_mul_f32 v95, v95, v196
    v_mfma_f32_16x16x32_bf16 v[36:39], a[148:151], a[20:23], v[36:39]
    s_and_b32 s37, s37, 0xffff
    v_cvt_pk_bf16_f32 v86, v92, v93
    v_cvt_pk_bf16_f32 v87, v94, v95
    s_mov_b32 s38, 2293760
    v_mfma_f32_16x16x32_bf16 v[36:39], a[152:155], a[24:27], v[36:39]
    s_mov_b32 s39, 0x20000
    buffer_store_dwordx4 v[84:87], v222, s[52:55], s4 offen sc1
    v_mfma_f32_16x16x32_bf16 v[36:39], a[156:159], a[28:31], v[36:39]
    s_and_b32 s24, s14, 7
    ds_read_b64_tr_b16 a[92:93], v232 offset:12288
    ds_read_b64_tr_b16 a[94:95], v232 offset:14336
    s_mul_i32 s24, s24, 286720
    v_mfma_f32_16x16x32_bf16 v[68:71], a[128:131], v[64:67], 0
    s_lshr_b32 s25, s14, 3
    ds_read_b64_tr_b16 a[96:97], v233 offset:0
    ds_read_b64_tr_b16 a[98:99], v233 offset:2048
    v_mfma_f32_16x16x32_bf16 v[68:71], a[132:135], v[72:75], v[68:71]
    s_mul_i32 s25, s25, 896
    ds_read_b64_tr_b16 a[100:101], v233 offset:4096
    ds_read_b64_tr_b16 a[102:103], v233 offset:6144
    s_add_u32 s24, s24, s25
    v_mfma_f32_16x16x32_bf16 v[68:71], a[136:139], v[80:83], v[68:71]
    s_lshl_b32 s25, s15, 2
    ds_read_b64_tr_b16 a[104:105], v233 offset:8192
    s_add_u32 s25, s25, s30
    v_mfma_f32_16x16x32_bf16 v[68:71], a[140:143], v[88:91], v[68:71]
    s_waitcnt lgkmcnt(7)
    ds_read_b64_tr_b16 a[106:107], v233 offset:10240
    ds_read_b64_tr_b16 a[108:109], v233 offset:12288
    s_lshl_b32 s26, s25, 10
    v_mfma_f32_16x16x32_bf16 v[68:71], a[144:147], a[32:35], v[68:71]
    s_add_u32 s93, s26, 0
    ds_read_b64_tr_b16 a[110:111], v233 offset:14336
    s_mov_b32 s97, 12800
    v_mfma_f32_16x16x32_bf16 v[68:71], a[148:151], a[36:39], v[68:71]
    s_add_u32 s4, s4, 2048
    buffer_load_dwordx4 v223, s[48:51], s97 offen offset:2048 lds
    s_lshr_b32 s26, s25, 0
    s_add_u32 s26, s26, 0
    v_mfma_f32_16x16x32_bf16 v[68:71], a[152:155], a[40:43], v[68:71]
    s_mul_i32 s27, s26, 205
    v_mul_f32 v116, v116, v197
    v_mul_f32 v117, v117, v197
    v_mfma_f32_16x16x32_bf16 v[68:71], a[156:159], a[44:47], v[68:71]
    s_lshr_b32 s27, s27, 12
    v_mul_f32 v118, v118, v197
    v_mul_f32 v119, v119, v197
    s_mul_i32 s88, s27, 20
    v_mfma_f32_16x16x32_bf16 v[100:103], a[128:131], v[96:99], 0
    s_sub_u32 s26, s26, s88
    v_cvt_pk_bf16_f32 v116, v116, v117
    v_cvt_pk_bf16_f32 v117, v118, v119
    v_mfma_f32_16x16x32_bf16 v[100:103], a[132:135], v[104:107], v[100:103]
    s_lshl_b32 s27, s27, 7
    v_mul_f32 v124, v124, v197
    v_mul_f32 v125, v125, v197
    s_and_b32 s88, s26, 1
    v_mfma_f32_16x16x32_bf16 v[100:103], a[136:139], v[112:115], v[100:103]
    s_lshl_b32 s88, s88, 6
    v_mul_f32 v126, v126, v197
    v_mul_f32 v127, v127, v197
    v_mfma_f32_16x16x32_bf16 v[100:103], a[140:143], v[120:123], v[100:103]
    s_add_u32 s27, s27, s88
    v_cvt_pk_bf16_f32 v118, v124, v125
    v_cvt_pk_bf16_f32 v119, v126, v127
    s_lshr_b32 s26, s26, 1
    v_mfma_f32_16x16x32_bf16 v[100:103], a[144:147], a[48:51], v[100:103]
    s_mul_i32 s26, s26, 28672
    buffer_store_dwordx4 v[116:119], v222, s[52:55], s4 offen sc1
    v_mfma_f32_16x16x32_bf16 v[100:103], a[148:151], a[52:55], v[100:103]
    s_add_u32 s27, s27, s26
    s_and_b32 s26, s25, 0
    s_mov_b32 s97, 18944
    v_mfma_f32_16x16x32_bf16 v[100:103], a[152:155], a[56:59], v[100:103]
    s_mul_i32 s26, s26, 0
    buffer_load_dwordx4 v223, s[48:51], s97 offen offset:3072 lds
    v_mfma_f32_16x16x32_bf16 v[100:103], a[156:159], a[60:63], v[100:103]
    s_add_u32 s27, s27, s26
    s_add_u32 s90, s27, s24
    s_lshl_b32 s26, s25, 10
    v_mfma_f32_16x16x32_bf16 v[132:135], a[128:131], v[128:131], 0
    s_add_u32 s94, s26, 65536
    s_lshr_b32 s26, s25, 0
    s_add_u32 s26, s26, 64
    v_mfma_f32_16x16x32_bf16 v[132:135], a[132:135], v[136:139], v[132:135]
    s_add_u32 s4, s4, 2048
    v_mul_f32 v148, v148, v198
    v_mul_f32 v149, v149, v198
    v_mfma_f32_16x16x32_bf16 v[132:135], a[136:139], v[144:147], v[132:135]
    s_mul_i32 s27, s26, 205
    v_mul_f32 v150, v150, v198
    v_mul_f32 v151, v151, v198
    v_mfma_f32_16x16x32_bf16 v[132:135], a[140:143], v[152:155], v[132:135]
    s_lshr_b32 s27, s27, 12
    v_cvt_pk_bf16_f32 v148, v148, v149
    v_cvt_pk_bf16_f32 v149, v150, v151
    v_mfma_f32_16x16x32_bf16 v[132:135], a[144:147], a[64:67], v[132:135]
    s_mul_i32 s88, s27, 20
    v_mul_f32 v156, v156, v198
    v_mul_f32 v157, v157, v198
    v_mfma_f32_16x16x32_bf16 v[132:135], a[148:151], a[68:71], v[132:135]
    s_sub_u32 s26, s26, s88
    v_mul_f32 v158, v158, v198
    v_mul_f32 v159, v159, v198
    v_mfma_f32_16x16x32_bf16 v[132:135], a[152:155], a[72:75], v[132:135]
    s_lshl_b32 s27, s27, 7
    v_cvt_pk_bf16_f32 v150, v156, v157
    v_cvt_pk_bf16_f32 v151, v158, v159
    s_and_b32 s88, s26, 1
    v_mfma_f32_16x16x32_bf16 v[132:135], a[156:159], a[76:79], v[132:135]
    s_lshl_b32 s88, s88, 6
    buffer_store_dwordx4 v[148:151], v222, s[52:55], s4 offen sc1
    v_mfma_f32_16x16x32_bf16 v[12:15], a[80:83], v[0:3], 0
    s_add_u32 m0, s92, 81920
    s_add_u32 s27, s27, s88
    s_lshr_b32 s26, s26, 1
    v_mfma_f32_16x16x32_bf16 v[12:15], a[84:87], v[8:11], v[12:15]
    s_mov_b32 s97, 115200
    buffer_load_dwordx4 v223, s[48:51], s97 offen offset:0 lds
    s_mul_i32 s26, s26, 28672
    v_mfma_f32_16x16x32_bf16 v[12:15], a[88:91], v[16:19], v[12:15]
    s_waitcnt lgkmcnt(0)
    s_add_u32 s27, s27, s26
    s_and_b32 s26, s25, 0
    v_mfma_f32_16x16x32_bf16 v[12:15], a[92:95], v[24:27], v[12:15]
    s_mul_i32 s26, s26, 0
    s_add_u32 s27, s27, s26
    s_add_u32 s91, s27, s24
    v_mfma_f32_16x16x32_bf16 v[12:15], a[96:99], a[0:3], v[12:15]
    s_lshl_b32 s26, s25, 8
    s_add_u32 s95, s26, 131072
    s_lshr_b32 s26, s25, 2
    v_mfma_f32_16x16x32_bf16 v[12:15], a[100:103], a[4:7], v[12:15]
    s_add_u32 s26, s26, 128
    s_mul_i32 s27, s26, 205
    s_lshr_b32 s27, s27, 12
    v_mfma_f32_16x16x32_bf16 v[12:15], a[104:107], a[8:11], v[12:15]
    s_add_u32 s4, s4, 12288
    s_mul_i32 s88, s27, 20
    s_mov_b32 s97, 121344
    v_mfma_f32_16x16x32_bf16 v[12:15], a[108:111], a[12:15], v[12:15]
    s_sub_u32 s26, s26, s88
    buffer_load_dwordx4 v223, s[48:51], s97 offen offset:1024 lds
    v_mfma_f32_16x16x32_bf16 v[44:47], a[80:83], v[32:35], 0
    s_lshl_b32 s27, s27, 7
    s_and_b32 s88, s26, 1
    s_lshl_b32 s88, s88, 6
    v_mfma_f32_16x16x32_bf16 v[44:47], a[84:87], v[40:43], v[44:47]
    s_add_u32 s27, s27, s88
    s_mov_b32 s12, 98304
    s_cmp_eq_u32 s10, 0
    s_cselect_b32 s5, s12, 114688
    s_cselect_b32 s6, 114688, s12
    v_mfma_f32_16x16x32_bf16 v[44:47], a[88:91], v[48:51], v[44:47]
    s_lshr_b32 s26, s26, 1
    v_add_u32 v234, s5, v238
    v_add_u32 v235, s6, v238
    v_mfma_f32_16x16x32_bf16 v[44:47], a[92:95], v[56:59], v[44:47]
    s_mul_i32 s26, s26, 28672
    v_add_u32 v236, s5, v239
    v_mul_f32 v4, v4, v194
    v_mfma_f32_16x16x32_bf16 v[44:47], a[96:99], a[16:19], v[44:47]
L_pg7:
    s_cbranch_execz L_pgret
    s_add_u32 s27, s27, s26
    v_mul_f32 v5, v5, v194
    v_mul_f32 v6, v6, v194
    v_mfma_f32_16x16x32_bf16 v[44:47], a[100:103], a[20:23], v[44:47]
    s_and_b32 s26, s25, 3
    v_mul_f32 v7, v7, v194
    s_mul_i32 s26, s26, 8
    v_mfma_f32_16x16x32_bf16 v[44:47], a[104:107], a[24:27], v[44:47]
    s_add_u32 s27, s27, s26
    v_add_u32 v237, s6, v239
    v_cvt_pk_bf16_f32 v4, v4, v5
    v_mfma_f32_16x16x32_bf16 v[44:47], a[108:111], a[28:31], v[44:47]
    s_add_u32 s13, s27, s24
    v_cvt_pk_bf16_f32 v5, v6, v7
    s_cmp_lt_u32 s15, 12
    s_cselect_b32 s95, s95, 0x4000000
    s_cselect_b32 s13, s13, 0x4000000
    v_mfma_f32_16x16x32_bf16 v[76:79], a[80:83], v[64:67], 0
    s_mov_b32 s97, 127488
    buffer_load_dwordx4 v223, s[48:51], s97 offen offset:2048 lds
    v_mfma_f32_16x16x32_bf16 v[76:79], a[84:87], v[72:75], v[76:79]
    v_lshrrev_b32 v212, 1, v222
    v_lshrrev_b32 v213, 2, v222
    v_mfma_f32_16x16x32_bf16 v[76:79], a[88:91], v[80:83], v[76:79]
    v_bfe_u32 v204, v222, 4, 4
    v_mul_f32 v12, v12, v194
    v_mfma_f32_16x16x32_bf16 v[76:79], a[92:95], v[88:91], v[76:79]
    v_mul_f32 v13, v13, v194
    v_mul_f32 v14, v14, v194
    v_mfma_f32_16x16x32_bf16 v[76:79], a[96:99], a[32:35], v[76:79]
    s_mov_b32 s97, 133632
    v_mul_u32_u24 v204, 1792, v204
    v_mul_f32 v15, v15, v194
    v_mfma_f32_16x16x32_bf16 v[76:79], a[100:103], a[36:39], v[76:79]
    buffer_load_dwordx4 v223, s[48:51], s97 offen offset:3072 lds
    v_mfma_f32_16x16x32_bf16 v[76:79], a[104:107], a[40:43], v[76:79]
    v_cvt_pk_bf16_f32 v6, v12, v13
    v_lshrrev_b32 v242, 8, v222
    v_mfma_f32_16x16x32_bf16 v[76:79], a[108:111], a[44:47], v[76:79]
    v_cvt_pk_bf16_f32 v7, v14, v15
    v_lshl_add_u32 v204, v242, 4, v204
    v_mfma_f32_16x16x32_bf16 v[108:111], a[80:83], v[96:99], 0
    buffer_store_dwordx4 v[4:7], v222, s[52:55], s4 offen sc1
    v_mfma_f32_16x16x32_bf16 v[108:111], a[84:87], v[104:107], v[108:111]
    s_add_u32 s4, s4, 2048
    v_mul_f32 v36, v36, v195
    v_mul_f32 v37, v37, v195
    v_mfma_f32_16x16x32_bf16 v[108:111], a[88:91], v[112:115], v[108:111]
    v_mul_f32 v38, v38, v195
    v_lshrrev_b32 v243, 9, v222
    v_mfma_f32_16x16x32_bf16 v[108:111], a[92:95], v[120:123], v[108:111]
    v_mul_f32 v39, v39, v195
    v_mfma_f32_16x16x32_bf16 v[108:111], a[96:99], a[48:51], v[108:111]
    v_cvt_pk_bf16_f32 v36, v36, v37
    v_bfe_u32 v205, v222, 5, 4
    v_mfma_f32_16x16x32_bf16 v[108:111], a[100:103], a[52:55], v[108:111]
    v_cvt_pk_bf16_f32 v37, v38, v39
    v_mfma_f32_16x16x32_bf16 v[108:111], a[104:107], a[56:59], v[108:111]
    v_mul_f32 v44, v44, v195
    v_mfma_f32_16x16x32_bf16 v[108:111], a[108:111], a[60:63], v[108:111]
    s_waitcnt vmcnt(13)
    s_barrier
    ds_read_b64_tr_b16 a[112:113], v234 offset:0
    v_mfma_f32_16x16x32_bf16 v[140:143], a[80:83], v[128:131], 0
    s_add_u32 m0, s92, 49152
    ds_read_b64_tr_b16 a[114:115], v234 offset:2048
    ds_read_b64_tr_b16 a[116:117], v234 offset:4096
    v_mfma_f32_16x16x32_bf16 v[140:143], a[84:87], v[136:139], v[140:143]
    s_mov_b32 s97, 640
    ds_read_b64_tr_b16 a[118:119], v234 offset:6144
    ds_read_b64_tr_b16 a[120:121], v234 offset:8192
    v_mfma_f32_16x16x32_bf16 v[140:143], a[88:91], v[144:147], v[140:143]
    ds_read_b64_tr_b16 a[122:123], v234 offset:10240
    v_mul_f32 v45, v45, v195
    v_mfma_f32_16x16x32_bf16 v[140:143], a[92:95], v[152:155], v[140:143]
    ds_read_b64_tr_b16 a[124:125], v234 offset:12288
    v_mul_u32_u24 v205, 1792, v205
    v_mfma_f32_16x16x32_bf16 v[140:143], a[96:99], a[64:67], v[140:143]
    ds_read_b64_tr_b16 a[126:127], v234 offset:14336
    v_mul_f32 v46, v46, v195
    v_mfma_f32_16x16x32_bf16 v[140:143], a[100:103], a[68:71], v[140:143]
    buffer_load_dwordx4 v223, s[48:51], s97 offen offset:0 lds
    v_mfma_f32_16x16x32_bf16 v[140:143], a[104:107], a[72:75], v[140:143]
    ds_read_b64_tr_b16 a[128:129], v235 offset:0
    ds_read_b64_tr_b16 a[130:131], v235 offset:2048
    v_mfma_f32_16x16x32_bf16 v[140:143], a[108:111], a[76:79], v[140:143]
    s_waitcnt lgkmcnt(8)
    ds_read_b64_tr_b16 a[132:133], v235 offset:4096
    ds_read_b64_tr_b16 a[134:135], v235 offset:6144
    v_mfma_f32_16x16x32_bf16 v[20:23], a[112:115], v[0:3], 0
    s_waitcnt lgkmcnt(8)
    ds_read_b64_tr_b16 a[136:137], v235 offset:8192
    ds_read_b64_tr_b16 a[138:139], v235 offset:10240
    v_mfma_f32_16x16x32_bf16 v[20:23], a[116:119], v[8:11], v[20:23]
    s_waitcnt lgkmcnt(8)
    ds_read_b64_tr_b16 a[140:141], v235 offset:12288
    ds_read_b64_tr_b16 a[142:143], v235 offset:14336
    v_mfma_f32_16x16x32_bf16 v[20:23], a[120:123], v[16:19], v[20:23]
    s_waitcnt lgkmcnt(8)
    v_mul_f32 v47, v47, v195
    v_cvt_pk_bf16_f32 v38, v44, v45
    v_mfma_f32_16x16x32_bf16 v[20:23], a[124:127], v[24:27], v[20:23]
    s_waitcnt lgkmcnt(6)
    v_lshl_add_u32 v205, v243, 3, v205
    v_cvt_pk_bf16_f32 v39, v46, v47
    v_mfma_f32_16x16x32_bf16 v[20:23], a[128:131], a[0:3], v[20:23]
    s_waitcnt lgkmcnt(4)
    buffer_store_dwordx4 v[36:39], v222, s[52:55], s4 offen sc1
    v_mfma_f32_16x16x32_bf16 v[20:23], a[132:135], a[4:7], v[20:23]
    s_waitcnt lgkmcnt(2)
    v_bfe_u32 v242, v222, 4, 1
    v_lshl_add_u32 v205, v242, 5, v205
    v_mfma_f32_16x16x32_bf16 v[20:23], a[136:139], a[8:11], v[20:23]
    s_waitcnt lgkmcnt(0)
    v_lshrrev_b32 v206, 6, v222
    v_mul_u32_u24 v206, 1792, v206
    v_mfma_f32_16x16x32_bf16 v[20:23], a[140:143], a[12:15], v[20:23]
    s_add_u32 s4, s4, 2048
    v_mul_f32 v68, v68, v196
    v_mul_f32 v69, v69, v196
    v_mfma_f32_16x16x32_bf16 v[52:55], a[112:115], v[32:35], 0
    s_mov_b32 s97, 6784
    buffer_load_dwordx4 v223, s[48:51], s97 offen offset:1024 lds
    v_mfma_f32_16x16x32_bf16 v[52:55], a[116:119], v[40:43], v[52:55]
    v_mul_f32 v70, v70, v196
    v_mul_f32 v71, v71, v196
    v_mfma_f32_16x16x32_bf16 v[52:55], a[120:123], v[48:51], v[52:55]
    v_cvt_pk_bf16_f32 v68, v68, v69
    v_cvt_pk_bf16_f32 v69, v70, v71
    v_mfma_f32_16x16x32_bf16 v[52:55], a[124:127], v[56:59], v[52:55]
    v_mul_f32 v76, v76, v196
    v_mul_f32 v77, v77, v196
    v_mfma_f32_16x16x32_bf16 v[52:55], a[128:131], a[16:19], v[52:55]
    s_mov_b32 s97, 12928
    v_mul_f32 v78, v78, v196
    v_mul_f32 v79, v79, v196
    v_mfma_f32_16x16x32_bf16 v[52:55], a[132:135], a[20:23], v[52:55]
    v_lshl_add_u32 v206, v242, 2, v206
    v_cvt_pk_bf16_f32 v70, v76, v77
    v_mfma_f32_16x16x32_bf16 v[52:55], a[136:139], a[24:27], v[52:55]
    v_cvt_pk_bf16_f32 v71, v78, v79
    v_bfe_u32 v242, v222, 5, 1
    v_mfma_f32_16x16x32_bf16 v[52:55], a[140:143], a[28:31], v[52:55]
    buffer_store_dwordx4 v[68:71], v222, s[52:55], s4 offen sc1
    v_mfma_f32_16x16x32_bf16 v[84:87], a[112:115], v[64:67], 0
    s_add_u32 s4, s4, 2048
    buffer_load_dwordx4 v223, s[48:51], s97 offen offset:2048 lds
    v_mfma_f32_16x16x32_bf16 v[84:87], a[116:119], v[72:75], v[84:87]
    v_mul_f32 v100, v100, v197
    v_mul_f32 v101, v101, v197
    v_mfma_f32_16x16x32_bf16 v[84:87], a[120:123], v[80:83], v[84:87]
    v_lshl_add_u32 v206, v242, 5, v206
    v_mul_f32 v102, v102, v197
    v_mfma_f32_16x16x32_bf16 v[84:87], a[124:127], v[88:91], v[84:87]
    v_mul_f32 v103, v103, v197
    v_add_u32 v214, s31, v222
    v_mfma_f32_16x16x32_bf16 v[84:87], a[128:131], a[32:35], v[84:87]
    v_cvt_pk_bf16_f32 v100, v100, v101
    v_cvt_pk_bf16_f32 v101, v102, v103
    v_mfma_f32_16x16x32_bf16 v[84:87], a[132:135], a[36:39], v[84:87]
    s_mov_b32 s97, 19072
    v_mul_f32 v108, v108, v197
    v_lshrrev_b32 v242, 4, v214
    v_mfma_f32_16x16x32_bf16 v[84:87], a[136:139], a[40:43], v[84:87]
    v_mul_f32 v109, v109, v197
    v_mul_f32 v110, v110, v197
    v_mfma_f32_16x16x32_bf16 v[84:87], a[140:143], a[44:47], v[84:87]
    ds_read_b64_tr_b16 a[144:145], v236 offset:0
    v_mul_f32 v111, v111, v197
    v_mfma_f32_16x16x32_bf16 v[116:119], a[112:115], v[96:99], 0
    v_lshlrev_b32 v214, 3, v214
    v_cvt_pk_bf16_f32 v102, v108, v109
    v_mfma_f32_16x16x32_bf16 v[116:119], a[116:119], v[104:107], v[116:119]
    buffer_load_dwordx4 v223, s[48:51], s97 offen offset:3072 lds
    v_mfma_f32_16x16x32_bf16 v[116:119], a[120:123], v[112:115], v[116:119]
    v_cvt_pk_bf16_f32 v103, v110, v111
    v_lshl_add_u32 v214, v242, 16, v214
    v_mfma_f32_16x16x32_bf16 v[116:119], a[124:127], v[120:123], v[116:119]
    buffer_store_dwordx4 v[100:103], v222, s[52:55], s4 offen sc1
    v_mfma_f32_16x16x32_bf16 v[116:119], a[128:131], a[48:51], v[116:119]
    s_add_u32 s4, s4, 2048
    ds_read_b64_tr_b16 a[146:147], v236 offset:2048
    v_min_u32 v215, 60, v213
    v_mfma_f32_16x16x32_bf16 v[116:119], a[132:135], a[52:55], v[116:119]
    s_mul_i32 s26, s15, 0
    ds_read_b64_tr_b16 a[148:149], v236 offset:4096
    v_mul_f32 v132, v132, v198
    v_mfma_f32_16x16x32_bf16 v[116:119], a[136:139], a[56:59], v[116:119]
    v_mul_f32 v133, v133, v198
    v_mul_f32 v134, v134, v198
    v_mfma_f32_16x16x32_bf16 v[116:119], a[140:143], a[60:63], v[116:119]
    s_add_u32 m0, s92, 147456
    ds_read_b64_tr_b16 a[150:151], v236 offset:6144
    v_mul_f32 v135, v135, v198
    v_mfma_f32_16x16x32_bf16 v[148:151], a[112:115], v[128:131], 0
    s_mov_b32 s97, 115328
    ds_read_b64_tr_b16 a[152:153], v236 offset:8192
    v_cvt_pk_bf16_f32 v132, v132, v133
    v_mfma_f32_16x16x32_bf16 v[148:151], a[116:119], v[136:139], v[148:151]
    ds_read_b64_tr_b16 a[154:155], v236 offset:10240
    v_add_u32 v215, s26, v215
    v_mfma_f32_16x16x32_bf16 v[148:151], a[120:123], v[144:147], v[148:151]
    ds_read_b64_tr_b16 a[156:157], v236 offset:12288
    v_cvt_pk_bf16_f32 v133, v134, v135
    v_mfma_f32_16x16x32_bf16 v[148:151], a[124:127], v[152:155], v[148:151]
    ds_read_b64_tr_b16 a[158:159], v236 offset:14336
    v_mul_f32 v140, v140, v198
    v_mfma_f32_16x16x32_bf16 v[148:151], a[128:131], a[64:67], v[148:151]
    buffer_load_dwordx4 v223, s[48:51], s97 offen offset:0 lds
    v_mfma_f32_16x16x32_bf16 v[148:151], a[132:135], a[68:71], v[148:151]
    ds_read_b64_tr_b16 a[80:81], v237 offset:0
    ds_read_b64_tr_b16 a[82:83], v237 offset:2048
    v_mfma_f32_16x16x32_bf16 v[148:151], a[136:139], a[72:75], v[148:151]
    ds_read_b64_tr_b16 a[84:85], v237 offset:4096
    ds_read_b64_tr_b16 a[86:87], v237 offset:6144
    v_mfma_f32_16x16x32_bf16 v[148:151], a[140:143], a[76:79], v[148:151]
    s_waitcnt lgkmcnt(8)
    ds_read_b64_tr_b16 a[88:89], v237 offset:8192
    ds_read_b64_tr_b16 a[90:91], v237 offset:10240
    v_mfma_f32_16x16x32_bf16 v[28:31], a[144:147], v[0:3], 0
    ds_read_b64_tr_b16 a[92:93], v237 offset:12288
    ds_read_b64_tr_b16 a[94:95], v237 offset:14336
    v_mfma_f32_16x16x32_bf16 v[28:31], a[148:151], v[8:11], v[28:31]
    s_waitcnt lgkmcnt(10)
    v_mov_b32 v216, 1
    v_mul_f32 v141, v141, v198
    v_mfma_f32_16x16x32_bf16 v[28:31], a[152:155], v[16:19], v[28:31]
    s_waitcnt lgkmcnt(8)
    v_mul_f32 v142, v142, v198
    v_mul_f32 v143, v143, v198
    v_mfma_f32_16x16x32_bf16 v[28:31], a[156:159], v[24:27], v[28:31]
    s_waitcnt lgkmcnt(6)
    v_mov_b32 v242, 0
    v_cvt_pk_bf16_f32 v134, v140, v141
    v_mfma_f32_16x16x32_bf16 v[28:31], a[80:83], a[0:3], v[28:31]
    s_waitcnt lgkmcnt(4)
    buffer_load_dword v244, v242, s[20:23], 0 offen sc1
    v_mfma_f32_16x16x32_bf16 v[28:31], a[84:87], a[4:7], v[28:31]
    s_waitcnt lgkmcnt(2)
    v_cvt_pk_bf16_f32 v135, v142, v143
    s_mov_b32 s97, 121472
    v_mfma_f32_16x16x32_bf16 v[28:31], a[88:91], a[8:11], v[28:31]
    s_waitcnt lgkmcnt(0)
    buffer_store_dwordx4 v[132:135], v222, s[52:55], s4 offen sc1
    v_mfma_f32_16x16x32_bf16 v[28:31], a[92:95], a[12:15], v[28:31]
    s_add_u32 s4, s4, 12288
    buffer_load_dwordx4 v223, s[48:51], s97 offen offset:1024 lds
    v_mfma_f32_16x16x32_bf16 v[60:63], a[144:147], v[32:35], 0
    s_lshl_b32 s89, s15, 2
    v_bfe_u32 v252, v222, 6, 1
    v_lshlrev_b32 v252, 3, v252
    v_mfma_f32_16x16x32_bf16 v[60:63], a[148:151], v[40:43], v[60:63]
    s_mov_b32 s12, 65536
    v_bfe_u32 v253, v222, 7, 1
    s_cmp_eq_u32 s10, 0
    s_cselect_b32 s5, s12, 81920
    s_cselect_b32 s6, 81920, s12
    v_mfma_f32_16x16x32_bf16 v[60:63], a[152:155], v[48:51], v[60:63]
    v_add_u32 v230, s5, v238
    v_add_u32 v231, s6, v238
    v_mfma_f32_16x16x32_bf16 v[60:63], a[156:159], v[56:59], v[60:63]
    s_mov_b32 s97, 127616
    v_add_u32 v232, s5, v239
    v_mul_f32 v20, v20, v194
    v_mfma_f32_16x16x32_bf16 v[60:63], a[80:83], a[16:19], v[60:63]
    buffer_load_dwordx4 v223, s[48:51], s97 offen offset:2048 lds
    v_mfma_f32_16x16x32_bf16 v[60:63], a[84:87], a[20:23], v[60:63]
    v_mul_f32 v21, v21, v194
    v_mul_f32 v22, v22, v194
    v_mfma_f32_16x16x32_bf16 v[60:63], a[88:91], a[24:27], v[60:63]
    v_lshl_add_u32 v252, v253, 1, v252
    v_mul_f32 v23, v23, v194
    v_mfma_f32_16x16x32_bf16 v[60:63], a[92:95], a[28:31], v[60:63]
    v_add_u32 v233, s6, v239
    v_cvt_pk_bf16_f32 v20, v20, v21
    v_mfma_f32_16x16x32_bf16 v[92:95], a[144:147], v[64:67], 0
    v_cvt_pk_bf16_f32 v21, v22, v23
    v_bfe_u32 v253, v222, 5, 1
    v_mfma_f32_16x16x32_bf16 v[92:95], a[148:151], v[72:75], v[92:95]
    v_mul_f32 v28, v28, v194
    v_mul_f32 v29, v29, v194
    v_mfma_f32_16x16x32_bf16 v[92:95], a[152:155], v[80:83], v[92:95]
    v_add_u32 v252, v252, v253
    v_mul_f32 v30, v30, v194
    v_mfma_f32_16x16x32_bf16 v[92:95], a[156:159], v[88:91], v[92:95]
    v_mul_f32 v31, v31, v194
    v_mfma_f32_16x16x32_bf16 v[92:95], a[80:83], a[32:35], v[92:95]
    s_mov_b32 s97, 133760
    v_cvt_pk_bf16_f32 v22, v28, v29
    v_lshrrev_b32 v253, 8, v222
    v_mfma_f32_16x16x32_bf16 v[92:95], a[84:87], a[36:39], v[92:95]
    buffer_load_dwordx4 v223, s[48:51], s97 offen offset:3072 lds
    v_mfma_f32_16x16x32_bf16 v[92:95], a[88:91], a[40:43], v[92:95]
    v_cvt_pk_bf16_f32 v23, v30, v31
    v_mfma_f32_16x16x32_bf16 v[92:95], a[92:95], a[44:47], v[92:95]
    buffer_store_dwordx4 v[20:23], v222, s[52:55], s4 offen sc1
    v_mfma_f32_16x16x32_bf16 v[124:127], a[144:147], v[96:99], 0
    s_add_u32 s4, s4, 2048
    v_lshlrev_b32 v253, 2, v253
    v_mfma_f32_16x16x32_bf16 v[124:127], a[148:151], v[104:107], v[124:127]
    v_mul_f32 v52, v52, v195
    v_mul_f32 v53, v53, v195
    v_mfma_f32_16x16x32_bf16 v[124:127], a[152:155], v[112:115], v[124:127]
    v_sub_u32 v252, v252, v253
    v_mul_f32 v54, v54, v195
    v_mfma_f32_16x16x32_bf16 v[124:127], a[156:159], v[120:123], v[124:127]
    v_mul_f32 v55, v55, v195
    v_mfma_f32_16x16x32_bf16 v[124:127], a[80:83], a[48:51], v[124:127]
    v_cvt_pk_bf16_f32 v52, v52, v53
    v_and_b32 v253, 16, v222
    v_mfma_f32_16x16x32_bf16 v[124:127], a[84:87], a[52:55], v[124:127]
    v_cvt_pk_bf16_f32 v53, v54, v55
    v_mfma_f32_16x16x32_bf16 v[124:127], a[88:91], a[56:59], v[124:127]
    v_mul_f32 v60, v60, v195
    v_mfma_f32_16x16x32_bf16 v[124:127], a[92:95], a[60:63], v[124:127]
    s_waitcnt vmcnt(15)
    s_barrier
    ds_read_b64_tr_b16 a[96:97], v230 offset:0
    v_mfma_f32_16x16x32_bf16 v[156:159], a[144:147], v[128:131], 0
    s_add_u32 m0, s92, 0
    ds_read_b64_tr_b16 a[98:99], v230 offset:2048
    ds_read_b64_tr_b16 a[100:101], v230 offset:4096
    v_mfma_f32_16x16x32_bf16 v[156:159], a[148:151], v[136:139], v[156:159]
    s_mov_b32 s97, 768
    ds_read_b64_tr_b16 a[102:103], v230 offset:6144
    ds_read_b64_tr_b16 a[104:105], v230 offset:8192
    v_mfma_f32_16x16x32_bf16 v[156:159], a[152:155], v[144:147], v[156:159]
    ds_read_b64_tr_b16 a[106:107], v230 offset:10240
    v_mul_f32 v61, v61, v195
    v_mfma_f32_16x16x32_bf16 v[156:159], a[156:159], v[152:155], v[156:159]
    ds_read_b64_tr_b16 a[108:109], v230 offset:12288
    v_mov_b32 v251, 0x3f80
    v_mfma_f32_16x16x32_bf16 v[156:159], a[80:83], a[64:67], v[156:159]
    ds_read_b64_tr_b16 a[110:111], v230 offset:14336
    v_mul_f32 v62, v62, v195
    v_mfma_f32_16x16x32_bf16 v[156:159], a[84:87], a[68:71], v[156:159]
    buffer_load_dwordx4 v223, s[48:51], s97 offen offset:0 lds
    v_mfma_f32_16x16x32_bf16 v[156:159], a[88:91], a[72:75], v[156:159]
    ds_read_b64_tr_b16 a[112:113], v231 offset:0
    ds_read_b64_tr_b16 a[114:115], v231 offset:2048
    v_mfma_f32_16x16x32_bf16 v[156:159], a[92:95], a[76:79], v[156:159]
    s_waitcnt lgkmcnt(8)
    ds_read_b64_tr_b16 a[116:117], v231 offset:4096
    ds_read_b64_tr_b16 a[118:119], v231 offset:6144
    v_mfma_f32_16x16x32_bf16 v[4:7], a[96:99], v[0:3], 0
    s_waitcnt lgkmcnt(8)
    ds_read_b64_tr_b16 a[120:121], v231 offset:8192
    ds_read_b64_tr_b16 a[122:123], v231 offset:10240
    v_mfma_f32_16x16x32_bf16 v[4:7], a[100:103], v[8:11], v[4:7]
    s_waitcnt lgkmcnt(8)
    ds_read_b64_tr_b16 a[124:125], v231 offset:12288
    ds_read_b64_tr_b16 a[126:127], v231 offset:14336
    v_mfma_f32_16x16x32_bf16 v[4:7], a[104:107], v[16:19], v[4:7]
    s_waitcnt lgkmcnt(8)
    v_mul_f32 v63, v63, v195
    v_cvt_pk_bf16_f32 v54, v60, v61
    v_mfma_f32_16x16x32_bf16 v[4:7], a[108:111], v[24:27], v[4:7]
    s_waitcnt lgkmcnt(6)
    v_lshlrev_b32 v253, v253, v251
    v_cvt_pk_bf16_f32 v55, v62, v63
    v_mfma_f32_16x16x32_bf16 v[4:7], a[112:115], a[0:3], v[4:7]
    s_waitcnt lgkmcnt(4)
    buffer_store_dwordx4 v[52:55], v222, s[52:55], s4 offen sc1
    v_mfma_f32_16x16x32_bf16 v[4:7], a[116:119], a[4:7], v[4:7]
    s_waitcnt lgkmcnt(2)
    v_cmp_eq_u32 vcc, 0, v252
    s_nop 1
    v_cndmask_b32 v184, 0, v253, vcc
    v_mfma_f32_16x16x32_bf16 v[4:7], a[120:123], a[8:11], v[4:7]
    s_waitcnt lgkmcnt(0)
    v_cmp_eq_u32 vcc, 1, v252
    s_nop 1
    v_cndmask_b32 v185, 0, v253, vcc
    v_mfma_f32_16x16x32_bf16 v[4:7], a[124:127], a[12:15], v[4:7]
    s_add_u32 s4, s4, 2048
    v_mul_f32 v84, v84, v196
    v_mul_f32 v85, v85, v196
    v_mfma_f32_16x16x32_bf16 v[36:39], a[96:99], v[32:35], 0
    s_mov_b32 s97, 6912
    buffer_load_dwordx4 v223, s[48:51], s97 offen offset:1024 lds
    v_mfma_f32_16x16x32_bf16 v[36:39], a[100:103], v[40:43], v[36:39]
    v_mul_f32 v86, v86, v196
    v_mul_f32 v87, v87, v196
    v_mfma_f32_16x16x32_bf16 v[36:39], a[104:107], v[48:51], v[36:39]
    v_cvt_pk_bf16_f32 v84, v84, v85
    v_cvt_pk_bf16_f32 v85, v86, v87
    v_mfma_f32_16x16x32_bf16 v[36:39], a[108:111], v[56:59], v[36:39]
    v_mul_f32 v92, v92, v196
    v_mul_f32 v93, v93, v196
    v_mfma_f32_16x16x32_bf16 v[36:39], a[112:115], a[16:19], v[36:39]
    s_mov_b32 s97, 13056
    v_mul_f32 v94, v94, v196
    v_mul_f32 v95, v95, v196
    v_mfma_f32_16x16x32_bf16 v[36:39], a[116:119], a[20:23], v[36:39]
    v_cmp_eq_u32 vcc, 2, v252
    v_cvt_pk_bf16_f32 v86, v92, v93
    v_mfma_f32_16x16x32_bf16 v[36:39], a[120:123], a[24:27], v[36:39]
    v_cvt_pk_bf16_f32 v87, v94, v95
    v_cndmask_b32 v186, 0, v253, vcc
    v_mfma_f32_16x16x32_bf16 v[36:39], a[124:127], a[28:31], v[36:39]
    buffer_store_dwordx4 v[84:87], v222, s[52:55], s4 offen sc1
    v_mfma_f32_16x16x32_bf16 v[68:71], a[96:99], v[64:67], 0
    s_add_u32 s4, s4, 2048
    buffer_load_dwordx4 v223, s[48:51], s97 offen offset:2048 lds
    v_mfma_f32_16x16x32_bf16 v[68:71], a[100:103], v[72:75], v[68:71]
    v_cmp_eq_u32 vcc, 3, v252
    v_mul_f32 v116, v116, v197
    v_mfma_f32_16x16x32_bf16 v[68:71], a[104:107], v[80:83], v[68:71]
    v_mul_f32 v117, v117, v197
    v_mul_f32 v118, v118, v197
    v_mfma_f32_16x16x32_bf16 v[68:71], a[108:111], v[88:91], v[68:71]
    v_mul_f32 v119, v119, v197
    v_cndmask_b32 v187, 0, v253, vcc
    v_mfma_f32_16x16x32_bf16 v[68:71], a[112:115], a[32:35], v[68:71]
    v_cvt_pk_bf16_f32 v116, v116, v117
    v_cvt_pk_bf16_f32 v117, v118, v119
    v_mfma_f32_16x16x32_bf16 v[68:71], a[116:119], a[36:39], v[68:71]
    s_mov_b32 s97, 19200
    v_mul_f32 v124, v124, v197
    v_cmp_eq_u32 vcc, -4, v252
    v_mfma_f32_16x16x32_bf16 v[68:71], a[120:123], a[40:43], v[68:71]
    v_mul_f32 v125, v125, v197
    v_mul_f32 v126, v126, v197
    v_mfma_f32_16x16x32_bf16 v[68:71], a[124:127], a[44:47], v[68:71]
    ds_read_b64_tr_b16 a[128:129], v232 offset:0
    v_mul_f32 v127, v127, v197
    v_mfma_f32_16x16x32_bf16 v[100:103], a[96:99], v[96:99], 0
    v_cndmask_b32 v188, 0, v253, vcc
    v_cvt_pk_bf16_f32 v118, v124, v125
    v_mfma_f32_16x16x32_bf16 v[100:103], a[100:103], v[104:107], v[100:103]
    buffer_load_dwordx4 v223, s[48:51], s97 offen offset:3072 lds
    v_mfma_f32_16x16x32_bf16 v[100:103], a[104:107], v[112:115], v[100:103]
    v_cvt_pk_bf16_f32 v119, v126, v127
    v_cmp_eq_u32 vcc, -3, v252
    v_mfma_f32_16x16x32_bf16 v[100:103], a[108:111], v[120:123], v[100:103]
    buffer_store_dwordx4 v[116:119], v222, s[52:55], s4 offen sc1
    v_mfma_f32_16x16x32_bf16 v[100:103], a[112:115], a[48:51], v[100:103]
    s_add_u32 s4, s4, 2048
    ds_read_b64_tr_b16 a[130:131], v232 offset:2048
    v_cndmask_b32 v189, 0, v253, vcc
    v_mfma_f32_16x16x32_bf16 v[100:103], a[116:119], a[52:55], v[100:103]
    ds_read_b64_tr_b16 a[132:133], v232 offset:4096
    v_mul_f32 v148, v148, v198
    v_mfma_f32_16x16x32_bf16 v[100:103], a[120:123], a[56:59], v[100:103]
    v_mul_f32 v149, v149, v198
    v_mul_f32 v150, v150, v198
    v_mfma_f32_16x16x32_bf16 v[100:103], a[124:127], a[60:63], v[100:103]
    s_add_u32 m0, s92, 16384
    ds_read_b64_tr_b16 a[134:135], v232 offset:6144
    v_mul_f32 v151, v151, v198
    v_mfma_f32_16x16x32_bf16 v[132:135], a[96:99], v[128:131], 0
    s_mov_b32 s97, 115456
    v_cmp_eq_u32 vcc, -2, v252
    v_cvt_pk_bf16_f32 v148, v148, v149
    v_mfma_f32_16x16x32_bf16 v[132:135], a[100:103], v[136:139], v[132:135]
    ds_read_b64_tr_b16 a[136:137], v232 offset:8192
    ds_read_b64_tr_b16 a[138:139], v232 offset:10240
    v_mfma_f32_16x16x32_bf16 v[132:135], a[104:107], v[144:147], v[132:135]
    ds_read_b64_tr_b16 a[140:141], v232 offset:12288
    v_cvt_pk_bf16_f32 v149, v150, v151
    v_mfma_f32_16x16x32_bf16 v[132:135], a[108:111], v[152:155], v[132:135]
    ds_read_b64_tr_b16 a[142:143], v232 offset:14336
    v_cndmask_b32 v190, 0, v253, vcc
    v_mfma_f32_16x16x32_bf16 v[132:135], a[112:115], a[64:67], v[132:135]
    buffer_load_dwordx4 v223, s[48:51], s97 offen offset:0 lds
    v_mfma_f32_16x16x32_bf16 v[132:135], a[116:119], a[68:71], v[132:135]
    ds_read_b64_tr_b16 a[144:145], v233 offset:0
    ds_read_b64_tr_b16 a[146:147], v233 offset:2048
    v_mfma_f32_16x16x32_bf16 v[132:135], a[120:123], a[72:75], v[132:135]
    ds_read_b64_tr_b16 a[148:149], v233 offset:4096
    ds_read_b64_tr_b16 a[150:151], v233 offset:6144
    v_mfma_f32_16x16x32_bf16 v[132:135], a[124:127], a[76:79], v[132:135]
    s_waitcnt lgkmcnt(8)
    ds_read_b64_tr_b16 a[152:153], v233 offset:8192
    ds_read_b64_tr_b16 a[154:155], v233 offset:10240
    v_mfma_f32_16x16x32_bf16 v[12:15], a[128:131], v[0:3], 0
    ds_read_b64_tr_b16 a[156:157], v233 offset:12288
    ds_read_b64_tr_b16 a[158:159], v233 offset:14336
    v_mfma_f32_16x16x32_bf16 v[12:15], a[132:135], v[8:11], v[12:15]
    s_waitcnt lgkmcnt(10)
    v_mul_f32 v156, v156, v198
    v_mul_f32 v157, v157, v198
    v_mfma_f32_16x16x32_bf16 v[12:15], a[136:139], v[16:19], v[12:15]
    s_waitcnt lgkmcnt(8)
    v_mul_f32 v158, v158, v198
    v_cmp_eq_u32 vcc, -1, v252
    v_mfma_f32_16x16x32_bf16 v[12:15], a[140:143], v[24:27], v[12:15]
    s_waitcnt lgkmcnt(6)
    v_mul_f32 v159, v159, v198
    v_cvt_pk_bf16_f32 v150, v156, v157
    v_mfma_f32_16x16x32_bf16 v[12:15], a[144:147], a[0:3], v[12:15]
    s_waitcnt lgkmcnt(4)
    v_cvt_pk_bf16_f32 v151, v158, v159
    v_cndmask_b32 v191, 0, v253, vcc
    v_mfma_f32_16x16x32_bf16 v[12:15], a[148:151], a[4:7], v[12:15]
    s_waitcnt lgkmcnt(2)
    buffer_store_dwordx4 v[148:151], v222, s[52:55], s4 offen sc1
    v_mfma_f32_16x16x32_bf16 v[12:15], a[152:155], a[8:11], v[12:15]
    s_waitcnt lgkmcnt(0)
    s_add_u32 s4, s4, 12288
    s_mov_b32 s97, 121600
    v_mfma_f32_16x16x32_bf16 v[12:15], a[156:159], a[12:15], v[12:15]
    s_mov_b32 s12, 49152
    buffer_load_dwordx4 v223, s[48:51], s97 offen offset:1024 lds
    v_mfma_f32_16x16x32_bf16 v[44:47], a[128:131], v[32:35], 0
    s_cmp_eq_u32 s10, 0
    s_cselect_b32 s5, s12, 147456
    s_cselect_b32 s6, 147456, s12
    v_add_u32 v234, s5, v238
    v_add_u32 v235, s6, v238
    v_mfma_f32_16x16x32_bf16 v[44:47], a[132:135], v[40:43], v[44:47]
    v_mfma_f32_16x16x32_bf16 v[44:47], a[136:139], v[48:51], v[44:47]
    v_mfma_f32_16x16x32_bf16 v[44:47], a[140:143], v[56:59], v[44:47]
    s_mov_b32 s97, 127744
    v_add_u32 v236, s5, v239
    v_mul_f32 v4, v4, v194
    v_mfma_f32_16x16x32_bf16 v[44:47], a[144:147], a[16:19], v[44:47]
    buffer_load_dwordx4 v223, s[48:51], s97 offen offset:2048 lds
    v_mfma_f32_16x16x32_bf16 v[44:47], a[148:151], a[20:23], v[44:47]
    v_mul_f32 v5, v5, v194
    v_mul_f32 v6, v6, v194
    v_mfma_f32_16x16x32_bf16 v[44:47], a[152:155], a[24:27], v[44:47]
    v_mul_f32 v7, v7, v194
    v_add_u32 v237, s6, v239
    v_mfma_f32_16x16x32_bf16 v[44:47], a[156:159], a[28:31], v[44:47]
    v_cvt_pk_bf16_f32 v4, v4, v5
    v_cvt_pk_bf16_f32 v5, v6, v7
    v_mfma_f32_16x16x32_bf16 v[76:79], a[128:131], v[64:67], 0
    v_mul_f32 v12, v12, v194
    v_mfma_f32_16x16x32_bf16 v[76:79], a[132:135], v[72:75], v[76:79]
    v_mul_f32 v13, v13, v194
    v_mfma_f32_16x16x32_bf16 v[76:79], a[136:139], v[80:83], v[76:79]
    v_mul_f32 v14, v14, v194
    v_mfma_f32_16x16x32_bf16 v[76:79], a[140:143], v[88:91], v[76:79]
    v_mul_f32 v15, v15, v194
    v_mfma_f32_16x16x32_bf16 v[76:79], a[144:147], a[32:35], v[76:79]
    s_mov_b32 s97, 133888
    v_cvt_pk_bf16_f32 v6, v12, v13
    v_mfma_f32_16x16x32_bf16 v[76:79], a[148:151], a[36:39], v[76:79]
    buffer_load_dwordx4 v223, s[48:51], s97 offen offset:3072 lds
    v_mfma_f32_16x16x32_bf16 v[76:79], a[152:155], a[40:43], v[76:79]
    v_cvt_pk_bf16_f32 v7, v14, v15
    v_mfma_f32_16x16x32_bf16 v[76:79], a[156:159], a[44:47], v[76:79]
    buffer_store_dwordx4 v[4:7], v222, s[52:55], s4 offen sc1
    v_mfma_f32_16x16x32_bf16 v[108:111], a[128:131], v[96:99], 0
    s_add_u32 s4, s4, 2048
    v_mfma_f32_16x16x32_bf16 v[108:111], a[132:135], v[104:107], v[108:111]
    v_mul_f32 v36, v36, v195
    v_mul_f32 v37, v37, v195
    v_mfma_f32_16x16x32_bf16 v[108:111], a[136:139], v[112:115], v[108:111]
    v_mul_f32 v38, v38, v195
    v_mfma_f32_16x16x32_bf16 v[108:111], a[140:143], v[120:123], v[108:111]
    v_mul_f32 v39, v39, v195
    v_mfma_f32_16x16x32_bf16 v[108:111], a[144:147], a[48:51], v[108:111]
    v_cvt_pk_bf16_f32 v36, v36, v37
    v_mfma_f32_16x16x32_bf16 v[108:111], a[148:151], a[52:55], v[108:111]
    v_cvt_pk_bf16_f32 v37, v38, v39
    v_mfma_f32_16x16x32_bf16 v[108:111], a[152:155], a[56:59], v[108:111]
    v_mul_f32 v44, v44, v195
    v_mfma_f32_16x16x32_bf16 v[108:111], a[156:159], a[60:63], v[108:111]
    s_waitcnt vmcnt(14)
    s_barrier
    ds_read_b64_tr_b16 a[80:81], v234 offset:0
    v_mfma_f32_16x16x32_bf16 v[140:143], a[128:131], v[128:131], 0
    ds_read_b64_tr_b16 a[82:83], v234 offset:2048
    ds_read_b64_tr_b16 a[84:85], v234 offset:4096
    v_mfma_f32_16x16x32_bf16 v[140:143], a[132:135], v[136:139], v[140:143]
    ds_read_b64_tr_b16 a[86:87], v234 offset:6144
    ds_read_b64_tr_b16 a[88:89], v234 offset:8192
    v_mfma_f32_16x16x32_bf16 v[140:143], a[136:139], v[144:147], v[140:143]
    ds_read_b64_tr_b16 a[90:91], v234 offset:10240
    v_mul_f32 v45, v45, v195
    v_mfma_f32_16x16x32_bf16 v[140:143], a[140:143], v[152:155], v[140:143]
    ds_read_b64_tr_b16 a[92:93], v234 offset:12288
    v_mul_f32 v46, v46, v195
    v_mfma_f32_16x16x32_bf16 v[140:143], a[144:147], a[64:67], v[140:143]
    ds_read_b64_tr_b16 a[94:95], v234 offset:14336
    v_mul_f32 v47, v47, v195
    v_mfma_f32_16x16x32_bf16 v[140:143], a[148:151], a[68:71], v[140:143]
    ds_read_b64_tr_b16 a[96:97], v235 offset:0
    ds_read_b64_tr_b16 a[98:99], v235 offset:2048
    v_mfma_f32_16x16x32_bf16 v[140:143], a[152:155], a[72:75], v[140:143]
    ds_read_b64_tr_b16 a[100:101], v235 offset:4096
    ds_read_b64_tr_b16 a[102:103], v235 offset:6144
    v_mfma_f32_16x16x32_bf16 v[140:143], a[156:159], a[76:79], v[140:143]
    s_waitcnt lgkmcnt(10)
    ds_read_b64_tr_b16 a[104:105], v235 offset:8192
    ds_read_b64_tr_b16 a[106:107], v235 offset:10240
    v_mfma_f32_16x16x32_bf16 v[20:23], a[80:83], v[0:3], 0
    s_waitcnt lgkmcnt(10)
    ds_read_b64_tr_b16 a[108:109], v235 offset:12288
    ds_read_b64_tr_b16 a[110:111], v235 offset:14336
    v_mfma_f32_16x16x32_bf16 v[20:23], a[84:87], v[8:11], v[20:23]
    s_waitcnt lgkmcnt(10)
    v_cvt_pk_bf16_f32 v38, v44, v45
    v_cvt_pk_bf16_f32 v39, v46, v47
    v_mfma_f32_16x16x32_bf16 v[20:23], a[88:91], v[16:19], v[20:23]
    s_waitcnt lgkmcnt(8)
    buffer_store_dwordx4 v[36:39], v222, s[52:55], s4 offen sc1
    v_mfma_f32_16x16x32_bf16 v[20:23], a[92:95], v[24:27], v[20:23]
    s_waitcnt lgkmcnt(6)
    s_add_u32 s4, s4, 2048
    v_mul_f32 v68, v68, v196
    v_mfma_f32_16x16x32_bf16 v[20:23], a[96:99], a[0:3], v[20:23]
    s_waitcnt lgkmcnt(4)
    v_mul_f32 v69, v69, v196
    v_mul_f32 v70, v70, v196
    v_mfma_f32_16x16x32_bf16 v[20:23], a[100:103], a[4:7], v[20:23]
    s_waitcnt lgkmcnt(2)
    v_mul_f32 v71, v71, v196
    v_cvt_pk_bf16_f32 v68, v68, v69
    v_mfma_f32_16x16x32_bf16 v[20:23], a[104:107], a[8:11], v[20:23]
L_pg8:
    s_cbranch_execz L_pgret
    s_waitcnt lgkmcnt(0)
    v_cvt_pk_bf16_f32 v69, v70, v71
    v_mul_f32 v76, v76, v196
    v_mfma_f32_16x16x32_bf16 v[20:23], a[108:111], a[12:15], v[20:23]
    ds_read_b64_tr_b16 a[112:113], v236 offset:0
    v_mul_f32 v77, v77, v196
    v_mfma_f32_16x16x32_bf16 v[52:55], a[80:83], v[32:35], 0
    ds_read_b64_tr_b16 a[114:115], v236 offset:2048
    v_mul_f32 v78, v78, v196
    v_mfma_f32_16x16x32_bf16 v[52:55], a[84:87], v[40:43], v[52:55]
    ds_read_b64_tr_b16 a[116:117], v236 offset:4096
    v_mul_f32 v79, v79, v196
    v_mfma_f32_16x16x32_bf16 v[52:55], a[88:91], v[48:51], v[52:55]
    ds_read_b64_tr_b16 a[118:119], v236 offset:6144
    v_cvt_pk_bf16_f32 v70, v76, v77
    v_mfma_f32_16x16x32_bf16 v[52:55], a[92:95], v[56:59], v[52:55]
    ds_read_b64_tr_b16 a[120:121], v236 offset:8192
    v_cvt_pk_bf16_f32 v71, v78, v79
    v_mfma_f32_16x16x32_bf16 v[52:55], a[96:99], a[16:19], v[52:55]
    buffer_store_dwordx4 v[68:71], v222, s[52:55], s4 offen sc1
    v_mfma_f32_16x16x32_bf16 v[52:55], a[100:103], a[20:23], v[52:55]
    s_add_u32 s4, s4, 2048
    ds_read_b64_tr_b16 a[122:123], v236 offset:10240
    v_mul_f32 v100, v100, v197
    v_mfma_f32_16x16x32_bf16 v[52:55], a[104:107], a[24:27], v[52:55]
    ds_read_b64_tr_b16 a[124:125], v236 offset:12288
    v_mul_f32 v101, v101, v197
    v_mfma_f32_16x16x32_bf16 v[52:55], a[108:111], a[28:31], v[52:55]
    ds_read_b64_tr_b16 a[126:127], v236 offset:14336
    v_mul_f32 v102, v102, v197
    v_mfma_f32_16x16x32_bf16 v[84:87], a[80:83], v[64:67], 0
    ds_read_b64_tr_b16 a[128:129], v237 offset:0
    v_mul_f32 v103, v103, v197
    v_mfma_f32_16x16x32_bf16 v[84:87], a[84:87], v[72:75], v[84:87]
    ds_read_b64_tr_b16 a[130:131], v237 offset:2048
    v_cvt_pk_bf16_f32 v100, v100, v101
    v_mfma_f32_16x16x32_bf16 v[84:87], a[88:91], v[80:83], v[84:87]
    ds_read_b64_tr_b16 a[132:133], v237 offset:4096
    v_cvt_pk_bf16_f32 v101, v102, v103
    v_mfma_f32_16x16x32_bf16 v[84:87], a[92:95], v[88:91], v[84:87]
    ds_read_b64_tr_b16 a[134:135], v237 offset:6144
    v_mul_f32 v108, v108, v197
    v_mfma_f32_16x16x32_bf16 v[84:87], a[96:99], a[32:35], v[84:87]
    ds_read_b64_tr_b16 a[136:137], v237 offset:8192
    v_mul_f32 v109, v109, v197
    v_mfma_f32_16x16x32_bf16 v[84:87], a[100:103], a[36:39], v[84:87]
    s_waitcnt lgkmcnt(7)
    ds_read_b64_tr_b16 a[138:139], v237 offset:10240
    v_mul_f32 v110, v110, v197
    v_mfma_f32_16x16x32_bf16 v[84:87], a[104:107], a[40:43], v[84:87]
    ds_read_b64_tr_b16 a[140:141], v237 offset:12288
    v_mul_f32 v111, v111, v197
    v_mfma_f32_16x16x32_bf16 v[84:87], a[108:111], a[44:47], v[84:87]
    ds_read_b64_tr_b16 a[142:143], v237 offset:14336
    v_cvt_pk_bf16_f32 v102, v108, v109
    v_mfma_f32_16x16x32_bf16 v[116:119], a[80:83], v[96:99], 0
    v_cvt_pk_bf16_f32 v103, v110, v111
    v_mfma_f32_16x16x32_bf16 v[116:119], a[84:87], v[104:107], v[116:119]
    buffer_store_dwordx4 v[100:103], v222, s[52:55], s4 offen sc1
    v_mfma_f32_16x16x32_bf16 v[116:119], a[88:91], v[112:115], v[116:119]
    s_add_u32 s4, s4, 2048
    v_mfma_f32_16x16x32_bf16 v[116:119], a[92:95], v[120:123], v[116:119]
    v_mul_f32 v132, v132, v198
    v_mul_f32 v133, v133, v198
    v_mfma_f32_16x16x32_bf16 v[116:119], a[96:99], a[48:51], v[116:119]
    v_mul_f32 v134, v134, v198
    v_mfma_f32_16x16x32_bf16 v[116:119], a[100:103], a[52:55], v[116:119]
    v_mul_f32 v135, v135, v198
    v_mfma_f32_16x16x32_bf16 v[116:119], a[104:107], a[56:59], v[116:119]
    v_cvt_pk_bf16_f32 v132, v132, v133
    v_mfma_f32_16x16x32_bf16 v[116:119], a[108:111], a[60:63], v[116:119]
    v_cvt_pk_bf16_f32 v133, v134, v135
    v_mfma_f32_16x16x32_bf16 v[148:151], a[80:83], v[128:131], 0
    v_mul_f32 v140, v140, v198
    v_mfma_f32_16x16x32_bf16 v[148:151], a[84:87], v[136:139], v[148:151]
    v_mul_f32 v141, v141, v198
    v_mfma_f32_16x16x32_bf16 v[148:151], a[88:91], v[144:147], v[148:151]
    v_mul_f32 v142, v142, v198
    v_mfma_f32_16x16x32_bf16 v[148:151], a[92:95], v[152:155], v[148:151]
    v_mul_f32 v143, v143, v198
    v_mfma_f32_16x16x32_bf16 v[148:151], a[96:99], a[64:67], v[148:151]
    v_cvt_pk_bf16_f32 v134, v140, v141
    v_mfma_f32_16x16x32_bf16 v[148:151], a[100:103], a[68:71], v[148:151]
    v_cvt_pk_bf16_f32 v135, v142, v143
    v_mfma_f32_16x16x32_bf16 v[148:151], a[104:107], a[72:75], v[148:151]
    buffer_store_dwordx4 v[132:135], v222, s[52:55], s4 offen sc1
    v_mfma_f32_16x16x32_bf16 v[148:151], a[108:111], a[76:79], v[148:151]
    v_mfma_f32_16x16x32_bf16 v[28:31], a[112:115], v[0:3], 0
    s_add_u32 s4, s4, 12288
    v_mfma_f32_16x16x32_bf16 v[28:31], a[116:119], v[8:11], v[28:31]
    v_mfma_f32_16x16x32_bf16 v[28:31], a[120:123], v[16:19], v[28:31]
    s_waitcnt lgkmcnt(0)
    v_mfma_f32_16x16x32_bf16 v[28:31], a[124:127], v[24:27], v[28:31]
    v_mfma_f32_16x16x32_bf16 v[28:31], a[128:131], a[0:3], v[28:31]
    s_mov_b32 s12, 0
    v_mfma_f32_16x16x32_bf16 v[28:31], a[132:135], a[4:7], v[28:31]
    s_cmp_eq_u32 s10, 0
    s_cselect_b32 s5, s12, 16384
    s_cselect_b32 s6, 16384, s12
    v_add_u32 v230, s5, v238
    v_mfma_f32_16x16x32_bf16 v[28:31], a[136:139], a[8:11], v[28:31]
    v_mfma_f32_16x16x32_bf16 v[28:31], a[140:143], a[12:15], v[28:31]
    v_mfma_f32_16x16x32_bf16 v[60:63], a[112:115], v[32:35], 0
    v_add_u32 v231, s6, v238
    v_mfma_f32_16x16x32_bf16 v[60:63], a[116:119], v[40:43], v[60:63]
    v_mfma_f32_16x16x32_bf16 v[60:63], a[120:123], v[48:51], v[60:63]
    v_mfma_f32_16x16x32_bf16 v[60:63], a[124:127], v[56:59], v[60:63]
    v_add_u32 v232, s5, v239
    v_mul_f32 v20, v20, v194
    v_mfma_f32_16x16x32_bf16 v[60:63], a[128:131], a[16:19], v[60:63]
    v_mul_f32 v21, v21, v194
    v_mul_f32 v22, v22, v194
    v_mfma_f32_16x16x32_bf16 v[60:63], a[132:135], a[20:23], v[60:63]
    v_mul_f32 v23, v23, v194
    v_mfma_f32_16x16x32_bf16 v[60:63], a[136:139], a[24:27], v[60:63]
    v_add_u32 v233, s6, v239
    v_cvt_pk_bf16_f32 v20, v20, v21
    v_mfma_f32_16x16x32_bf16 v[60:63], a[140:143], a[28:31], v[60:63]
    v_cvt_pk_bf16_f32 v21, v22, v23
    v_mfma_f32_16x16x32_bf16 v[92:95], a[112:115], v[64:67], 0
    v_mul_f32 v28, v28, v194
    v_mfma_f32_16x16x32_bf16 v[92:95], a[116:119], v[72:75], v[92:95]
    v_mul_f32 v29, v29, v194
    v_mfma_f32_16x16x32_bf16 v[92:95], a[120:123], v[80:83], v[92:95]
    v_mul_f32 v30, v30, v194
    v_mfma_f32_16x16x32_bf16 v[92:95], a[124:127], v[88:91], v[92:95]
    v_mul_f32 v31, v31, v194
    v_mfma_f32_16x16x32_bf16 v[92:95], a[128:131], a[32:35], v[92:95]
    v_cvt_pk_bf16_f32 v22, v28, v29
    v_mfma_f32_16x16x32_bf16 v[92:95], a[132:135], a[36:39], v[92:95]
    v_cvt_pk_bf16_f32 v23, v30, v31
    v_mfma_f32_16x16x32_bf16 v[92:95], a[136:139], a[40:43], v[92:95]
    buffer_store_dwordx4 v[20:23], v222, s[52:55], s4 offen sc1
    v_mfma_f32_16x16x32_bf16 v[92:95], a[140:143], a[44:47], v[92:95]
    v_mfma_f32_16x16x32_bf16 v[124:127], a[112:115], v[96:99], 0
    s_add_u32 s4, s4, 2048
    v_mfma_f32_16x16x32_bf16 v[124:127], a[116:119], v[104:107], v[124:127]
    v_mul_f32 v52, v52, v195
    v_mul_f32 v53, v53, v195
    v_mfma_f32_16x16x32_bf16 v[124:127], a[120:123], v[112:115], v[124:127]
    v_mul_f32 v54, v54, v195
    v_mfma_f32_16x16x32_bf16 v[124:127], a[124:127], v[120:123], v[124:127]
    v_mul_f32 v55, v55, v195
    v_mfma_f32_16x16x32_bf16 v[124:127], a[128:131], a[48:51], v[124:127]
    v_cvt_pk_bf16_f32 v52, v52, v53
    v_mfma_f32_16x16x32_bf16 v[124:127], a[132:135], a[52:55], v[124:127]
    v_cvt_pk_bf16_f32 v53, v54, v55
    v_mfma_f32_16x16x32_bf16 v[124:127], a[136:139], a[56:59], v[124:127]
    v_mul_f32 v60, v60, v195
    v_mfma_f32_16x16x32_bf16 v[124:127], a[140:143], a[60:63], v[124:127]
    s_waitcnt vmcnt(6)
    s_barrier
    ds_read_b64_tr_b16 a[144:145], v230 offset:0
    v_mfma_f32_16x16x32_bf16 v[156:159], a[112:115], v[128:131], 0
    ds_read_b64_tr_b16 a[146:147], v230 offset:2048
    ds_read_b64_tr_b16 a[148:149], v230 offset:4096
    v_mfma_f32_16x16x32_bf16 v[156:159], a[116:119], v[136:139], v[156:159]
    ds_read_b64_tr_b16 a[150:151], v230 offset:6144
    ds_read_b64_tr_b16 a[152:153], v230 offset:8192
    v_mfma_f32_16x16x32_bf16 v[156:159], a[120:123], v[144:147], v[156:159]
    ds_read_b64_tr_b16 a[154:155], v230 offset:10240
    v_mul_f32 v61, v61, v195
    v_mfma_f32_16x16x32_bf16 v[156:159], a[124:127], v[152:155], v[156:159]
    buffer_store_dword v216, v214, s[16:19], s89 offen sc1
    v_mfma_f32_16x16x32_bf16 v[156:159], a[128:131], a[64:67], v[156:159]
    ds_read_b64_tr_b16 a[156:157], v230 offset:12288
    ds_read_b64_tr_b16 a[158:159], v230 offset:14336
    v_mfma_f32_16x16x32_bf16 v[156:159], a[132:135], a[68:71], v[156:159]
    ds_read_b64_tr_b16 a[80:81], v231 offset:0
    ds_read_b64_tr_b16 a[82:83], v231 offset:2048
    v_mfma_f32_16x16x32_bf16 v[156:159], a[136:139], a[72:75], v[156:159]
    ds_read_b64_tr_b16 a[84:85], v231 offset:4096
    ds_read_b64_tr_b16 a[86:87], v231 offset:6144
    v_mfma_f32_16x16x32_bf16 v[156:159], a[140:143], a[76:79], v[156:159]
    s_waitcnt lgkmcnt(10)
    ds_read_b64_tr_b16 a[88:89], v231 offset:8192
    ds_read_b64_tr_b16 a[90:91], v231 offset:10240
    v_mfma_f32_16x16x32_bf16 v[4:7], a[144:147], v[0:3], 0
    s_waitcnt lgkmcnt(10)
    ds_read_b64_tr_b16 a[92:93], v231 offset:12288
    ds_read_b64_tr_b16 a[94:95], v231 offset:14336
    v_mfma_f32_16x16x32_bf16 v[4:7], a[148:151], v[8:11], v[4:7]
    s_waitcnt lgkmcnt(10)
    v_mul_f32 v62, v62, v195
    v_mul_f32 v63, v63, v195
    v_mfma_f32_16x16x32_bf16 v[4:7], a[152:155], v[16:19], v[4:7]
    s_waitcnt lgkmcnt(8)
    v_cvt_pk_bf16_f32 v54, v60, v61
    v_cvt_pk_bf16_f32 v55, v62, v63
    v_mfma_f32_16x16x32_bf16 v[4:7], a[156:159], v[24:27], v[4:7]
    s_waitcnt lgkmcnt(6)
    buffer_store_dwordx4 v[52:55], v222, s[52:55], s4 offen sc1
    v_mfma_f32_16x16x32_bf16 v[4:7], a[80:83], a[0:3], v[4:7]
    s_waitcnt lgkmcnt(4)
    ds_read_b64_tr_b16 a[96:97], v232 offset:0
    ds_read_b64_tr_b16 a[98:99], v232 offset:2048
    v_mfma_f32_16x16x32_bf16 v[4:7], a[84:87], a[4:7], v[4:7]
    s_waitcnt lgkmcnt(4)
    ds_read_b64_tr_b16 a[100:101], v232 offset:4096
    ds_read_b64_tr_b16 a[102:103], v232 offset:6144
    v_mfma_f32_16x16x32_bf16 v[4:7], a[88:91], a[8:11], v[4:7]
    s_waitcnt lgkmcnt(4)
    ds_read_b64_tr_b16 a[104:105], v232 offset:8192
    ds_read_b64_tr_b16 a[106:107], v232 offset:10240
    v_mfma_f32_16x16x32_bf16 v[4:7], a[92:95], a[12:15], v[4:7]
    s_add_u32 s4, s4, 2048
    v_mul_f32 v84, v84, v196
    v_mul_f32 v85, v85, v196
    v_mfma_f32_16x16x32_bf16 v[36:39], a[144:147], v[32:35], 0
    v_mul_f32 v86, v86, v196
    v_mul_f32 v87, v87, v196
    v_mfma_f32_16x16x32_bf16 v[36:39], a[148:151], v[40:43], v[36:39]
    v_cvt_pk_bf16_f32 v84, v84, v85
    v_cvt_pk_bf16_f32 v85, v86, v87
    v_mfma_f32_16x16x32_bf16 v[36:39], a[152:155], v[48:51], v[36:39]
    v_mul_f32 v92, v92, v196
    v_mul_f32 v93, v93, v196
    v_mfma_f32_16x16x32_bf16 v[36:39], a[156:159], v[56:59], v[36:39]
    v_mul_f32 v94, v94, v196
    v_mul_f32 v95, v95, v196
    v_mfma_f32_16x16x32_bf16 v[36:39], a[80:83], a[16:19], v[36:39]
    v_cvt_pk_bf16_f32 v86, v92, v93
    v_cvt_pk_bf16_f32 v87, v94, v95
    v_mfma_f32_16x16x32_bf16 v[36:39], a[84:87], a[20:23], v[36:39]
    buffer_store_dwordx4 v[84:87], v222, s[52:55], s4 offen sc1
    v_mfma_f32_16x16x32_bf16 v[36:39], a[88:91], a[24:27], v[36:39]
    s_add_u32 s4, s4, 2048
    ds_read_b64_tr_b16 a[108:109], v232 offset:12288
    v_mul_f32 v116, v116, v197
    v_mfma_f32_16x16x32_bf16 v[36:39], a[92:95], a[28:31], v[36:39]
    ds_read_b64_tr_b16 a[110:111], v232 offset:14336
    v_mul_f32 v117, v117, v197
    v_mfma_f32_16x16x32_bf16 v[68:71], a[144:147], v[64:67], 0
    ds_read_b64_tr_b16 a[112:113], v233 offset:0
    v_mul_f32 v118, v118, v197
    v_mfma_f32_16x16x32_bf16 v[68:71], a[148:151], v[72:75], v[68:71]
    ds_read_b64_tr_b16 a[114:115], v233 offset:2048
    v_mul_f32 v119, v119, v197
    v_mfma_f32_16x16x32_bf16 v[68:71], a[152:155], v[80:83], v[68:71]
    ds_read_b64_tr_b16 a[116:117], v233 offset:4096
    v_cvt_pk_bf16_f32 v116, v116, v117
    v_mfma_f32_16x16x32_bf16 v[68:71], a[156:159], v[88:91], v[68:71]
    ds_read_b64_tr_b16 a[118:119], v233 offset:6144
    v_cvt_pk_bf16_f32 v117, v118, v119
    v_mfma_f32_16x16x32_bf16 v[68:71], a[80:83], a[32:35], v[68:71]
    ds_read_b64_tr_b16 a[120:121], v233 offset:8192
    v_mul_f32 v124, v124, v197
    v_mfma_f32_16x16x32_bf16 v[68:71], a[84:87], a[36:39], v[68:71]
    s_waitcnt lgkmcnt(7)
    ds_read_b64_tr_b16 a[122:123], v233 offset:10240
    v_mul_f32 v125, v125, v197
    v_mfma_f32_16x16x32_bf16 v[68:71], a[88:91], a[40:43], v[68:71]
    ds_read_b64_tr_b16 a[124:125], v233 offset:12288
    v_mul_f32 v126, v126, v197
    v_mfma_f32_16x16x32_bf16 v[68:71], a[92:95], a[44:47], v[68:71]
    ds_read_b64_tr_b16 a[126:127], v233 offset:14336
    v_mul_f32 v127, v127, v197
    v_mfma_f32_16x16x32_bf16 v[100:103], a[144:147], v[96:99], 0
    v_cvt_pk_bf16_f32 v118, v124, v125
    v_cvt_pk_bf16_f32 v119, v126, v127
    v_mfma_f32_16x16x32_bf16 v[100:103], a[148:151], v[104:107], v[100:103]
    buffer_store_dwordx4 v[116:119], v222, s[52:55], s4 offen sc1
    v_mfma_f32_16x16x32_bf16 v[100:103], a[152:155], v[112:115], v[100:103]
    s_add_u32 s4, s4, 2048
    v_mfma_f32_16x16x32_bf16 v[100:103], a[156:159], v[120:123], v[100:103]
    v_mul_f32 v148, v148, v198
    v_mul_f32 v149, v149, v198
    v_mfma_f32_16x16x32_bf16 v[100:103], a[80:83], a[48:51], v[100:103]
    v_mul_f32 v150, v150, v198
    v_mfma_f32_16x16x32_bf16 v[100:103], a[84:87], a[52:55], v[100:103]
    v_mul_f32 v151, v151, v198
    v_mfma_f32_16x16x32_bf16 v[100:103], a[88:91], a[56:59], v[100:103]
    v_cvt_pk_bf16_f32 v148, v148, v149
    v_mfma_f32_16x16x32_bf16 v[100:103], a[92:95], a[60:63], v[100:103]
    v_cvt_pk_bf16_f32 v149, v150, v151
    v_mfma_f32_16x16x32_bf16 v[132:135], a[144:147], v[128:131], 0
    v_mul_f32 v156, v156, v198
    v_mfma_f32_16x16x32_bf16 v[132:135], a[148:151], v[136:139], v[132:135]
    v_mul_f32 v157, v157, v198
    v_mfma_f32_16x16x32_bf16 v[132:135], a[152:155], v[144:147], v[132:135]
    v_mul_f32 v158, v158, v198
    v_mfma_f32_16x16x32_bf16 v[132:135], a[156:159], v[152:155], v[132:135]
    v_mul_f32 v159, v159, v198
    v_mfma_f32_16x16x32_bf16 v[132:135], a[80:83], a[64:67], v[132:135]
    v_cvt_pk_bf16_f32 v150, v156, v157
    v_mfma_f32_16x16x32_bf16 v[132:135], a[84:87], a[68:71], v[132:135]
    v_cvt_pk_bf16_f32 v151, v158, v159
    v_mfma_f32_16x16x32_bf16 v[132:135], a[88:91], a[72:75], v[132:135]
    buffer_store_dwordx4 v[148:151], v222, s[52:55], s4 offen sc1
    v_mfma_f32_16x16x32_bf16 v[132:135], a[92:95], a[76:79], v[132:135]
    v_mfma_f32_16x16x32_bf16 v[12:15], a[96:99], v[0:3], 0
    s_add_u32 s4, s4, 12288
    v_mfma_f32_16x16x32_bf16 v[12:15], a[100:103], v[8:11], v[12:15]
    v_mfma_f32_16x16x32_bf16 v[12:15], a[104:107], v[16:19], v[12:15]
    s_waitcnt lgkmcnt(0)
    v_mfma_f32_16x16x32_bf16 v[12:15], a[108:111], v[24:27], v[12:15]
    v_mfma_f32_16x16x32_bf16 v[12:15], a[112:115], a[0:3], v[12:15]
    v_mfma_f32_16x16x32_bf16 v[12:15], a[116:119], a[4:7], v[12:15]
    v_mfma_f32_16x16x32_bf16 v[12:15], a[120:123], a[8:11], v[12:15]
    v_mfma_f32_16x16x32_bf16 v[12:15], a[124:127], a[12:15], v[12:15]
    v_mfma_f32_16x16x32_bf16 v[44:47], a[96:99], v[32:35], 0
    v_mfma_f32_16x16x32_bf16 v[44:47], a[100:103], v[40:43], v[44:47]
    v_mfma_f32_16x16x32_bf16 v[44:47], a[104:107], v[48:51], v[44:47]
    v_mfma_f32_16x16x32_bf16 v[44:47], a[108:111], v[56:59], v[44:47]
    v_mul_f32 v4, v4, v194
    v_mul_f32 v5, v5, v194
    v_mfma_f32_16x16x32_bf16 v[44:47], a[112:115], a[16:19], v[44:47]
    v_mul_f32 v6, v6, v194
    v_mul_f32 v7, v7, v194
    v_mfma_f32_16x16x32_bf16 v[44:47], a[116:119], a[20:23], v[44:47]
    v_cvt_pk_bf16_f32 v4, v4, v5
    v_cvt_pk_bf16_f32 v5, v6, v7
    v_mfma_f32_16x16x32_bf16 v[44:47], a[120:123], a[24:27], v[44:47]
    v_mul_f32 v12, v12, v194
    v_mul_f32 v13, v13, v194
    v_mfma_f32_16x16x32_bf16 v[44:47], a[124:127], a[28:31], v[44:47]
    v_mul_f32 v14, v14, v194
    v_mfma_f32_16x16x32_bf16 v[76:79], a[96:99], v[64:67], 0
    v_mul_f32 v15, v15, v194
    v_cvt_pk_bf16_f32 v6, v12, v13
    v_mfma_f32_16x16x32_bf16 v[76:79], a[100:103], v[72:75], v[76:79]
    v_cvt_pk_bf16_f32 v7, v14, v15
    v_mfma_f32_16x16x32_bf16 v[76:79], a[104:107], v[80:83], v[76:79]
    buffer_store_dwordx4 v[4:7], v222, s[52:55], s4 offen sc1
    v_mfma_f32_16x16x32_bf16 v[76:79], a[108:111], v[88:91], v[76:79]
    s_add_u32 s4, s4, 2048
    v_mul_f32 v36, v36, v195
    v_mul_f32 v37, v37, v195
    v_mfma_f32_16x16x32_bf16 v[76:79], a[112:115], a[32:35], v[76:79]
    v_mul_f32 v38, v38, v195
    v_mul_f32 v39, v39, v195
    v_mfma_f32_16x16x32_bf16 v[76:79], a[116:119], a[36:39], v[76:79]
    v_cvt_pk_bf16_f32 v36, v36, v37
    v_cvt_pk_bf16_f32 v37, v38, v39
    v_mfma_f32_16x16x32_bf16 v[76:79], a[120:123], a[40:43], v[76:79]
    v_mul_f32 v44, v44, v195
    v_mul_f32 v45, v45, v195
    v_mfma_f32_16x16x32_bf16 v[76:79], a[124:127], a[44:47], v[76:79]
    v_mul_f32 v46, v46, v195
    v_mfma_f32_16x16x32_bf16 v[108:111], a[96:99], v[96:99], 0
    v_mul_f32 v47, v47, v195
    v_cvt_pk_bf16_f32 v38, v44, v45
    v_mfma_f32_16x16x32_bf16 v[108:111], a[100:103], v[104:107], v[108:111]
    v_cvt_pk_bf16_f32 v39, v46, v47
    v_mfma_f32_16x16x32_bf16 v[108:111], a[104:107], v[112:115], v[108:111]
    buffer_store_dwordx4 v[36:39], v222, s[52:55], s4 offen sc1
    v_mfma_f32_16x16x32_bf16 v[108:111], a[108:111], v[120:123], v[108:111]
    s_add_u32 s4, s4, 2048
    v_mul_f32 v68, v68, v196
    v_mul_f32 v69, v69, v196
    v_mfma_f32_16x16x32_bf16 v[108:111], a[112:115], a[48:51], v[108:111]
    v_mul_f32 v70, v70, v196
    v_mul_f32 v71, v71, v196
    v_mfma_f32_16x16x32_bf16 v[108:111], a[116:119], a[52:55], v[108:111]
    v_cvt_pk_bf16_f32 v68, v68, v69
    v_cvt_pk_bf16_f32 v69, v70, v71
    v_mfma_f32_16x16x32_bf16 v[108:111], a[120:123], a[56:59], v[108:111]
    v_mul_f32 v76, v76, v196
    v_mul_f32 v77, v77, v196
    v_mfma_f32_16x16x32_bf16 v[108:111], a[124:127], a[60:63], v[108:111]
    v_mul_f32 v78, v78, v196
    v_mfma_f32_16x16x32_bf16 v[140:143], a[96:99], v[128:131], 0
    v_mul_f32 v79, v79, v196
    v_cvt_pk_bf16_f32 v70, v76, v77
    v_mfma_f32_16x16x32_bf16 v[140:143], a[100:103], v[136:139], v[140:143]
    v_cvt_pk_bf16_f32 v71, v78, v79
    v_mfma_f32_16x16x32_bf16 v[140:143], a[104:107], v[144:147], v[140:143]
    buffer_store_dwordx4 v[68:71], v222, s[52:55], s4 offen sc1
    v_mfma_f32_16x16x32_bf16 v[140:143], a[108:111], v[152:155], v[140:143]
    s_add_u32 s4, s4, 2048
    v_mul_f32 v100, v100, v197
    v_mul_f32 v101, v101, v197
    v_mfma_f32_16x16x32_bf16 v[140:143], a[112:115], a[64:67], v[140:143]
    v_mul_f32 v102, v102, v197
    v_mul_f32 v103, v103, v197
    v_mfma_f32_16x16x32_bf16 v[140:143], a[116:119], a[68:71], v[140:143]
    v_cvt_pk_bf16_f32 v100, v100, v101
    v_cvt_pk_bf16_f32 v101, v102, v103
    v_mfma_f32_16x16x32_bf16 v[140:143], a[120:123], a[72:75], v[140:143]
    v_mul_f32 v108, v108, v197
    v_mul_f32 v109, v109, v197
    v_mfma_f32_16x16x32_bf16 v[140:143], a[124:127], a[76:79], v[140:143]
    v_mul_f32 v110, v110, v197
    v_mul_f32 v111, v111, v197
    v_cvt_pk_bf16_f32 v102, v108, v109
    v_cvt_pk_bf16_f32 v103, v110, v111
    buffer_store_dwordx4 v[100:103], v222, s[52:55], s4 offen sc1
    s_add_u32 s4, s4, 2048
    v_mul_f32 v132, v132, v198
    v_mul_f32 v133, v133, v198
    v_mul_f32 v134, v134, v198
    v_mul_f32 v135, v135, v198
    v_cvt_pk_bf16_f32 v132, v132, v133
    v_cvt_pk_bf16_f32 v133, v134, v135
    v_mul_f32 v140, v140, v198
    v_mul_f32 v141, v141, v198
    v_mul_f32 v142, v142, v198
    v_mul_f32 v143, v143, v198
    v_cvt_pk_bf16_f32 v134, v140, v141
    v_cvt_pk_bf16_f32 v135, v142, v143
    buffer_store_dwordx4 v[132:135], v222, s[52:55], s4 offen sc1
    s_add_u32 s4, s4, 12288
    s_mov_b32 s26, 0
L_cnt:
    v_cmp_gt_u32 vcc, 16, v244
    s_nop 4
    s_cbranch_vccz L_cnt_ok
    v_mov_b32 v217, 0
    buffer_load_dword v244, v242, s[20:23], 0 offen sc1
    s_add_u32 s26, s26, 1
    s_cmp_lt_u32 s26, 65536
    s_waitcnt vmcnt(0)
    s_cbranch_scc1 L_cnt
L_cnt_ok:
    buffer_load_dword v217, v215, s[16:19], 0 offen offset:0 sc1
    s_waitcnt vmcnt(0)
    s_barrier
    buffer_store_dword v216, v214, s[16:19], s89 offen offset:128 sc1
L_poll0:
    v_cmp_ne_u32 vcc, 1, v217
    s_nop 4
    s_cbranch_vccz L_poll0_ok
    buffer_load_dword v217, v215, s[16:19], 0 offen offset:0 sc1
    s_add_u32 s26, s26, 1
    s_cmp_lt_u32 s26, 65536
    s_waitcnt vmcnt(0)
    s_cbranch_scc1 L_poll0
L_poll0_ok:
    buffer_load_dwordx4 v[0:3], v222, s[32:35], s93 offen sc1
    s_add_u32 s93, s93, 143360
    buffer_load_dwordx4 v[4:7], v222, s[32:35], s93 offen sc1
    s_add_u32 s93, s93, 143360
    buffer_load_dwordx4 v[8:11], v222, s[32:35], s93 offen sc1
    s_add_u32 s93, s93, 143360
    buffer_load_dwordx4 v[12:15], v222, s[32:35], s93 offen sc1
    s_add_u32 s93, s93, 143360
    buffer_load_dwordx4 v[16:19], v222, s[32:35], s93 offen sc1
    s_add_u32 s93, s93, 143360
    buffer_load_dwordx4 v[20:23], v222, s[32:35], s93 offen sc1
    s_add_u32 s93, s93, 143360
    buffer_load_dwordx4 v[24:27], v222, s[32:35], s93 offen sc1
    s_add_u32 s93, s93, 143360
    buffer_load_dwordx4 v[28:31], v222, s[32:35], s93 offen sc1
    s_add_u32 s93, s93, 143360
    buffer_load_dwordx4 v[32:35], v222, s[32:35], s93 offen sc1
    s_add_u32 s93, s93, 143360
    buffer_load_dwordx4 v[36:39], v222, s[32:35], s93 offen sc1
    s_add_u32 s93, s93, 143360
    buffer_load_dwordx4 v[40:43], v222, s[32:35], s93 offen sc1
    s_add_u32 s93, s93, 143360
    buffer_load_dwordx4 v[44:47], v222, s[32:35], s93 offen sc1
    s_add_u32 s93, s93, 143360
    buffer_load_dwordx4 v[48:51], v222, s[32:35], s93 offen sc1
    s_add_u32 s93, s93, 143360
    buffer_load_dwordx4 v[52:55], v222, s[32:35], s93 offen sc1
    s_add_u32 s93, s93, 143360
    buffer_load_dwordx4 v[56:59], v222, s[32:35], s93 offen sc1
    s_add_u32 s93, s93, 143360
    buffer_load_dwordx4 v[60:63], v222, s[32:35], s93 offen sc1
    s_add_u32 s93, s93, 143360
L_have0:
    s_waitcnt vmcnt(15)
    v_mfma_f32_16x16x32_bf16 v[160:163], v[184:187], v[0:3], 0
    v_mfma_f32_16x16x32_bf16 v[164:167], v[188:191], v[0:3], 0
    s_waitcnt vmcnt(14)
    v_mfma_f32_16x16x32_bf16 v[160:163], v[184:187], v[4:7], v[160:163]
    v_mfma_f32_16x16x32_bf16 v[164:167], v[188:191], v[4:7], v[164:167]
    s_waitcnt vmcnt(13)
    v_mfma_f32_16x16x32_bf16 v[160:163], v[184:187], v[8:11], v[160:163]
    v_mfma_f32_16x16x32_bf16 v[164:167], v[188:191], v[8:11], v[164:167]
    s_waitcnt vmcnt(12)
    v_mfma_f32_16x16x32_bf16 v[160:163], v[184:187], v[12:15], v[160:163]
    v_mfma_f32_16x16x32_bf16 v[164:167], v[188:191], v[12:15], v[164:167]
    s_waitcnt vmcnt(11)
    v_mfma_f32_16x16x32_bf16 v[160:163], v[184:187], v[16:19], v[160:163]
    v_mfma_f32_16x16x32_bf16 v[164:167], v[188:191], v[16:19], v[164:167]
    s_waitcnt vmcnt(10)
    v_mfma_f32_16x16x32_bf16 v[160:163], v[184:187], v[20:23], v[160:163]
    v_mfma_f32_16x16x32_bf16 v[164:167], v[188:191], v[20:23], v[164:167]
    s_waitcnt vmcnt(9)
    v_mfma_f32_16x16x32_bf16 v[160:163], v[184:187], v[24:27], v[160:163]
    v_mfma_f32_16x16x32_bf16 v[164:167], v[188:191], v[24:27], v[164:167]
    s_waitcnt vmcnt(8)
    v_mfma_f32_16x16x32_bf16 v[160:163], v[184:187], v[28:31], v[160:163]
    v_mfma_f32_16x16x32_bf16 v[164:167], v[188:191], v[28:31], v[164:167]
    s_waitcnt vmcnt(7)
    v_mfma_f32_16x16x32_bf16 v[160:163], v[184:187], v[32:35], v[160:163]
    v_mfma_f32_16x16x32_bf16 v[164:167], v[188:191], v[32:35], v[164:167]
    buffer_load_dword v217, v215, s[16:19], 0 offen offset:128 sc1
    s_waitcnt vmcnt(7)
    v_mfma_f32_16x16x32_bf16 v[160:163], v[184:187], v[36:39], v[160:163]
    v_mfma_f32_16x16x32_bf16 v[164:167], v[188:191], v[36:39], v[164:167]
    s_waitcnt vmcnt(6)
    v_mfma_f32_16x16x32_bf16 v[160:163], v[184:187], v[40:43], v[160:163]
    v_mfma_f32_16x16x32_bf16 v[164:167], v[188:191], v[40:43], v[164:167]
    s_waitcnt vmcnt(5)
    v_mfma_f32_16x16x32_bf16 v[160:163], v[184:187], v[44:47], v[160:163]
    v_mfma_f32_16x16x32_bf16 v[164:167], v[188:191], v[44:47], v[164:167]
    s_waitcnt vmcnt(4)
    v_mfma_f32_16x16x32_bf16 v[160:163], v[184:187], v[48:51], v[160:163]
    v_mfma_f32_16x16x32_bf16 v[164:167], v[188:191], v[48:51], v[164:167]
    s_waitcnt vmcnt(3)
    v_mfma_f32_16x16x32_bf16 v[160:163], v[184:187], v[52:55], v[160:163]
    v_mfma_f32_16x16x32_bf16 v[164:167], v[188:191], v[52:55], v[164:167]
    s_waitcnt vmcnt(2)
    v_mfma_f32_16x16x32_bf16 v[160:163], v[184:187], v[56:59], v[160:163]
    v_mfma_f32_16x16x32_bf16 v[164:167], v[188:191], v[56:59], v[164:167]
    s_waitcnt vmcnt(1)
    v_mfma_f32_16x16x32_bf16 v[160:163], v[184:187], v[60:63], v[160:163]
    v_mfma_f32_16x16x32_bf16 v[164:167], v[188:191], v[60:63], v[164:167]
L_poll1:
    s_waitcnt vmcnt(0)
    v_cmp_ne_u32 vcc, 1, v217
    s_nop 4
    s_cbranch_vccz L_poll1_ok
    buffer_load_dword v217, v215, s[16:19], 0 offen offset:128 sc1
    s_add_u32 s26, s26, 1
    s_cmp_lt_u32 s26, 65536
    s_waitcnt vmcnt(0)
    s_cbranch_scc1 L_poll1
L_poll1_ok:
    buffer_load_dwordx4 v[64:67], v222, s[32:35], s94 offen sc1
    s_add_u32 s94, s94, 143360
    buffer_load_dwordx4 v[68:71], v222, s[32:35], s94 offen sc1
    s_add_u32 s94, s94, 143360
    buffer_load_dwordx4 v[72:75], v222, s[32:35], s94 offen sc1
    s_add_u32 s94, s94, 143360
    buffer_load_dwordx4 v[76:79], v222, s[32:35], s94 offen sc1
    s_add_u32 s94, s94, 143360
    buffer_load_dwordx4 v[80:83], v222, s[32:35], s94 offen sc1
    s_add_u32 s94, s94, 143360
    buffer_load_dwordx4 v[84:87], v222, s[32:35], s94 offen sc1
    s_add_u32 s94, s94, 143360
    buffer_load_dwordx4 v[88:91], v222, s[32:35], s94 offen sc1
    s_add_u32 s94, s94, 143360
    buffer_load_dwordx4 v[92:95], v222, s[32:35], s94 offen sc1
    s_add_u32 s94, s94, 143360
    buffer_load_dwordx4 v[96:99], v222, s[32:35], s94 offen sc1
    s_add_u32 s94, s94, 143360
    buffer_load_dwordx4 v[100:103], v222, s[32:35], s94 offen sc1
    s_add_u32 s94, s94, 143360
    buffer_load_dwordx4 v[104:107], v222, s[32:35], s94 offen sc1
    s_add_u32 s94, s94, 143360
    buffer_load_dwordx4 v[108:111], v222, s[32:35], s94 offen sc1
    s_add_u32 s94, s94, 143360
    buffer_load_dwordx4 v[112:115], v222, s[32:35], s94 offen sc1
    s_add_u32 s94, s94, 143360
    buffer_load_dwordx4 v[116:119], v222, s[32:35], s94 offen sc1
    s_add_u32 s94, s94, 143360
    buffer_load_dwordx4 v[120:123], v222, s[32:35], s94 offen sc1
    s_add_u32 s94, s94, 143360
    buffer_load_dwordx4 v[124:127], v222, s[32:35], s94 offen sc1
    s_add_u32 s94, s94, 143360
    buffer_load_dword v128, v213, s[32:35], s95 offen sc1
    s_add_u32 s95, s95, 143360
    buffer_load_dword v129, v213, s[32:35], s95 offen sc1
    s_add_u32 s95, s95, 143360
    buffer_load_dword v130, v213, s[32:35], s95 offen sc1
    s_add_u32 s95, s95, 143360
    buffer_load_dword v131, v213, s[32:35], s95 offen sc1
    s_add_u32 s95, s95, 143360
    buffer_load_dword v132, v213, s[32:35], s95 offen sc1
    s_add_u32 s95, s95, 143360
    buffer_load_dword v133, v213, s[32:35], s95 offen sc1
    s_add_u32 s95, s95, 143360
    buffer_load_dword v134, v213, s[32:35], s95 offen sc1
    s_add_u32 s95, s95, 143360
    buffer_load_dword v135, v213, s[32:35], s95 offen sc1
    s_add_u32 s95, s95, 143360
    buffer_load_dword v136, v213, s[32:35], s95 offen sc1
    s_add_u32 s95, s95, 143360
    buffer_load_dword v137, v213, s[32:35], s95 offen sc1
    s_add_u32 s95, s95, 143360
    buffer_load_dword v138, v213, s[32:35], s95 offen sc1
    s_add_u32 s95, s95, 143360
    buffer_load_dword v139, v213, s[32:35], s95 offen sc1
    s_add_u32 s95, s95, 143360
    buffer_load_dword v140, v213, s[32:35], s95 offen sc1
    s_add_u32 s95, s95, 143360
    buffer_load_dword v141, v213, s[32:35], s95 offen sc1
    s_add_u32 s95, s95, 143360
    buffer_load_dword v142, v213, s[32:35], s95 offen sc1
    s_add_u32 s95, s95, 143360
    buffer_load_dword v143, v213, s[32:35], s95 offen sc1
    s_add_u32 s95, s95, 143360
    v_cvt_pk_bf16_f32 v160, v160, v161
    v_cvt_pk_bf16_f32 v161, v162, v163
    v_cvt_pk_bf16_f32 v162, v164, v165
    v_cvt_pk_bf16_f32 v163, v166, v167
    buffer_store_dwordx4 v[160:163], v204, s[36:39], s90 offen
    s_waitcnt vmcnt(32)
    v_mfma_f32_16x16x32_bf16 v[168:171], v[184:187], v[64:67], 0
    v_mfma_f32_16x16x32_bf16 v[172:175], v[188:191], v[64:67], 0
    s_waitcnt vmcnt(31)
    v_mfma_f32_16x16x32_bf16 v[168:171], v[184:187], v[68:71], v[168:171]
    v_mfma_f32_16x16x32_bf16 v[172:175], v[188:191], v[68:71], v[172:175]
    s_waitcnt vmcnt(30)
    v_mfma_f32_16x16x32_bf16 v[168:171], v[184:187], v[72:75], v[168:171]
    v_mfma_f32_16x16x32_bf16 v[172:175], v[188:191], v[72:75], v[172:175]
L_pg9:
    s_cbranch_execz L_pgret
    s_waitcnt vmcnt(29)
    v_mfma_f32_16x16x32_bf16 v[168:171], v[184:187], v[76:79], v[168:171]
    v_mfma_f32_16x16x32_bf16 v[172:175], v[188:191], v[76:79], v[172:175]
    s_waitcnt vmcnt(28)
    v_mfma_f32_16x16x32_bf16 v[168:171], v[184:187], v[80:83], v[168:171]
    v_mfma_f32_16x16x32_bf16 v[172:175], v[188:191], v[80:83], v[172:175]
    s_waitcnt vmcnt(27)
    v_mfma_f32_16x16x32_bf16 v[168:171], v[184:187], v[84:87], v[168:171]
    v_mfma_f32_16x16x32_bf16 v[172:175], v[188:191], v[84:87], v[172:175]
    s_waitcnt vmcnt(26)
    v_mfma_f32_16x16x32_bf16 v[168:171], v[184:187], v[88:91], v[168:171]
    v_mfma_f32_16x16x32_bf16 v[172:175], v[188:191], v[88:91], v[172:175]
    s_waitcnt vmcnt(25)
    v_mfma_f32_16x16x32_bf16 v[168:171], v[184:187], v[92:95], v[168:171]
    v_mfma_f32_16x16x32_bf16 v[172:175], v[188:191], v[92:95], v[172:175]
    s_waitcnt vmcnt(24)
    v_mfma_f32_16x16x32_bf16 v[168:171], v[184:187], v[96:99], v[168:171]
    v_mfma_f32_16x16x32_bf16 v[172:175], v[188:191], v[96:99], v[172:175]
    s_waitcnt vmcnt(23)
    v_mfma_f32_16x16x32_bf16 v[168:171], v[184:187], v[100:103], v[168:171]
    v_mfma_f32_16x16x32_bf16 v[172:175], v[188:191], v[100:103], v[172:175]
    s_waitcnt vmcnt(22)
    v_mfma_f32_16x16x32_bf16 v[168:171], v[184:187], v[104:107], v[168:171]
    v_mfma_f32_16x16x32_bf16 v[172:175], v[188:191], v[104:107], v[172:175]
    s_waitcnt vmcnt(21)
    v_mfma_f32_16x16x32_bf16 v[168:171], v[184:187], v[108:111], v[168:171]
    v_mfma_f32_16x16x32_bf16 v[172:175], v[188:191], v[108:111], v[172:175]
    s_waitcnt vmcnt(20)
    v_mfma_f32_16x16x32_bf16 v[168:171], v[184:187], v[112:115], v[168:171]
    v_mfma_f32_16x16x32_bf16 v[172:175], v[188:191], v[112:115], v[172:175]
    s_waitcnt vmcnt(19)
    v_mfma_f32_16x16x32_bf16 v[168:171], v[184:187], v[116:119], v[168:171]
    v_mfma_f32_16x16x32_bf16 v[172:175], v[188:191], v[116:119], v[172:175]
    s_waitcnt vmcnt(18)
    v_mfma_f32_16x16x32_bf16 v[168:171], v[184:187], v[120:123], v[168:171]
    v_mfma_f32_16x16x32_bf16 v[172:175], v[188:191], v[120:123], v[172:175]
    s_waitcnt vmcnt(17)
    v_mfma_f32_16x16x32_bf16 v[168:171], v[184:187], v[124:127], v[168:171]
    v_mfma_f32_16x16x32_bf16 v[172:175], v[188:191], v[124:127], v[172:175]
    s_nop 6
    v_cvt_pk_bf16_f32 v168, v168, v169
    v_cvt_pk_bf16_f32 v169, v170, v171
    v_cvt_pk_bf16_f32 v170, v172, v173
    v_cvt_pk_bf16_f32 v171, v174, v175
    buffer_store_dwordx4 v[168:171], v204, s[36:39], s91 offen
    s_waitcnt vmcnt(17)
    v_lshlrev_b32 v176, 16, v128
    v_and_b32 v177, 0xffff0000, v128
    s_waitcnt vmcnt(16)
    v_lshlrev_b32 v146, 16, v129
    v_and_b32 v147, 0xffff0000, v129
    v_pk_add_f32 v[176:177], v[176:177], v[146:147]
    s_waitcnt vmcnt(15)
    v_lshlrev_b32 v144, 16, v130
    v_and_b32 v145, 0xffff0000, v130
    v_pk_add_f32 v[176:177], v[176:177], v[144:145]
    s_waitcnt vmcnt(14)
    v_lshlrev_b32 v146, 16, v131
    v_and_b32 v147, 0xffff0000, v131
    v_pk_add_f32 v[176:177], v[176:177], v[146:147]
    s_waitcnt vmcnt(13)
    v_lshlrev_b32 v144, 16, v132
    v_and_b32 v145, 0xffff0000, v132
    v_pk_add_f32 v[176:177], v[176:177], v[144:145]
    s_waitcnt vmcnt(12)
    v_lshlrev_b32 v146, 16, v133
    v_and_b32 v147, 0xffff0000, v133
    v_pk_add_f32 v[176:177], v[176:177], v[146:147]
    s_waitcnt vmcnt(11)
    v_lshlrev_b32 v144, 16, v134
    v_and_b32 v145, 0xffff0000, v134
    v_pk_add_f32 v[176:177], v[176:177], v[144:145]
    s_waitcnt vmcnt(10)
    v_lshlrev_b32 v146, 16, v135
    v_and_b32 v147, 0xffff0000, v135
    v_pk_add_f32 v[176:177], v[176:177], v[146:147]
    s_waitcnt vmcnt(9)
    v_lshlrev_b32 v144, 16, v136
    v_and_b32 v145, 0xffff0000, v136
    v_pk_add_f32 v[176:177], v[176:177], v[144:145]
    s_waitcnt vmcnt(8)
    v_lshlrev_b32 v146, 16, v137
    v_and_b32 v147, 0xffff0000, v137
    v_pk_add_f32 v[176:177], v[176:177], v[146:147]
    s_waitcnt vmcnt(7)
    v_lshlrev_b32 v144, 16, v138
    v_and_b32 v145, 0xffff0000, v138
    v_pk_add_f32 v[176:177], v[176:177], v[144:145]
    s_waitcnt vmcnt(6)
    v_lshlrev_b32 v146, 16, v139
    v_and_b32 v147, 0xffff0000, v139
    v_pk_add_f32 v[176:177], v[176:177], v[146:147]
    s_waitcnt vmcnt(5)
    v_lshlrev_b32 v144, 16, v140
    v_and_b32 v145, 0xffff0000, v140
    v_pk_add_f32 v[176:177], v[176:177], v[144:145]
    s_waitcnt vmcnt(4)
    v_lshlrev_b32 v146, 16, v141
    v_and_b32 v147, 0xffff0000, v141
    v_pk_add_f32 v[176:177], v[176:177], v[146:147]
    s_waitcnt vmcnt(3)
    v_lshlrev_b32 v144, 16, v142
    v_and_b32 v145, 0xffff0000, v142
    v_pk_add_f32 v[176:177], v[176:177], v[144:145]
    s_waitcnt vmcnt(2)
    v_lshlrev_b32 v146, 16, v143
    v_and_b32 v147, 0xffff0000, v143
    v_pk_add_f32 v[176:177], v[176:177], v[146:147]
    v_cvt_pk_bf16_f32 v176, v176, v177
    buffer_store_dword v176, v206, s[36:39], s13 offen
L_end:
    s_endpgm
L_fallback:
    s_waitcnt vmcnt(0) lgkmcnt(0)
    s_nop 15
    s_nop 3
    s_barrier
    s_mov_b32 s96, 1
    s_mov_b32 s93, 0
    s_mov_b32 s94, 0
    s_mov_b32 s95, 0
    v_mov_b32 v194, 0xff800000
    v_mov_b32 v195, 0xff800000
    v_mov_b32 v196, 0xff800000
    v_mov_b32 v197, 0xff800000
    v_mov_b32 v198, 0xff800000
L_fbloop:
    s_add_u32 m0, s92, 65536
    s_nop 0
    buffer_load_dwordx4 v212, s[40:43], s93 offen offset:0 nt lds
    buffer_load_dwordx4 v213, s[40:43], s93 offen offset:1024 nt lds
    buffer_load_dwordx4 v214, s[40:43], s93 offen offset:2048 nt lds
    buffer_load_dwordx4 v215, s[40:43], s93 offen offset:3072 nt lds
    s_add_u32 s93, s93, 16384
    s_waitcnt vmcnt(0)
    s_barrier
    ds_read_b128 a[160:163], v200 offset:0
    ds_read_b128 a[164:167], v201 offset:0
    ds_read_b128 a[168:171], v202 offset:0
    ds_read_b128 a[172:175], v203 offset:0
    ds_read_b128 a[176:179], v245 offset:0
    ds_read_b128 a[180:183], v246 offset:0
    ds_read_b128 a[184:187], v247 offset:0
    ds_read_b128 a[188:191], v248 offset:0
    s_waitcnt lgkmcnt(7)
    v_mfma_f32_16x16x32_bf16 v[0:3], a[160:163], a[0:3], 0
    s_waitcnt lgkmcnt(6)
    v_mfma_f32_16x16x32_bf16 v[0:3], a[164:167], a[4:7], v[0:3]
    s_waitcnt lgkmcnt(5)
    v_mfma_f32_16x16x32_bf16 v[0:3], a[168:171], a[8:11], v[0:3]
    s_waitcnt lgkmcnt(4)
    v_mfma_f32_16x16x32_bf16 v[0:3], a[172:175], a[12:15], v[0:3]
    s_waitcnt lgkmcnt(3)
    v_mfma_f32_16x16x32_bf16 v[0:3], a[176:179], a[16:19], v[0:3]
    s_waitcnt lgkmcnt(2)
    v_mfma_f32_16x16x32_bf16 v[0:3], a[180:183], a[20:23], v[0:3]
    s_waitcnt lgkmcnt(1)
    v_mfma_f32_16x16x32_bf16 v[0:3], a[184:187], a[24:27], v[0:3]
    s_waitcnt lgkmcnt(0)
    v_mfma_f32_16x16x32_bf16 v[0:3], a[188:191], a[28:31], v[0:3]
    v_mfma_f32_16x16x32_bf16 v[4:7], a[160:163], a[32:35], 0
    v_mfma_f32_16x16x32_bf16 v[4:7], a[164:167], a[36:39], v[4:7]
    v_mfma_f32_16x16x32_bf16 v[4:7], a[168:171], a[40:43], v[4:7]
    v_mfma_f32_16x16x32_bf16 v[4:7], a[172:175], a[44:47], v[4:7]
    v_mfma_f32_16x16x32_bf16 v[4:7], a[176:179], a[48:51], v[4:7]
    v_mfma_f32_16x16x32_bf16 v[4:7], a[180:183], a[52:55], v[4:7]
    v_mfma_f32_16x16x32_bf16 v[4:7], a[184:187], a[56:59], v[4:7]
    v_mfma_f32_16x16x32_bf16 v[4:7], a[188:191], a[60:63], v[4:7]
    v_mfma_f32_16x16x32_bf16 v[8:11], a[160:163], a[64:67], 0
    v_mfma_f32_16x16x32_bf16 v[8:11], a[164:167], a[68:71], v[8:11]
    v_mfma_f32_16x16x32_bf16 v[8:11], a[168:171], a[72:75], v[8:11]
    v_mfma_f32_16x16x32_bf16 v[8:11], a[172:175], a[76:79], v[8:11]
    v_mfma_f32_16x16x32_bf16 v[8:11], a[176:179], a[80:83], v[8:11]
    v_mfma_f32_16x16x32_bf16 v[8:11], a[180:183], a[84:87], v[8:11]
    v_mfma_f32_16x16x32_bf16 v[8:11], a[184:187], a[88:91], v[8:11]
    v_mfma_f32_16x16x32_bf16 v[8:11], a[188:191], a[92:95], v[8:11]
    v_mfma_f32_16x16x32_bf16 v[12:15], a[160:163], a[96:99], 0
    v_mfma_f32_16x16x32_bf16 v[12:15], a[164:167], a[100:103], v[12:15]
    v_mfma_f32_16x16x32_bf16 v[12:15], a[168:171], a[104:107], v[12:15]
    v_mfma_f32_16x16x32_bf16 v[12:15], a[172:175], a[108:111], v[12:15]
    v_mfma_f32_16x16x32_bf16 v[12:15], a[176:179], a[112:115], v[12:15]
    v_mfma_f32_16x16x32_bf16 v[12:15], a[180:183], a[116:119], v[12:15]
    v_mfma_f32_16x16x32_bf16 v[12:15], a[184:187], a[120:123], v[12:15]
    v_mfma_f32_16x16x32_bf16 v[12:15], a[188:191], a[124:127], v[12:15]
    v_mfma_f32_16x16x32_bf16 v[16:19], a[160:163], a[128:131], 0
    v_mfma_f32_16x16x32_bf16 v[16:19], a[164:167], a[132:135], v[16:19]
    v_mfma_f32_16x16x32_bf16 v[16:19], a[168:171], a[136:139], v[16:19]
    v_mfma_f32_16x16x32_bf16 v[16:19], a[172:175], a[140:143], v[16:19]
    v_mfma_f32_16x16x32_bf16 v[16:19], a[176:179], a[144:147], v[16:19]
    v_mfma_f32_16x16x32_bf16 v[16:19], a[180:183], a[148:151], v[16:19]
    v_mfma_f32_16x16x32_bf16 v[16:19], a[184:187], a[152:155], v[16:19]
    v_mfma_f32_16x16x32_bf16 v[16:19], a[188:191], a[156:159], v[16:19]
    s_cmp_eq_u32 s95, 32
    s_cbranch_scc1 L_fbdone
    v_max3_f32 v194, v194, v0, v1
    v_max3_f32 v194, v194, v2, v3
    v_max3_f32 v195, v195, v4, v5
    v_max3_f32 v195, v195, v6, v7
    v_max3_f32 v196, v196, v8, v9
    v_max3_f32 v196, v196, v10, v11
    v_max3_f32 v197, v197, v12, v13
    v_max3_f32 v197, v197, v14, v15
    v_max3_f32 v198, v198, v16, v17
    v_max3_f32 v198, v198, v18, v19
    s_waitcnt vmcnt(0) lgkmcnt(0)
    s_nop 15
    s_nop 3
    s_barrier
    s_add_u32 s95, s95, 1
    s_cmp_lt_u32 s95, 32
    s_cbranch_scc1 L_fbloop
    v_mov_b32 v242, v194
    s_nop 1
    v_permlane32_swap_b32 v242, v194
    v_max_f32 v194, v194, v242
    ds_write_b32 v224, v194 offset:0
    v_mov_b32 v243, v195
    s_nop 1
    v_permlane32_swap_b32 v243, v195
    v_max_f32 v195, v195, v243
    ds_write_b32 v224, v195 offset:256
    v_mov_b32 v242, v196
    s_nop 1
    v_permlane32_swap_b32 v242, v196
    v_max_f32 v196, v196, v242
    ds_write_b32 v224, v196 offset:512
    v_mov_b32 v243, v197
    s_nop 1
    v_permlane32_swap_b32 v243, v197
    v_max_f32 v197, v197, v243
    ds_write_b32 v224, v197 offset:768
    v_mov_b32 v242, v198
    s_nop 1
    v_permlane32_swap_b32 v242, v198
    v_max_f32 v198, v198, v242
    ds_write_b32 v224, v198 offset:1024
    s_waitcnt vmcnt(0) lgkmcnt(0)
    s_nop 15
    s_nop 3
    s_barrier
    ds_read_b128 v[32:35], v225 offset:0
    ds_read_b128 v[36:39], v225 offset:256
    ds_read_b128 v[40:43], v225 offset:512
    ds_read_b128 v[44:47], v225 offset:768
    ds_read_b128 v[48:51], v225 offset:1024
    s_waitcnt lgkmcnt(4)
    v_max_f32 v194, v32, v33
    v_max3_f32 v194, v194, v34, v35
    s_waitcnt lgkmcnt(3)
    v_max_f32 v195, v36, v37
    v_max3_f32 v195, v195, v38, v39
    s_waitcnt lgkmcnt(2)
    v_max_f32 v196, v40, v41
    v_max3_f32 v196, v196, v42, v43
    s_waitcnt lgkmcnt(1)
    v_max_f32 v197, v44, v45
    v_max3_f32 v197, v197, v46, v47
    s_waitcnt lgkmcnt(0)
    v_max_f32 v198, v48, v49
    v_max3_f32 v198, v198, v50, v51
    v_mul_f32 v184, s99, v194
    v_mul_f32 v185, s99, v195
    v_mul_f32 v186, s99, v196
    v_mul_f32 v187, s99, v197
    v_mul_f32 v188, s99, v198
    s_mov_b32 s93, 0
    s_waitcnt vmcnt(0) lgkmcnt(0)
    s_nop 15
    s_nop 3
    s_branch L_fbloop
L_fbdone:
    s_add_u32 m0, s92, 81920
    s_nop 0
    buffer_load_dwordx4 v212, s[40:43], s93 offen offset:0 nt lds
    buffer_load_dwordx4 v213, s[40:43], s93 offen offset:1024 nt lds
    buffer_load_dwordx4 v214, s[40:43], s93 offen offset:2048 nt lds
    buffer_load_dwordx4 v215, s[40:43], s93 offen offset:3072 nt lds
    s_add_u32 s93, s93, 16384
    s_add_u32 m0, s92, 0
    s_nop 0
    buffer_load_dwordx4 v216, s[44:47], s94 offen offset:0 nt lds
    buffer_load_dwordx4 v217, s[44:47], s94 offen offset:1024 nt lds
    buffer_load_dwordx4 v218, s[44:47], s94 offen offset:2048 nt lds
    buffer_load_dwordx4 v219, s[44:47], s94 offen offset:3072 nt lds
    s_add_u32 s94, s94, 16384
    s_add_u32 m0, s92, 16384
    s_nop 0
    buffer_load_dwordx4 v216, s[44:47], s94 offen offset:0 nt lds
    buffer_load_dwordx4 v217, s[44:47], s94 offen offset:1024 nt lds
    s_waitcnt vmcnt(0) lgkmcnt(0)
    s_nop 15
    s_nop 3
    s_barrier
    ds_read_b128 a[220:223], v200 offset:16384
    ds_read_b128 a[224:227], v201 offset:16384
    ds_read_b128 a[228:231], v202 offset:16384
    ds_read_b128 a[232:235], v203 offset:16384
    ds_read_b128 a[236:239], v245 offset:16384
    ds_read_b128 a[240:243], v246 offset:16384
    ds_read_b128 a[244:247], v247 offset:16384
    ds_read_b128 a[248:251], v248 offset:16384
    s_waitcnt vmcnt(0) lgkmcnt(0)
    s_nop 15
    s_nop 3
    s_branch L_attn1
L_code_end:

.section .rodata,"a"
.p2align 6
.amdhsa_kernel concat_heads__gqa_block_cached__mha_block_cached__near_ridge_kernel
  .amdhsa_next_free_vgpr 512
  .amdhsa_next_free_sgpr 102
  .amdhsa_accum_offset 256
  .amdhsa_group_segment_fixed_size 0
  .amdhsa_kernarg_size 104
  .amdhsa_user_sgpr_count 2
  .amdhsa_user_sgpr_kernarg_segment_ptr 1
  .amdhsa_system_sgpr_workgroup_id_x 1
.end_amdhsa_kernel
```
